```python
import torch

def _softmax(x, axis=-1):
    return torch.softmax(x, dim=axis)
def _gelu(x):
    return torch.nn.functional.gelu(x, approximate="tanh")
def _silu(x):
    return torch.nn.functional.silu(x)
def _sigmoid(x):
    return torch.sigmoid(x)
def _layernorm(x, axis=-1, eps=1e-5):
    m = x.mean(dim=axis, keepdim=True)
    v = x.var(dim=axis, keepdim=True, unbiased=False)
    return (x - m) / torch.sqrt(v + eps)
def _scatter_add(tgt, idx, src, axis=0):
    return tgt.clone().index_add_(axis, idx, src)
def _segment_sum(src, seg, n):
    out = torch.zeros((n,) + src.shape[1:], dtype=src.dtype)
    return out.index_add_(0, seg, src)
def _pad(x, pw):
    flat = tuple(v for pair in reversed(pw) for v in pair)
    return torch.nn.functional.pad(x, flat)

kernel_name = 'concat_heads__mha_block_cached__gqa_block_cached__near_ridge'

def setup_inputs():

    _w = (lambda a: (lambda t: t.to(torch.bfloat16) if t.is_floating_point() else t)(torch.as_tensor(a)))
    def _A_setup():
        B, Sq, D = 8, 240, 576
        H, Sk, Dh = 32, 1024, 128
        return {
            "x": _w((lambda *s: torch.randn(*s, dtype=torch.bfloat16) * 0.8)(B, Sq, D)),
            "k_cache": _w((lambda *s: torch.randn(*s, dtype=torch.bfloat16) * 0.8)(B, H, Sk, Dh)),
            "v_cache": _w((lambda *s: torch.randn(*s, dtype=torch.bfloat16) * 0.05)(B, H, Sk, Dh)),
            "wq": _w((lambda *s: torch.randn(*s, dtype=torch.bfloat16) * 0.8)(D, H * Dh) * (D ** -0.5)),
            "wo": _w((lambda *s: torch.randn(*s, dtype=torch.bfloat16) * 0.05)(H * Dh, D) * ((H * Dh) ** -0.5)),
        }
    _A_in = _A_setup()

    def _B_setup():
        B, Sq, D = 8, 240, 576
        Hq, Hkv, Sk, Dh = 32, 32, 1024, 128
        assert Hq % Hkv == 0, (Hq, Hkv)
        return {
            "x": _w((lambda *s: torch.randn(*s, dtype=torch.bfloat16) * 0.8)(B, Sq, D)),
            "k_cache": _w((lambda *s: torch.randn(*s, dtype=torch.bfloat16) * 0.8)(B, Hkv, Sk, Dh)),
            "v_cache": _w((lambda *s: torch.randn(*s, dtype=torch.bfloat16) * 0.05)(B, Hkv, Sk, Dh)),
            "wq": _w((lambda *s: torch.randn(*s, dtype=torch.bfloat16) * 0.8)(D, Hq * Dh) * (D ** -0.5)),
            "wo": _w((lambda *s: torch.randn(*s, dtype=torch.bfloat16) * 0.05)(Hq * Dh, D) * ((Hq * Dh) ** -0.5)),
        }
    _B_in = _B_setup()

    return {
        "A_x": _A_in["x"],
        "A_k_cache": _A_in["k_cache"],
        "A_v_cache": _A_in["v_cache"],
        "A_wq": _A_in["wq"],
        "A_wo": _A_in["wo"],
        "B_x": _B_in["x"],
        "B_k_cache": _B_in["k_cache"],
        "B_v_cache": _B_in["v_cache"],
        "B_wq": _B_in["wq"],
        "B_wo": _B_in["wo"],
    }

def reference(A_x, A_k_cache, A_v_cache, A_wq, A_wo, B_x, B_k_cache, B_v_cache, B_wq, B_wo):
    def _A_ref(x, k_cache, v_cache, wq, wo):
        B, Sq, D = x.shape
        H, Dh = 32, 128
        q = (lambda x, *d: x.permute(*d))((x @ wq).reshape(B, Sq, H, Dh), 0, 2, 1, 3)
        scores = torch.einsum("bhqd,bhkd->bhqk", q, k_cache) * (Dh ** -0.5)
        p = _softmax(scores, axis=-1)
        o = torch.einsum("bhqk,bhkd->bhqd", p, v_cache)
        return (lambda x, *d: x.permute(*d))(o, 0, 2, 1, 3).reshape(B, Sq, H * Dh) @ wo

    def _B_ref(x, k_cache, v_cache, wq, wo):
        B, Sq, D = x.shape
        Hq, Dh = 32, 128
        Hkv = k_cache.shape[1]
        rep = Hq // Hkv
        q = (lambda x, *d: x.permute(*d))((x @ wq).reshape(B, Sq, Hq, Dh), 0, 2, 1, 3)
        k = (lambda x, n, axis: torch.repeat_interleave(x, n, dim=axis))(k_cache, rep, axis=1)
        v = (lambda x, n, axis: torch.repeat_interleave(x, n, dim=axis))(v_cache, rep, axis=1)
        scores = torch.einsum("bhqd,bhkd->bhqk", q, k) * (Dh ** -0.5)
        p = _softmax(scores, axis=-1)
        o = torch.einsum("bhqk,bhkd->bhqd", p, v)
        return (lambda x, *d: x.permute(*d))(o, 0, 2, 1, 3).reshape(B, Sq, Hq * Dh) @ wo

    a = _A_ref(A_x, A_k_cache, A_v_cache, A_wq, A_wo)
    b = _B_ref(B_x, B_k_cache, B_v_cache, B_wq, B_wo)
    return torch.concatenate([a, b], axis=-1)
```

```asm
; @launch kernel=attn_kernel grid=(256,1,1) block=(256,1,1) lds=163840
; @launch kernel=oproj_kernel grid=(240,1,1) block=(256,1,1) lds=147456
.amdgcn_target "amdgcn-amd-amdhsa--gfx950"
.text
.globl attn_kernel
.p2align 8
.type attn_kernel,@function
attn_kernel:
    s_cmp_ge_u32 s2, 256
    s_cbranch_scc1 L_k1_end
    s_load_dwordx8 s[4:11], s[0:1], 0
    s_load_dwordx2 s[12:13], s[0:1], 32
    s_load_dwordx8 s[32:39], s[0:1], 40
    s_load_dwordx2 s[40:41], s[0:1], 72
    s_load_dwordx2 s[14:15], s[0:1], 96
    s_getpc_b64 s[72:73]
L_here:
    s_mov_b32 s75, 131072
    s_mov_b32 s74, L_code_end-L_here
    v_mov_b32 v101, 2130706432
    v_lshlrev_b32 v100, 7, v0
    v_cmp_gt_u32 vcc, 40, v0
    s_bfe_u32 s3, s2, 196611
    s_mul_i32 s3, s3, 5120
    v_add_u32 v100, s3, v100
    v_cndmask_b32_e32 v100, v101, v100, vcc
    buffer_load_dword v101, v100, s[72:75], 0 offen offset:0
    s_bfe_u32 s67, s2, 65538
    s_and_b32 s3, s2, 1
    s_lshl_b32 s3, s3, 2
    s_bfe_u32 s69, s2, 131075
    s_add_u32 s65, s3, s69
    s_lshl_b32 s69, s69, 1
    s_lshr_b32 s80, s2, 5
    s_add_u32 s101, s69, s80
    s_cmp_ge_u32 s101, 9
    s_cselect_b32 s69, 9, 0
    s_sub_u32 s101, s101, s69
    s_and_b32 s3, s2, 2
    s_lshl_b32 s3, s3, 2
    s_add_u32 s66, s3, s80
    s_lshl_b32 s66, s66, 1
    s_mov_b32 s101, 0
    s_lshl_b32 s87, s101, 7
    s_lshl_b32 s89, s101, 19
    s_add_u32 s88, s89, 262144
    v_lshrrev_b32 v67, 6, v0
    v_and_b32 v64, 63, v0
    v_readfirstlane_b32 s64, v67
    v_lshrrev_b32 v65, 4, v64
    v_and_b32 v66, 15, v64
    v_lshrrev_b32 v68, 3, v64
    s_lshl_b32 s68, s64, 12
    s_mul_i32 s3, s64, 73728
    v_mul_u32_u24 v67, 1152, v68
    v_and_b32 v69, 7, v64
    v_xor_b32 v69, v69, v65
    v_add_u32 v67, s3, v67
    v_lshl_add_u32 v32, v69, 4, v67
    v_xor_b32 v69, 4, v69
    v_lshl_add_u32 v70, v69, 4, v67
    v_add_u32 v33, 8192, v70
    v_add_u32 v34, 16384, v32
    v_add_u32 v35, 24576, v70
    v_add_u32 v36, 36864, v32
    v_add_u32 v37, 45056, v70
    v_add_u32 v38, 53248, v32
    v_add_u32 v39, 61440, v70
    v_lshrrev_b32 v68, 5, v64
    v_and_b32 v69, 31, v64
    v_xor_b32 v69, v69, v68
    s_and_b32 s3, s64, 1
    s_lshl_b32 s3, s3, 3
    v_xor_b32 v69, s3, v69
    s_lshl_b32 s69, s64, 16
    v_lshlrev_b32 v68, 13, v68
    v_add_u32 v67, s69, v68
    v_lshl_add_u32 v40, v69, 4, v67
    v_xor_b32 v69, 4, v69
    v_lshl_add_u32 v70, v69, 4, v67
    v_add_u32 v41, 15360, v70
    v_add_u32 v42, 30720, v40
    v_add_u32 v43, 46080, v70
    v_mov_b32 v44, v40
    v_mov_b32 v45, v41
    v_mov_b32 v46, v42
    v_mov_b32 v47, v43
    s_add_u32 s90, s68, 32768
    s_add_u32 s91, s68, 49152
    s_add_u32 s92, s68, 131072
    s_waitcnt lgkmcnt(0)
    s_cmp_eq_u32 s67, 0
    s_cselect_b64 s[4:5], s[4:5], s[32:33]
    s_cselect_b64 s[10:11], s[10:11], s[38:39]
    s_cselect_b64 s[6:7], s[6:7], s[34:35]
    s_cselect_b64 s[8:9], s[8:9], s[36:37]
    s_cselect_b64 s[12:13], s[12:13], s[40:41]
    s_mul_i32 s3, s65, 276480
    s_add_u32 s44, s4, s3
    s_addc_u32 s45, s5, 0
    s_mov_b32 s46, 276480
    s_mov_b32 s47, 131072
    s_add_u32 s48, s4, s3
    s_addc_u32 s49, s5, 0
    s_mov_b32 s50, 276480
    s_mov_b32 s51, 131072
    s_lshl_b32 s3, s66, 8
    s_sub_u32 s69, 4718592, s3
    s_add_u32 s52, s10, s3
    s_addc_u32 s53, s11, 0
    s_mov_b32 s54, s69
    s_mov_b32 s55, 131072
    s_add_u32 s56, s10, s3
    s_addc_u32 s57, s11, 0
    s_mov_b32 s58, s69
    s_mov_b32 s59, 131072
    s_mov_b32 m0, s90
    s_nop 0
    buffer_load_dwordx4 v32, s[44:47], s87 offen offset:0 lds
    buffer_load_dwordx4 v33, s[44:47], s87 offen offset:1024 lds
    buffer_load_dwordx4 v34, s[44:47], s87 offen offset:2048 lds
    buffer_load_dwordx4 v35, s[44:47], s87 offen offset:3072 lds
    s_mov_b32 m0, s91
    s_nop 0
    buffer_load_dwordx4 v36, s[48:51], s87 offen offset:0 lds
    buffer_load_dwordx4 v37, s[48:51], s87 offen offset:1024 lds
    buffer_load_dwordx4 v38, s[48:51], s87 offen offset:2048 lds
    buffer_load_dwordx4 v39, s[48:51], s87 offen offset:3072 lds
    s_add_u32 s87, s87, 128
    s_cmp_eq_u32 s87, 1152
    s_cselect_b32 s87, 0, s87
    s_xor_b32 s90, s90, 49152
    s_xor_b32 s91, s91, 98304
    s_add_u32 m0, s92, 16384
    s_nop 0
    buffer_load_dwordx4 v44, s[56:59], s89 offen offset:0 lds
    buffer_load_dwordx4 v45, s[56:59], s89 offen offset:1024 lds
    buffer_load_dwordx4 v46, s[56:59], s89 offen offset:2048 lds
    buffer_load_dwordx4 v47, s[56:59], s89 offen offset:3072 lds
    s_add_u32 s89, s89, 524288
    s_cmp_eq_u32 s89, 4718592
    s_cselect_b32 s89, 0, s89
    s_mov_b32 m0, s92
    s_nop 0
    buffer_load_dwordx4 v40, s[52:55], s88 offen offset:0 lds
    buffer_load_dwordx4 v41, s[52:55], s88 offen offset:1024 lds
    buffer_load_dwordx4 v42, s[52:55], s88 offen offset:2048 lds
    buffer_load_dwordx4 v43, s[52:55], s88 offen offset:3072 lds
    s_add_u32 s88, s88, 524288
    s_cmp_eq_u32 s88, 4980736
    s_cselect_b32 s88, 262144, s88
    v_mov_b32 v60, 0
    v_mov_b32 v61, 0
    v_mov_b32 v62, 0
    v_mov_b32 v63, 0
    s_nop 1
    s_lshl_b32 s3, s65, 5
    s_add_u32 s3, s3, s66
    s_lshl_b32 s3, s3, 18
    s_add_u32 s32, s6, s3
    s_addc_u32 s33, s7, 0
    s_mov_b32 s34, 524288
    s_mov_b32 s35, 131072
    s_add_u32 s36, s8, s3
    s_addc_u32 s37, s9, 0
    s_mov_b32 s38, 524288
    s_mov_b32 s39, 131072
    s_mul_i32 s3, s67, 15728640
    v_mfma_f32_32x32x16_bf16 v[128:143], v[60:63], v[60:63], 0
    s_add_u32 s40, s14, s3
    s_addc_u32 s41, s15, 0
    s_mov_b32 s42, 15728640
    s_mov_b32 s43, 131072
    s_add_u32 s16, s12, 0
    s_addc_u32 s17, s13, 0
    s_mov_b32 s18, 4718592
    s_mov_b32 s19, 131072
    s_mul_i32 s3, s67, 4718592
    s_add_u32 s3, s3, 33554432
    s_add_u32 s20, s14, s3
    s_addc_u32 s21, s15, 0
    v_mfma_f32_32x32x16_bf16 a[0:15], v[60:63], v[60:63], 0
    s_mov_b32 s22, 4718592
    s_mov_b32 s23, 131072
    s_lshr_b32 s31, s2, 4
    s_xor_b32 s31, s31, s2
    s_and_b32 s31, s31, 15
    s_lshl_b32 s31, s31, 14
    s_lshr_b32 s3, s31, 14
    s_bfe_u32 s69, s3, 65536
    s_lshl_b32 s31, s69, 10
    s_bfe_u32 s69, s3, 65537
    s_lshl_b32 s69, s69, 12
    s_or_b32 s31, s31, s69
    v_mfma_f32_32x32x16_bf16 v[144:159], v[60:63], v[60:63], 0
    s_bfe_u32 s69, s3, 65538
    s_lshl_b32 s69, s69, 13
    s_or_b32 s31, s31, s69
    s_bfe_u32 s69, s3, 65539
    s_lshl_b32 s69, s69, 14
    s_or_b32 s31, s31, s69
    s_mov_b32 s81, 4096
    s_mov_b32 s82, 5120
    s_mov_b32 s86, 0
    s_mov_b32 s98, 0
    s_mov_b32 s93, 0
    s_mov_b32 s84, 32768
    v_mfma_f32_32x32x16_bf16 a[16:31], v[60:63], v[60:63], 0
    s_mov_b32 s85, 267264
    s_add_u32 s83, s68, 32768
    s_lshl_b32 s99, s66, 12
    s_add_u32 s100, s99, 2048
    s_mov_b32 s94, 1400897536
    s_mov_b32 s95, 729808896
    s_mov_b32 s60, 1040356334
    s_mov_b32 s61, 1040356334
    s_cmp_eq_u32 s64, 3
    s_cselect_b32 s3, 4048155338, 0
    s_cselect_b32 s97, 1065353216, 0
    v_mov_b32 v20, s3
    v_mfma_f32_32x32x16_bf16 v[160:175], v[60:63], v[60:63], 0
    v_mov_b32 v21, s3
    v_mov_b32 v22, s3
    v_mov_b32 v23, s3
    v_lshlrev_b32 v67, 8, v65
    s_bfe_u32 s69, s64, 65536
    s_lshl_b32 s3, s69, 15
    s_bfe_u32 s69, s64, 65537
    s_lshl_b32 s69, s69, 16
    s_or_b32 s3, s3, s69
    v_add_u32 v67, s3, v67
    v_add_u32 v70, 0, v65
    v_xor_b32 v70, v70, v66
    v_mfma_f32_32x32x16_bf16 a[32:47], v[60:63], v[60:63], 0
    v_lshl_add_u32 v13, v70, 4, v67
    v_add_u32 v70, 4, v65
    v_xor_b32 v70, v70, v66
    v_lshl_add_u32 v14, v70, 4, v67
    v_add_u32 v14, 130048, v14
    v_add_u32 v70, 8, v65
    v_xor_b32 v70, v70, v66
    v_lshl_add_u32 v15, v70, 4, v67
    v_add_u32 v70, 12, v65
    v_xor_b32 v70, v70, v66
    v_lshl_add_u32 v16, v70, 4, v67
    v_add_u32 v16, 130048, v16
    v_mfma_f32_32x32x16_bf16 v[176:191], v[60:63], v[60:63], 0
    v_lshlrev_b32 v70, 1, v65
    v_xor_b32 v70, v70, v66
    v_lshl_add_u32 v17, v70, 4, v67
    v_xor_b32 v18, 128, v17
    v_add_u32 v18, 130048, v18
    v_lshrrev_b32 v69, 1, v66
    v_xor_b32 v69, v69, v65
    v_lshlrev_b32 v68, 7, v66
    v_add_u32 v68, s68, v68
    v_lshl_add_u32 v68, v69, 4, v68
    v_xor_b32 v70, 64, v68
    v_add_u32 v48, 32768, v68
    v_mfma_f32_32x32x16_bf16 a[48:63], v[60:63], v[60:63], 0
    v_add_u32 v49, 32768, v70
    v_add_u32 v50, 49152, v68
    v_add_u32 v51, 49152, v70
    v_xor_b32 v69, v65, v66
    v_lshlrev_b32 v68, 8, v66
    v_lshl_add_u32 v1, v69, 4, v68
    v_xor_b32 v2, 64, v1
    v_xor_b32 v3, 128, v1
    v_xor_b32 v4, 192, v1
    v_lshrrev_b32 v71, 2, v66
    v_and_b32 v72, 3, v64
    v_lshl_add_u32 v67, v65, 2, v71
    v_mfma_f32_32x32x16_bf16 v[192:207], v[60:63], v[60:63], 0
    v_and_b32 v69, 7, v67
    v_lshlrev_b32 v68, 8, v67
    v_lshl_add_u32 v68, v69, 5, v68
    v_lshl_add_u32 v68, v72, 3, v68
    v_add_u32 v5, 65536, v68
    v_xor_b32 v6, 32, v5
    v_xor_b32 v7, 64, v5
    v_xor_b32 v8, 96, v5
    v_xor_b32 v9, 128, v5
    v_xor_b32 v10, 160, v5
    v_xor_b32 v11, 192, v5
    v_xor_b32 v12, 224, v5
    v_mfma_f32_32x32x16_bf16 a[64:79], v[60:63], v[60:63], 0
    v_lshl_add_u32 v67, v65, 3, v71
    v_lshlrev_b32 v67, 9, v67
    v_and_b32 v68, 1, v72
    v_lshl_add_u32 v67, v68, 3, v67
    v_and_b32 v68, 2, v72
    v_and_b32 v69, 1, v71
    v_or_b32 v68, v68, v69
    v_and_b32 v69, 2, v71
    v_lshl_or_b32 v68, v69, 1, v68
    v_and_b32 v69, 1, v65
    v_lshl_or_b32 v68, v69, 3, v68
    v_lshl_add_u32 v67, v68, 4, v67
    v_mfma_f32_32x32x16_bf16 v[208:223], v[60:63], v[60:63], 0
    v_add_u32 v52, 131072, v67
    v_xor_b32 v53, 16, v52
    v_xor_b32 v54, 64, v52
    v_xor_b32 v55, 80, v52
    v_xor_b32 v56, 128, v52
    v_xor_b32 v57, 144, v52
    v_xor_b32 v58, 192, v52
    v_xor_b32 v59, 208, v52
    v_lshrrev_b32 v67, 5, v64
    v_bfe_u32 v68, v64, 1, 1
    v_cmp_eq_u32 vcc, v67, v68
    v_mov_b32 v69, 1065369472
    v_mfma_f32_32x32x16_bf16 a[80:95], v[60:63], v[60:63], 0
    v_and_b32 v70, 1, v64
    v_cndmask_b32 v69, 0, v69, vcc
    v_mul_u32_u24 v70, 43690, v70
    v_add_u32 v19, 17476, v70
    v_accvgpr_write_b32 a232, v69
    v_accvgpr_write_b32 a233, v69
    v_accvgpr_write_b32 a234, v69
    v_accvgpr_write_b32 a235, v69
    s_lshl_b32 s96, s64, 13
    s_add_u32 s96, s96, 131072
    v_lshl_add_u32 v67, v65, 2, v71
    v_mul_u32_u24 v67, 96, v67
    v_mfma_f32_32x32x16_bf16 v[224:239], v[60:63], v[60:63], 0
    v_mul_u32_u24 v68, 24, v72
    v_add3_u32 v67, v67, v68, s96
    v_lshlrev_b32 v0, 4, v64
    v_accvgpr_write_b32 a239, v67
    v_subrev_u32 v67, s96, v67
    v_add_u32 v67, s68, v67
    v_accvgpr_write_b32 a240, v67
    v_add_u32 v67, 0, v64
    v_mul_u32_u24 v68, 171, v67
    v_lshrrev_b32 v68, 10, v68
    v_mul_u32_u24 v69, 6, v68
    v_sub_u32 v69, v67, v69
    v_mfma_f32_32x32x16_bf16 a[96:111], v[60:63], v[60:63], 0
    v_mul_u32_u24 v68, 1152, v68
    v_lshl_add_u32 v68, v69, 4, v68
    v_subrev_u32 v68, 0, v68
    v_accvgpr_write_b32 a236, v68
    v_add_u32 v67, 64, v64
    v_mul_u32_u24 v68, 171, v67
    v_lshrrev_b32 v68, 10, v68
    v_mul_u32_u24 v69, 6, v68
    v_sub_u32 v69, v67, v69
    v_mul_u32_u24 v68, 1152, v68
    v_lshl_add_u32 v68, v69, 4, v68
    v_subrev_u32 v68, 1024, v68
    v_mfma_f32_32x32x16_bf16 v[240:255], v[60:63], v[60:63], 0
    v_accvgpr_write_b32 a237, v68
    v_add_u32 v67, 128, v64
    v_mul_u32_u24 v68, 171, v67
    v_lshrrev_b32 v68, 10, v68
    v_mul_u32_u24 v69, 6, v68
    v_sub_u32 v69, v67, v69
    v_mul_u32_u24 v68, 1152, v68
    v_lshl_add_u32 v68, v69, 4, v68
    v_subrev_u32 v68, 2048, v68
    v_accvgpr_write_b32 a238, v68
    s_mul_i32 s69, s65, 15
    s_lshl2_add_u32 s69, s64, s69
    v_mfma_f32_32x32x16_bf16 a[112:127], v[60:63], v[60:63], 0
    s_lshl_b32 s69, s69, 17
    v_add_u32 v24, s69, v0
    s_mov_b32 s80, 393216
    s_cmp_eq_u32 s64, 3
    s_cselect_b32 s69, 2130706432, s80
    v_add_u32 v25, 131072, v24
    v_add_u32 v26, 262144, v24
    v_add_u32 v27, s69, v24
    s_and_b32 s3, s2, 3
    s_lshl_b32 s3, s3, 5
    s_lshr_b32 s69, s2, 3
    s_add_u32 s3, s3, s69
    s_mul_i32 s24, s3, 36864
    s_mul_i32 s69, s64, 288
    s_add_u32 s24, s24, s69
    s_add_u32 s25, s24, 96
    s_add_u32 s26, s24, 192
    s_mul_i32 s3, s3, 6144
    s_mul_i32 s69, s64, 3
    s_lshr_b32 s80, s69, 1
    s_mul_i32 s80, s80, 786432
    s_add_u32 s27, s3, s80
    s_and_b32 s80, s69, 1
    s_mul_i32 s80, s80, 3072
    s_add_u32 s27, s27, s80
    s_add_u32 s69, s69, 1
    s_lshr_b32 s80, s69, 1
    s_mul_i32 s80, s80, 786432
    s_add_u32 s28, s3, s80
    s_and_b32 s80, s69, 1
    s_mul_i32 s80, s80, 3072
    s_add_u32 s28, s28, s80
    s_add_u32 s69, s69, 1
    s_lshr_b32 s80, s69, 1
    s_mul_i32 s80, s80, 786432
    s_add_u32 s29, s3, s80
    s_and_b32 s80, s69, 1
    s_mul_i32 s80, s80, 3072
    s_add_u32 s29, s29, s80
    s_mov_b32 m0, s90
    s_nop 0
    buffer_load_dwordx4 v32, s[44:47], s87 offen offset:0 lds
    buffer_load_dwordx4 v33, s[44:47], s87 offen offset:1024 lds
    buffer_load_dwordx4 v34, s[44:47], s87 offen offset:2048 lds
    buffer_load_dwordx4 v35, s[44:47], s87 offen offset:3072 lds
    s_mov_b32 m0, s91
    s_nop 0
    buffer_load_dwordx4 v36, s[48:51], s87 offen offset:0 lds
    buffer_load_dwordx4 v37, s[48:51], s87 offen offset:1024 lds
    buffer_load_dwordx4 v38, s[48:51], s87 offen offset:2048 lds
    buffer_load_dwordx4 v39, s[48:51], s87 offen offset:3072 lds
    s_add_u32 s87, s87, 128
    s_cmp_eq_u32 s87, 1152
    s_cselect_b32 s87, 0, s87
    s_xor_b32 s90, s90, 49152
    s_xor_b32 s91, s91, 98304
    s_add_u32 m0, s68, 114688
    s_nop 0
    buffer_load_dwordx4 v44, s[56:59], s89 offen offset:0 lds
    buffer_load_dwordx4 v45, s[56:59], s89 offen offset:1024 lds
    buffer_load_dwordx4 v46, s[56:59], s89 offen offset:2048 lds
    buffer_load_dwordx4 v47, s[56:59], s89 offen offset:3072 lds
    s_add_u32 s89, s89, 524288
    s_cmp_eq_u32 s89, 4718592
    s_cselect_b32 s89, 0, s89
    s_mov_b32 s30, 7
    s_mov_b32 s6, 0
    s_mov_b32 s7, 1024
    s_mov_b32 s10, 0
    s_mov_b32 s11, 131072
    s_waitcnt vmcnt(20)
    ds_read_b128 a[192:195], v48 offset:0
    ds_read_b128 a[196:199], v48 offset:2048
    ds_read_b128 a[200:203], v50 offset:0
    ds_read_b128 a[204:207], v50 offset:2048
    v_xor_b32 v48, 49152, v48
    v_xor_b32 v50, 98304, v50
    s_waitcnt vmcnt(16)
    s_barrier
    ds_read_b64_tr_b16 a[160:161], v52 offset:16384
    ds_read_b64_tr_b16 a[162:163], v52 offset:18432
    ds_read_b64_tr_b16 a[164:165], v53 offset:16384
    ds_read_b64_tr_b16 a[166:167], v53 offset:18432
    ds_read_b64_tr_b16 a[168:169], v54 offset:16384
    ds_read_b64_tr_b16 a[170:171], v54 offset:18432
    ds_read_b64_tr_b16 a[172:173], v55 offset:16384
    ds_read_b64_tr_b16 a[174:175], v55 offset:18432
    s_waitcnt lgkmcnt(4)
    s_cmp_eq_u32 s64, 3
    s_cbranch_scc1 L_qs
.p2align 6
L_q:
    v_mfma_f32_16x16x32_bf16 v[128:131], a[160:163], a[192:195], v[128:131]
    ds_read_b64_tr_b16 a[176:177], v56 offset:16384
    ds_read_b64_tr_b16 a[178:179], v56 offset:18432
    v_mfma_f32_16x16x32_bf16 v[160:163], a[160:163], a[196:199], v[160:163]
    ds_read_b128 a[208:211], v49 offset:0
    ds_read_b128 a[216:219], v51 offset:0
    v_mfma_f32_16x16x32_bf16 v[192:195], a[160:163], a[200:203], v[192:195]
    ds_read_b128 a[212:215], v49 offset:2048
    ds_read_b128 a[220:223], v51 offset:2048
    v_mfma_f32_16x16x32_bf16 v[224:227], a[160:163], a[204:207], v[224:227]
    v_mfma_f32_16x16x32_bf16 v[132:135], a[164:167], a[192:195], v[132:135]
    ds_read_b64_tr_b16 a[180:181], v57 offset:16384
    ds_read_b64_tr_b16 a[182:183], v57 offset:18432
    v_mfma_f32_16x16x32_bf16 v[164:167], a[164:167], a[196:199], v[164:167]
    v_xor_b32 v49, 49152, v49
    v_xor_b32 v51, 98304, v51
    v_mfma_f32_16x16x32_bf16 v[196:199], a[164:167], a[200:203], v[196:199]
    v_mfma_f32_16x16x32_bf16 v[228:231], a[164:167], a[204:207], v[228:231]
    s_waitcnt lgkmcnt(8)
    v_mfma_f32_16x16x32_bf16 v[136:139], a[168:171], a[192:195], v[136:139]
    ds_read_b64_tr_b16 a[184:185], v58 offset:16384
    ds_read_b64_tr_b16 a[186:187], v58 offset:18432
    v_mfma_f32_16x16x32_bf16 v[168:171], a[168:171], a[196:199], v[168:171]
    v_mfma_f32_16x16x32_bf16 v[200:203], a[168:171], a[200:203], v[200:203]
    v_mfma_f32_16x16x32_bf16 v[232:235], a[168:171], a[204:207], v[232:235]
    v_mfma_f32_16x16x32_bf16 v[140:143], a[172:175], a[192:195], v[140:143]
    ds_read_b64_tr_b16 a[188:189], v59 offset:16384
    ds_read_b64_tr_b16 a[190:191], v59 offset:18432
    v_mfma_f32_16x16x32_bf16 v[172:175], a[172:175], a[196:199], v[172:175]
    v_mfma_f32_16x16x32_bf16 v[204:207], a[172:175], a[200:203], v[204:207]
    v_mfma_f32_16x16x32_bf16 v[236:239], a[172:175], a[204:207], v[236:239]
    s_waitcnt lgkmcnt(4)
    v_mfma_f32_16x16x32_bf16 v[144:147], a[176:179], a[192:195], v[144:147]
    ds_read_b64_tr_b16 a[160:161], v52 offset:16640
    ds_read_b64_tr_b16 a[162:163], v52 offset:18688
    v_mfma_f32_16x16x32_bf16 v[176:179], a[176:179], a[196:199], v[176:179]
    s_mov_b32 m0, s90
    v_mfma_f32_16x16x32_bf16 v[208:211], a[176:179], a[200:203], v[208:211]
    buffer_load_dwordx4 v32, s[44:47], s87 offen offset:0 lds
    v_mfma_f32_16x16x32_bf16 v[240:243], a[176:179], a[204:207], v[240:243]
    v_mfma_f32_16x16x32_bf16 v[148:151], a[180:183], a[192:195], v[148:151]
    ds_read_b64_tr_b16 a[164:165], v53 offset:16640
    ds_read_b64_tr_b16 a[166:167], v53 offset:18688
    v_mfma_f32_16x16x32_bf16 v[180:183], a[180:183], a[196:199], v[180:183]
    v_mfma_f32_16x16x32_bf16 v[212:215], a[180:183], a[200:203], v[212:215]
    buffer_load_dwordx4 v33, s[44:47], s87 offen offset:1024 lds
    v_mfma_f32_16x16x32_bf16 v[244:247], a[180:183], a[204:207], v[244:247]
    s_waitcnt lgkmcnt(4)
    v_mfma_f32_16x16x32_bf16 v[152:155], a[184:187], a[192:195], v[152:155]
    ds_read_b64_tr_b16 a[168:169], v54 offset:16640
    ds_read_b64_tr_b16 a[170:171], v54 offset:18688
    v_mfma_f32_16x16x32_bf16 v[184:187], a[184:187], a[196:199], v[184:187]
    v_mfma_f32_16x16x32_bf16 v[216:219], a[184:187], a[200:203], v[216:219]
    buffer_load_dwordx4 v34, s[44:47], s87 offen offset:2048 lds
    v_mfma_f32_16x16x32_bf16 v[248:251], a[184:187], a[204:207], v[248:251]
    v_mfma_f32_16x16x32_bf16 v[156:159], a[188:191], a[192:195], v[156:159]
    ds_read_b64_tr_b16 a[172:173], v55 offset:16640
    ds_read_b64_tr_b16 a[174:175], v55 offset:18688
    v_mfma_f32_16x16x32_bf16 v[188:191], a[188:191], a[196:199], v[188:191]
    v_mfma_f32_16x16x32_bf16 v[220:223], a[188:191], a[200:203], v[220:223]
    buffer_load_dwordx4 v35, s[44:47], s87 offen offset:3072 lds
    v_mfma_f32_16x16x32_bf16 v[252:255], a[188:191], a[204:207], v[252:255]
    s_waitcnt lgkmcnt(4)
    v_mfma_f32_16x16x32_bf16 a[0:3], a[160:163], a[192:195], a[0:3]
    ds_read_b64_tr_b16 a[176:177], v56 offset:16640
    ds_read_b64_tr_b16 a[178:179], v56 offset:18688
    v_mfma_f32_16x16x32_bf16 a[32:35], a[160:163], a[196:199], a[32:35]
    s_xor_b32 s90, s90, 49152
    v_mfma_f32_16x16x32_bf16 a[64:67], a[160:163], a[200:203], a[64:67]
    s_or_b32 s8, s31, s10
    s_lshr_b32 s9, s6, 4
    v_mfma_f32_16x16x32_bf16 a[96:99], a[160:163], a[204:207], a[96:99]
    s_cmp_lt_u32 s93, 3
    s_cselect_b32 s8, 2130706432, s8
    v_mfma_f32_16x16x32_bf16 a[4:7], a[164:167], a[192:195], a[4:7]
    ds_read_b64_tr_b16 a[180:181], v57 offset:16640
    ds_read_b64_tr_b16 a[182:183], v57 offset:18688
    v_mfma_f32_16x16x32_bf16 a[36:39], a[164:167], a[196:199], a[36:39]
    v_xor_b32 v64, s9, v13
    v_mfma_f32_16x16x32_bf16 a[68:71], a[164:167], a[200:203], a[68:71]
    v_mfma_f32_16x16x32_bf16 a[100:103], a[164:167], a[204:207], a[100:103]
    s_waitcnt lgkmcnt(4)
    v_mfma_f32_16x16x32_bf16 a[8:11], a[168:171], a[192:195], a[8:11]
    ds_read_b64_tr_b16 a[184:185], v58 offset:16640
    ds_read_b64_tr_b16 a[186:187], v58 offset:18688
    v_mfma_f32_16x16x32_bf16 a[40:43], a[168:171], a[196:199], a[40:43]
    v_mfma_f32_16x16x32_bf16 a[72:75], a[168:171], a[200:203], a[72:75]
    v_mfma_f32_16x16x32_bf16 a[104:107], a[168:171], a[204:207], a[104:107]
    v_mfma_f32_16x16x32_bf16 a[12:15], a[172:175], a[192:195], a[12:15]
    ds_read_b64_tr_b16 a[188:189], v59 offset:16640
    ds_read_b64_tr_b16 a[190:191], v59 offset:18688
    v_mfma_f32_16x16x32_bf16 a[44:47], a[172:175], a[196:199], a[44:47]
    v_mfma_f32_16x16x32_bf16 a[76:79], a[172:175], a[200:203], a[76:79]
    s_waitcnt vmcnt(14)
    s_barrier
    v_mfma_f32_16x16x32_bf16 a[108:111], a[172:175], a[204:207], a[108:111]
    s_waitcnt lgkmcnt(4)
    v_mfma_f32_16x16x32_bf16 a[16:19], a[176:179], a[192:195], a[16:19]
    ds_read_b64_tr_b16 a[160:161], v52 offset:0
    ds_read_b64_tr_b16 a[162:163], v52 offset:2048
    v_mfma_f32_16x16x32_bf16 a[48:51], a[176:179], a[196:199], a[48:51]
    s_xor_b32 m0, s92, 229376
    v_mfma_f32_16x16x32_bf16 a[80:83], a[176:179], a[200:203], a[80:83]
    buffer_load_dwordx4 v40, s[52:55], s88 offen offset:0 lds
    v_mfma_f32_16x16x32_bf16 a[112:115], a[176:179], a[204:207], a[112:115]
    v_mfma_f32_16x16x32_bf16 a[20:23], a[180:183], a[192:195], a[20:23]
    ds_read_b64_tr_b16 a[164:165], v53 offset:0
    ds_read_b64_tr_b16 a[166:167], v53 offset:2048
    v_mfma_f32_16x16x32_bf16 a[52:55], a[180:183], a[196:199], a[52:55]
    buffer_load_dwordx4 v41, s[52:55], s88 offen offset:1024 lds
    v_mfma_f32_16x16x32_bf16 a[84:87], a[180:183], a[200:203], a[84:87]
    v_mfma_f32_16x16x32_bf16 a[116:119], a[180:183], a[204:207], a[116:119]
    s_waitcnt lgkmcnt(4)
    v_mfma_f32_16x16x32_bf16 a[24:27], a[184:187], a[192:195], a[24:27]
    ds_read_b64_tr_b16 a[168:169], v54 offset:0
    ds_read_b64_tr_b16 a[170:171], v54 offset:2048
    v_mfma_f32_16x16x32_bf16 a[56:59], a[184:187], a[196:199], a[56:59]
    buffer_load_dwordx4 v42, s[52:55], s88 offen offset:2048 lds
    v_mfma_f32_16x16x32_bf16 a[88:91], a[184:187], a[200:203], a[88:91]
    v_mfma_f32_16x16x32_bf16 a[120:123], a[184:187], a[204:207], a[120:123]
    v_mfma_f32_16x16x32_bf16 a[28:31], a[188:191], a[192:195], a[28:31]
    ds_read_b64_tr_b16 a[172:173], v55 offset:0
    ds_read_b64_tr_b16 a[174:175], v55 offset:2048
    v_mfma_f32_16x16x32_bf16 a[60:63], a[188:191], a[196:199], a[60:63]
    buffer_load_dwordx4 v43, s[52:55], s88 offen offset:3072 lds
    v_mfma_f32_16x16x32_bf16 a[92:95], a[188:191], a[200:203], a[92:95]
    s_add_u32 s88, s88, 524288
    s_cmp_eq_u32 s88, 4980736
    s_cselect_b32 s88, 262144, s88
    s_or_b32 m0, s68, s6
    v_mfma_f32_16x16x32_bf16 a[124:127], a[188:191], a[204:207], a[124:127]
    buffer_load_dwordx4 v64, s[32:35], s8 offen offset:0 nt lds
    s_waitcnt lgkmcnt(4)
    v_mfma_f32_16x16x32_bf16 v[128:131], a[160:163], a[208:211], v[128:131]
    ds_read_b64_tr_b16 a[176:177], v56 offset:0
    ds_read_b64_tr_b16 a[178:179], v56 offset:2048
    v_mfma_f32_16x16x32_bf16 v[160:163], a[160:163], a[212:215], v[160:163]
    s_mov_b32 m0, s91
    v_mfma_f32_16x16x32_bf16 v[192:195], a[160:163], a[216:219], v[192:195]
    buffer_load_dwordx4 v36, s[48:51], s87 offen offset:0 lds
    v_mfma_f32_16x16x32_bf16 v[224:227], a[160:163], a[220:223], v[224:227]
    v_mfma_f32_16x16x32_bf16 v[132:135], a[164:167], a[208:211], v[132:135]
    ds_read_b64_tr_b16 a[180:181], v57 offset:0
    ds_read_b64_tr_b16 a[182:183], v57 offset:2048
    v_mfma_f32_16x16x32_bf16 v[164:167], a[164:167], a[212:215], v[164:167]
    v_mfma_f32_16x16x32_bf16 v[196:199], a[164:167], a[216:219], v[196:199]
    buffer_load_dwordx4 v37, s[48:51], s87 offen offset:1024 lds
    v_mfma_f32_16x16x32_bf16 v[228:231], a[164:167], a[220:223], v[228:231]
    s_waitcnt lgkmcnt(4)
    v_mfma_f32_16x16x32_bf16 v[136:139], a[168:171], a[208:211], v[136:139]
    ds_read_b64_tr_b16 a[184:185], v58 offset:0
    ds_read_b64_tr_b16 a[186:187], v58 offset:2048
    v_mfma_f32_16x16x32_bf16 v[168:171], a[168:171], a[212:215], v[168:171]
    v_mfma_f32_16x16x32_bf16 v[200:203], a[168:171], a[216:219], v[200:203]
    buffer_load_dwordx4 v38, s[48:51], s87 offen offset:2048 lds
    v_mfma_f32_16x16x32_bf16 v[232:235], a[168:171], a[220:223], v[232:235]
    v_mfma_f32_16x16x32_bf16 v[140:143], a[172:175], a[208:211], v[140:143]
    ds_read_b64_tr_b16 a[188:189], v59 offset:0
    ds_read_b64_tr_b16 a[190:191], v59 offset:2048
    v_mfma_f32_16x16x32_bf16 v[172:175], a[172:175], a[212:215], v[172:175]
    v_mfma_f32_16x16x32_bf16 v[204:207], a[172:175], a[216:219], v[204:207]
    buffer_load_dwordx4 v39, s[48:51], s87 offen offset:3072 lds
    v_mfma_f32_16x16x32_bf16 v[236:239], a[172:175], a[220:223], v[236:239]
    s_waitcnt lgkmcnt(4)
    v_mfma_f32_16x16x32_bf16 v[144:147], a[176:179], a[208:211], v[144:147]
    ds_read_b64_tr_b16 a[160:161], v52 offset:256
    ds_read_b64_tr_b16 a[162:163], v52 offset:2304
    v_mfma_f32_16x16x32_bf16 v[176:179], a[176:179], a[212:215], v[176:179]
    s_xor_b32 s91, s91, 98304
    v_mfma_f32_16x16x32_bf16 v[208:211], a[176:179], a[216:219], v[208:211]
    s_add_u32 s87, s87, 128
    s_cmp_eq_u32 s87, 1152
    s_cselect_b32 s87, 0, s87
    v_mfma_f32_16x16x32_bf16 v[240:243], a[176:179], a[220:223], v[240:243]
    v_xor_b32 v52, 229376, v52
    v_mfma_f32_16x16x32_bf16 v[148:151], a[180:183], a[208:211], v[148:151]
    ds_read_b64_tr_b16 a[164:165], v53 offset:256
    ds_read_b64_tr_b16 a[166:167], v53 offset:2304
    v_mfma_f32_16x16x32_bf16 v[180:183], a[180:183], a[212:215], v[180:183]
    v_xor_b32 v53, 229376, v53
    v_mfma_f32_16x16x32_bf16 v[212:215], a[180:183], a[216:219], v[212:215]
    v_mfma_f32_16x16x32_bf16 v[244:247], a[180:183], a[220:223], v[244:247]
    s_waitcnt lgkmcnt(4)
    v_mfma_f32_16x16x32_bf16 v[152:155], a[184:187], a[208:211], v[152:155]
    ds_read_b64_tr_b16 a[168:169], v54 offset:256
    ds_read_b64_tr_b16 a[170:171], v54 offset:2304
    v_mfma_f32_16x16x32_bf16 v[184:187], a[184:187], a[212:215], v[184:187]
    v_xor_b32 v54, 229376, v54
    v_mfma_f32_16x16x32_bf16 v[216:219], a[184:187], a[216:219], v[216:219]
    v_mfma_f32_16x16x32_bf16 v[248:251], a[184:187], a[220:223], v[248:251]
    v_mfma_f32_16x16x32_bf16 v[156:159], a[188:191], a[208:211], v[156:159]
    ds_read_b64_tr_b16 a[172:173], v55 offset:256
    ds_read_b64_tr_b16 a[174:175], v55 offset:2304
    v_mfma_f32_16x16x32_bf16 v[188:191], a[188:191], a[212:215], v[188:191]
    v_xor_b32 v55, 229376, v55
    v_mfma_f32_16x16x32_bf16 v[220:223], a[188:191], a[216:219], v[220:223]
    v_mfma_f32_16x16x32_bf16 v[252:255], a[188:191], a[220:223], v[252:255]
    s_waitcnt lgkmcnt(4)
    v_mfma_f32_16x16x32_bf16 a[0:3], a[160:163], a[208:211], a[0:3]
    ds_read_b64_tr_b16 a[176:177], v56 offset:256
    ds_read_b64_tr_b16 a[178:179], v56 offset:2304
    v_mfma_f32_16x16x32_bf16 a[32:35], a[160:163], a[212:215], a[32:35]
    v_xor_b32 v56, 229376, v56
    v_mfma_f32_16x16x32_bf16 a[64:67], a[160:163], a[216:219], a[64:67]
    s_lshr_b32 s9, s6, 3
    s_and_b32 s9, s9, 128
    v_mfma_f32_16x16x32_bf16 a[96:99], a[160:163], a[220:223], a[96:99]
    v_xor_b32 v64, s9, v17
    v_mfma_f32_16x16x32_bf16 a[4:7], a[164:167], a[208:211], a[4:7]
    ds_read_b64_tr_b16 a[180:181], v57 offset:256
    ds_read_b64_tr_b16 a[182:183], v57 offset:2304
    v_mfma_f32_16x16x32_bf16 a[36:39], a[164:167], a[212:215], a[36:39]
    v_xor_b32 v57, 229376, v57
    s_waitcnt vmcnt(17)
    v_mfma_f32_16x16x32_bf16 a[68:71], a[164:167], a[216:219], a[68:71]
    ds_read_b128 a[192:195], v48 offset:0
    ds_read_b128 a[200:203], v50 offset:0
    v_mfma_f32_16x16x32_bf16 a[100:103], a[164:167], a[220:223], a[100:103]
    s_waitcnt lgkmcnt(6)
    v_mfma_f32_16x16x32_bf16 a[8:11], a[168:171], a[208:211], a[8:11]
    ds_read_b64_tr_b16 a[184:185], v58 offset:256
    ds_read_b64_tr_b16 a[186:187], v58 offset:2304
    v_mfma_f32_16x16x32_bf16 a[40:43], a[168:171], a[212:215], a[40:43]
    ds_read_b128 a[196:199], v48 offset:2048
    ds_read_b128 a[204:207], v50 offset:2048
    v_mfma_f32_16x16x32_bf16 a[72:75], a[168:171], a[216:219], a[72:75]
    v_xor_b32 v48, 49152, v48
    v_xor_b32 v50, 98304, v50
    v_mfma_f32_16x16x32_bf16 a[104:107], a[168:171], a[220:223], a[104:107]
    v_xor_b32 v58, 229376, v58
    v_mfma_f32_16x16x32_bf16 a[12:15], a[172:175], a[208:211], a[12:15]
    ds_read_b64_tr_b16 a[188:189], v59 offset:256
    ds_read_b64_tr_b16 a[190:191], v59 offset:2304
    v_mfma_f32_16x16x32_bf16 a[44:47], a[172:175], a[212:215], a[44:47]
    v_xor_b32 v59, 229376, v59
    v_mfma_f32_16x16x32_bf16 a[76:79], a[172:175], a[216:219], a[76:79]
    s_waitcnt vmcnt(13)
    s_barrier
    v_mfma_f32_16x16x32_bf16 a[108:111], a[172:175], a[220:223], a[108:111]
    s_waitcnt lgkmcnt(8)
    v_mfma_f32_16x16x32_bf16 a[16:19], a[176:179], a[208:211], a[16:19]
    ds_read_b64_tr_b16 a[160:161], v52 offset:16384
    ds_read_b64_tr_b16 a[162:163], v52 offset:18432
    v_mfma_f32_16x16x32_bf16 a[48:51], a[176:179], a[212:215], a[48:51]
    s_add_u32 m0, s92, 16384
    v_mfma_f32_16x16x32_bf16 a[80:83], a[176:179], a[216:219], a[80:83]
    buffer_load_dwordx4 v44, s[56:59], s89 offen offset:0 lds
    v_mfma_f32_16x16x32_bf16 a[112:115], a[176:179], a[220:223], a[112:115]
    s_xor_b32 s92, s92, 229376
    v_mfma_f32_16x16x32_bf16 a[20:23], a[180:183], a[208:211], a[20:23]
    ds_read_b64_tr_b16 a[164:165], v53 offset:16384
    ds_read_b64_tr_b16 a[166:167], v53 offset:18432
    v_mfma_f32_16x16x32_bf16 a[52:55], a[180:183], a[212:215], a[52:55]
    buffer_load_dwordx4 v45, s[56:59], s89 offen offset:1024 lds
    v_mfma_f32_16x16x32_bf16 a[84:87], a[180:183], a[216:219], a[84:87]
    v_mfma_f32_16x16x32_bf16 a[116:119], a[180:183], a[220:223], a[116:119]
    s_or_b32 s9, s6, 65536
    s_xor_b32 s6, s6, s7
    s_waitcnt lgkmcnt(4)
    v_mfma_f32_16x16x32_bf16 a[24:27], a[184:187], a[208:211], a[24:27]
    ds_read_b64_tr_b16 a[168:169], v54 offset:16384
    ds_read_b64_tr_b16 a[170:171], v54 offset:18432
    v_mfma_f32_16x16x32_bf16 a[56:59], a[184:187], a[212:215], a[56:59]
    buffer_load_dwordx4 v46, s[56:59], s89 offen offset:2048 lds
    v_mfma_f32_16x16x32_bf16 a[88:91], a[184:187], a[216:219], a[88:91]
    s_xor_b32 s10, s10, s11
    s_xor_b32 s11, s11, 133120
    v_mfma_f32_16x16x32_bf16 a[120:123], a[184:187], a[220:223], a[120:123]
    s_xor_b32 s7, s7, 3072
    v_mfma_f32_16x16x32_bf16 a[28:31], a[188:191], a[208:211], a[28:31]
    ds_read_b64_tr_b16 a[172:173], v55 offset:16384
    ds_read_b64_tr_b16 a[174:175], v55 offset:18432
    v_mfma_f32_16x16x32_bf16 a[60:63], a[188:191], a[212:215], a[60:63]
    buffer_load_dwordx4 v47, s[56:59], s89 offen offset:3072 lds
    v_mfma_f32_16x16x32_bf16 a[92:95], a[188:191], a[216:219], a[92:95]
    s_add_u32 s89, s89, 524288
    s_cmp_eq_u32 s89, 4718592
    s_cselect_b32 s89, 0, s89
    s_or_b32 m0, s68, s9
    v_mfma_f32_16x16x32_bf16 a[124:127], a[188:191], a[220:223], a[124:127]
    buffer_load_dwordx4 v64, s[36:39], s8 offen offset:0 nt lds
    s_waitcnt lgkmcnt(4)
    s_add_u32 s93, s93, 1
    s_cmp_lg_u32 s93, s30
    s_cbranch_scc1 L_q
L_qtail:
    v_mfma_f32_16x16x32_bf16 v[128:131], a[160:163], a[192:195], v[128:131]
    ds_read_b64_tr_b16 a[176:177], v56 offset:16384
    ds_read_b64_tr_b16 a[178:179], v56 offset:18432
    v_mfma_f32_16x16x32_bf16 v[160:163], a[160:163], a[196:199], v[160:163]
    ds_read_b128 a[208:211], v49 offset:0
    ds_read_b128 a[216:219], v51 offset:0
    v_mfma_f32_16x16x32_bf16 v[192:195], a[160:163], a[200:203], v[192:195]
    ds_read_b128 a[212:215], v49 offset:2048
    ds_read_b128 a[220:223], v51 offset:2048
    v_mfma_f32_16x16x32_bf16 v[224:227], a[160:163], a[204:207], v[224:227]
    v_mfma_f32_16x16x32_bf16 v[132:135], a[164:167], a[192:195], v[132:135]
    ds_read_b64_tr_b16 a[180:181], v57 offset:16384
    ds_read_b64_tr_b16 a[182:183], v57 offset:18432
    v_mfma_f32_16x16x32_bf16 v[164:167], a[164:167], a[196:199], v[164:167]
    v_xor_b32 v49, 49152, v49
    v_xor_b32 v51, 98304, v51
    v_mfma_f32_16x16x32_bf16 v[196:199], a[164:167], a[200:203], v[196:199]
    v_mfma_f32_16x16x32_bf16 v[228:231], a[164:167], a[204:207], v[228:231]
    s_waitcnt lgkmcnt(8)
    v_mfma_f32_16x16x32_bf16 v[136:139], a[168:171], a[192:195], v[136:139]
    ds_read_b64_tr_b16 a[184:185], v58 offset:16384
    ds_read_b64_tr_b16 a[186:187], v58 offset:18432
    v_mfma_f32_16x16x32_bf16 v[168:171], a[168:171], a[196:199], v[168:171]
    v_mfma_f32_16x16x32_bf16 v[200:203], a[168:171], a[200:203], v[200:203]
    v_mfma_f32_16x16x32_bf16 v[232:235], a[168:171], a[204:207], v[232:235]
    v_mfma_f32_16x16x32_bf16 v[140:143], a[172:175], a[192:195], v[140:143]
    ds_read_b64_tr_b16 a[188:189], v59 offset:16384
    ds_read_b64_tr_b16 a[190:191], v59 offset:18432
    v_mfma_f32_16x16x32_bf16 v[172:175], a[172:175], a[196:199], v[172:175]
    v_mfma_f32_16x16x32_bf16 v[204:207], a[172:175], a[200:203], v[204:207]
    v_mfma_f32_16x16x32_bf16 v[236:239], a[172:175], a[204:207], v[236:239]
    s_waitcnt lgkmcnt(4)
    v_mfma_f32_16x16x32_bf16 v[144:147], a[176:179], a[192:195], v[144:147]
    ds_read_b64_tr_b16 a[160:161], v52 offset:16640
    ds_read_b64_tr_b16 a[162:163], v52 offset:18688
    v_mfma_f32_16x16x32_bf16 v[176:179], a[176:179], a[196:199], v[176:179]
    s_xor_b32 s12, 1024, s31
    s_add_u32 m0, s68, 16384
    v_mfma_f32_16x16x32_bf16 v[208:211], a[176:179], a[200:203], v[208:211]
    buffer_load_dwordx4 v13, s[32:35], s12 offen offset:0 nt lds
    v_mfma_f32_16x16x32_bf16 v[240:243], a[176:179], a[204:207], v[240:243]
    v_mfma_f32_16x16x32_bf16 v[148:151], a[180:183], a[192:195], v[148:151]
    ds_read_b64_tr_b16 a[164:165], v53 offset:16640
    ds_read_b64_tr_b16 a[166:167], v53 offset:18688
    v_mfma_f32_16x16x32_bf16 v[180:183], a[180:183], a[196:199], v[180:183]
    v_mfma_f32_16x16x32_bf16 v[212:215], a[180:183], a[200:203], v[212:215]
    buffer_load_dwordx4 v14, s[32:35], s12 offen offset:1024 nt lds
    v_mfma_f32_16x16x32_bf16 v[244:247], a[180:183], a[204:207], v[244:247]
    s_waitcnt lgkmcnt(4)
    v_mfma_f32_16x16x32_bf16 v[152:155], a[184:187], a[192:195], v[152:155]
    ds_read_b64_tr_b16 a[168:169], v54 offset:16640
    ds_read_b64_tr_b16 a[170:171], v54 offset:18688
    v_mfma_f32_16x16x32_bf16 v[184:187], a[184:187], a[196:199], v[184:187]
    v_mfma_f32_16x16x32_bf16 v[216:219], a[184:187], a[200:203], v[216:219]
    buffer_load_dwordx4 v15, s[32:35], s12 offen offset:2048 nt lds
    v_mfma_f32_16x16x32_bf16 v[248:251], a[184:187], a[204:207], v[248:251]
    v_mfma_f32_16x16x32_bf16 v[156:159], a[188:191], a[192:195], v[156:159]
    ds_read_b64_tr_b16 a[172:173], v55 offset:16640
    ds_read_b64_tr_b16 a[174:175], v55 offset:18688
    v_mfma_f32_16x16x32_bf16 v[188:191], a[188:191], a[196:199], v[188:191]
    v_mfma_f32_16x16x32_bf16 v[220:223], a[188:191], a[200:203], v[220:223]
    buffer_load_dwordx4 v16, s[32:35], s12 offen offset:3072 nt lds
    v_mfma_f32_16x16x32_bf16 v[252:255], a[188:191], a[204:207], v[252:255]
    s_waitcnt lgkmcnt(4)
    v_mfma_f32_16x16x32_bf16 a[0:3], a[160:163], a[192:195], a[0:3]
    ds_read_b64_tr_b16 a[176:177], v56 offset:16640
    ds_read_b64_tr_b16 a[178:179], v56 offset:18688
    v_mfma_f32_16x16x32_bf16 a[32:35], a[160:163], a[196:199], a[32:35]
    v_mfma_f32_16x16x32_bf16 a[64:67], a[160:163], a[200:203], a[64:67]
    v_mfma_f32_16x16x32_bf16 a[96:99], a[160:163], a[204:207], a[96:99]
    v_mfma_f32_16x16x32_bf16 a[4:7], a[164:167], a[192:195], a[4:7]
    ds_read_b64_tr_b16 a[180:181], v57 offset:16640
    ds_read_b64_tr_b16 a[182:183], v57 offset:18688
    v_mfma_f32_16x16x32_bf16 a[36:39], a[164:167], a[196:199], a[36:39]
    v_mfma_f32_16x16x32_bf16 a[68:71], a[164:167], a[200:203], a[68:71]
    v_mfma_f32_16x16x32_bf16 a[100:103], a[164:167], a[204:207], a[100:103]
    s_waitcnt lgkmcnt(4)
    v_mfma_f32_16x16x32_bf16 a[8:11], a[168:171], a[192:195], a[8:11]
    ds_read_b64_tr_b16 a[184:185], v58 offset:16640
    ds_read_b64_tr_b16 a[186:187], v58 offset:18688
    v_mfma_f32_16x16x32_bf16 a[40:43], a[168:171], a[196:199], a[40:43]
    v_mfma_f32_16x16x32_bf16 a[72:75], a[168:171], a[200:203], a[72:75]
    v_mfma_f32_16x16x32_bf16 a[104:107], a[168:171], a[204:207], a[104:107]
    v_mfma_f32_16x16x32_bf16 a[12:15], a[172:175], a[192:195], a[12:15]
    ds_read_b64_tr_b16 a[188:189], v59 offset:16640
    ds_read_b64_tr_b16 a[190:191], v59 offset:18688
    v_mfma_f32_16x16x32_bf16 a[44:47], a[172:175], a[196:199], a[44:47]
    v_mfma_f32_16x16x32_bf16 a[76:79], a[172:175], a[200:203], a[76:79]
    s_waitcnt vmcnt(14)
    s_barrier
    v_mfma_f32_16x16x32_bf16 a[108:111], a[172:175], a[204:207], a[108:111]
    s_waitcnt lgkmcnt(4)
    v_mfma_f32_16x16x32_bf16 a[16:19], a[176:179], a[192:195], a[16:19]
    ds_read_b64_tr_b16 a[160:161], v52 offset:0
    ds_read_b64_tr_b16 a[162:163], v52 offset:2048
    v_mfma_f32_16x16x32_bf16 a[48:51], a[176:179], a[196:199], a[48:51]
    s_xor_b32 m0, s92, 229376
    v_mfma_f32_16x16x32_bf16 a[80:83], a[176:179], a[200:203], a[80:83]
    buffer_load_dwordx4 v40, s[52:55], s88 offen offset:0 lds
    v_mfma_f32_16x16x32_bf16 a[112:115], a[176:179], a[204:207], a[112:115]
    v_mfma_f32_16x16x32_bf16 a[20:23], a[180:183], a[192:195], a[20:23]
    ds_read_b64_tr_b16 a[164:165], v53 offset:0
    ds_read_b64_tr_b16 a[166:167], v53 offset:2048
    v_mfma_f32_16x16x32_bf16 a[52:55], a[180:183], a[196:199], a[52:55]
    buffer_load_dwordx4 v41, s[52:55], s88 offen offset:1024 lds
    v_mfma_f32_16x16x32_bf16 a[84:87], a[180:183], a[200:203], a[84:87]
    v_mfma_f32_16x16x32_bf16 a[116:119], a[180:183], a[204:207], a[116:119]
    s_waitcnt lgkmcnt(4)
    v_mfma_f32_16x16x32_bf16 a[24:27], a[184:187], a[192:195], a[24:27]
    ds_read_b64_tr_b16 a[168:169], v54 offset:0
    ds_read_b64_tr_b16 a[170:171], v54 offset:2048
    v_mfma_f32_16x16x32_bf16 a[56:59], a[184:187], a[196:199], a[56:59]
    buffer_load_dwordx4 v42, s[52:55], s88 offen offset:2048 lds
    v_mfma_f32_16x16x32_bf16 a[88:91], a[184:187], a[200:203], a[88:91]
    v_mfma_f32_16x16x32_bf16 a[120:123], a[184:187], a[204:207], a[120:123]
    v_mfma_f32_16x16x32_bf16 a[28:31], a[188:191], a[192:195], a[28:31]
    ds_read_b64_tr_b16 a[172:173], v55 offset:0
    ds_read_b64_tr_b16 a[174:175], v55 offset:2048
    v_mfma_f32_16x16x32_bf16 a[60:63], a[188:191], a[196:199], a[60:63]
    buffer_load_dwordx4 v43, s[52:55], s88 offen offset:3072 lds
    v_mfma_f32_16x16x32_bf16 a[92:95], a[188:191], a[200:203], a[92:95]
    s_add_u32 s88, s88, 524288
    s_cmp_eq_u32 s88, 4980736
    s_cselect_b32 s88, 262144, s88
    v_mfma_f32_16x16x32_bf16 a[124:127], a[188:191], a[204:207], a[124:127]
    s_waitcnt lgkmcnt(4)
    v_mfma_f32_16x16x32_bf16 v[128:131], a[160:163], a[208:211], v[128:131]
    ds_read_b64_tr_b16 a[176:177], v56 offset:0
    ds_read_b64_tr_b16 a[178:179], v56 offset:2048
    v_mfma_f32_16x16x32_bf16 v[160:163], a[160:163], a[212:215], v[160:163]
    s_xor_b32 s13, 1024, s31
    s_add_u32 m0, s68, 81920
    v_mfma_f32_16x16x32_bf16 v[192:195], a[160:163], a[216:219], v[192:195]
    buffer_load_dwordx4 v17, s[36:39], s13 offen offset:0 nt lds
    v_mfma_f32_16x16x32_bf16 v[224:227], a[160:163], a[220:223], v[224:227]
    v_mfma_f32_16x16x32_bf16 v[132:135], a[164:167], a[208:211], v[132:135]
    ds_read_b64_tr_b16 a[180:181], v57 offset:0
    ds_read_b64_tr_b16 a[182:183], v57 offset:2048
    v_mfma_f32_16x16x32_bf16 v[164:167], a[164:167], a[212:215], v[164:167]
    v_mfma_f32_16x16x32_bf16 v[196:199], a[164:167], a[216:219], v[196:199]
    buffer_load_dwordx4 v18, s[36:39], s13 offen offset:1024 nt lds
    v_mfma_f32_16x16x32_bf16 v[228:231], a[164:167], a[220:223], v[228:231]
    s_waitcnt lgkmcnt(4)
    v_mfma_f32_16x16x32_bf16 v[136:139], a[168:171], a[208:211], v[136:139]
    ds_read_b64_tr_b16 a[184:185], v58 offset:0
    ds_read_b64_tr_b16 a[186:187], v58 offset:2048
    v_mfma_f32_16x16x32_bf16 v[168:171], a[168:171], a[212:215], v[168:171]
    v_mfma_f32_16x16x32_bf16 v[200:203], a[168:171], a[216:219], v[200:203]
    buffer_load_dwordx4 v17, s[36:39], s13 offen offset:2048 nt lds
    v_mfma_f32_16x16x32_bf16 v[232:235], a[168:171], a[220:223], v[232:235]
    v_mfma_f32_16x16x32_bf16 v[140:143], a[172:175], a[208:211], v[140:143]
    ds_read_b64_tr_b16 a[188:189], v59 offset:0
    ds_read_b64_tr_b16 a[190:191], v59 offset:2048
    v_mfma_f32_16x16x32_bf16 v[172:175], a[172:175], a[212:215], v[172:175]
    v_mfma_f32_16x16x32_bf16 v[204:207], a[172:175], a[216:219], v[204:207]
    buffer_load_dwordx4 v18, s[36:39], s13 offen offset:3072 nt lds
    v_mfma_f32_16x16x32_bf16 v[236:239], a[172:175], a[220:223], v[236:239]
    s_waitcnt lgkmcnt(4)
    v_mfma_f32_16x16x32_bf16 v[144:147], a[176:179], a[208:211], v[144:147]
    ds_read_b64_tr_b16 a[160:161], v52 offset:256
    ds_read_b64_tr_b16 a[162:163], v52 offset:2304
    v_mfma_f32_16x16x32_bf16 v[176:179], a[176:179], a[212:215], v[176:179]
    v_mfma_f32_16x16x32_bf16 v[208:211], a[176:179], a[216:219], v[208:211]
    v_mfma_f32_16x16x32_bf16 v[240:243], a[176:179], a[220:223], v[240:243]
    v_xor_b32 v52, 229376, v52
    v_mfma_f32_16x16x32_bf16 v[148:151], a[180:183], a[208:211], v[148:151]
    ds_read_b64_tr_b16 a[164:165], v53 offset:256
    ds_read_b64_tr_b16 a[166:167], v53 offset:2304
    v_mfma_f32_16x16x32_bf16 v[180:183], a[180:183], a[212:215], v[180:183]
    v_xor_b32 v53, 229376, v53
    v_mfma_f32_16x16x32_bf16 v[212:215], a[180:183], a[216:219], v[212:215]
    v_mfma_f32_16x16x32_bf16 v[244:247], a[180:183], a[220:223], v[244:247]
    s_waitcnt lgkmcnt(4)
    v_mfma_f32_16x16x32_bf16 v[152:155], a[184:187], a[208:211], v[152:155]
    ds_read_b64_tr_b16 a[168:169], v54 offset:256
    ds_read_b64_tr_b16 a[170:171], v54 offset:2304
    v_mfma_f32_16x16x32_bf16 v[184:187], a[184:187], a[212:215], v[184:187]
    v_xor_b32 v54, 229376, v54
    v_mfma_f32_16x16x32_bf16 v[216:219], a[184:187], a[216:219], v[216:219]
    v_mfma_f32_16x16x32_bf16 v[248:251], a[184:187], a[220:223], v[248:251]
    v_mfma_f32_16x16x32_bf16 v[156:159], a[188:191], a[208:211], v[156:159]
    ds_read_b64_tr_b16 a[172:173], v55 offset:256
    ds_read_b64_tr_b16 a[174:175], v55 offset:2304
    v_mfma_f32_16x16x32_bf16 v[188:191], a[188:191], a[212:215], v[188:191]
    v_xor_b32 v55, 229376, v55
    v_mfma_f32_16x16x32_bf16 v[220:223], a[188:191], a[216:219], v[220:223]
    v_mfma_f32_16x16x32_bf16 v[252:255], a[188:191], a[220:223], v[252:255]
    s_waitcnt lgkmcnt(4)
    v_mfma_f32_16x16x32_bf16 a[0:3], a[160:163], a[208:211], a[0:3]
    ds_read_b64_tr_b16 a[176:177], v56 offset:256
    ds_read_b64_tr_b16 a[178:179], v56 offset:2304
    v_mfma_f32_16x16x32_bf16 a[32:35], a[160:163], a[212:215], a[32:35]
    v_xor_b32 v56, 229376, v56
    v_mfma_f32_16x16x32_bf16 a[64:67], a[160:163], a[216:219], a[64:67]
    v_mfma_f32_16x16x32_bf16 a[96:99], a[160:163], a[220:223], a[96:99]
    v_mfma_f32_16x16x32_bf16 a[4:7], a[164:167], a[208:211], a[4:7]
    ds_read_b64_tr_b16 a[180:181], v57 offset:256
    ds_read_b64_tr_b16 a[182:183], v57 offset:2304
    v_mfma_f32_16x16x32_bf16 a[36:39], a[164:167], a[212:215], a[36:39]
    v_xor_b32 v57, 229376, v57
    s_waitcnt vmcnt(17)
    v_mfma_f32_16x16x32_bf16 a[68:71], a[164:167], a[216:219], a[68:71]
    ds_read_b128 a[192:195], v48 offset:0
    ds_read_b128 a[200:203], v50 offset:0
    v_mfma_f32_16x16x32_bf16 a[100:103], a[164:167], a[220:223], a[100:103]
    s_waitcnt lgkmcnt(6)
    v_mfma_f32_16x16x32_bf16 a[8:11], a[168:171], a[208:211], a[8:11]
    ds_read_b64_tr_b16 a[184:185], v58 offset:256
    ds_read_b64_tr_b16 a[186:187], v58 offset:2304
    v_mfma_f32_16x16x32_bf16 a[40:43], a[168:171], a[212:215], a[40:43]
    ds_read_b128 a[196:199], v48 offset:2048
    ds_read_b128 a[204:207], v50 offset:2048
    v_mfma_f32_16x16x32_bf16 a[72:75], a[168:171], a[216:219], a[72:75]
    v_xor_b32 v48, 49152, v48
    v_xor_b32 v50, 98304, v50
    v_mfma_f32_16x16x32_bf16 a[104:107], a[168:171], a[220:223], a[104:107]
    v_xor_b32 v58, 229376, v58
    v_mfma_f32_16x16x32_bf16 a[12:15], a[172:175], a[208:211], a[12:15]
    ds_read_b64_tr_b16 a[188:189], v59 offset:256
    ds_read_b64_tr_b16 a[190:191], v59 offset:2304
    v_mfma_f32_16x16x32_bf16 a[44:47], a[172:175], a[212:215], a[44:47]
    v_xor_b32 v59, 229376, v59
    v_mfma_f32_16x16x32_bf16 a[76:79], a[172:175], a[216:219], a[76:79]
    s_waitcnt vmcnt(13)
    s_barrier
    v_mfma_f32_16x16x32_bf16 a[108:111], a[172:175], a[220:223], a[108:111]
    s_waitcnt lgkmcnt(8)
    v_mfma_f32_16x16x32_bf16 a[16:19], a[176:179], a[208:211], a[16:19]
    ds_read_b64_tr_b16 a[160:161], v52 offset:16384
    ds_read_b64_tr_b16 a[162:163], v52 offset:18432
    v_mfma_f32_16x16x32_bf16 a[48:51], a[176:179], a[212:215], a[48:51]
    v_mfma_f32_16x16x32_bf16 a[80:83], a[176:179], a[216:219], a[80:83]
    v_mfma_f32_16x16x32_bf16 a[112:115], a[176:179], a[220:223], a[112:115]
    v_mfma_f32_16x16x32_bf16 a[20:23], a[180:183], a[208:211], a[20:23]
    ds_read_b64_tr_b16 a[164:165], v53 offset:16384
    ds_read_b64_tr_b16 a[166:167], v53 offset:18432
    v_mfma_f32_16x16x32_bf16 a[52:55], a[180:183], a[212:215], a[52:55]
    v_mfma_f32_16x16x32_bf16 a[84:87], a[180:183], a[216:219], a[84:87]
    v_mfma_f32_16x16x32_bf16 a[116:119], a[180:183], a[220:223], a[116:119]
    s_waitcnt lgkmcnt(4)
    v_mfma_f32_16x16x32_bf16 a[24:27], a[184:187], a[208:211], a[24:27]
    ds_read_b64_tr_b16 a[168:169], v54 offset:16384
    ds_read_b64_tr_b16 a[170:171], v54 offset:18432
    v_mfma_f32_16x16x32_bf16 a[56:59], a[184:187], a[212:215], a[56:59]
    v_mfma_f32_16x16x32_bf16 a[88:91], a[184:187], a[216:219], a[88:91]
    v_mfma_f32_16x16x32_bf16 a[120:123], a[184:187], a[220:223], a[120:123]
    v_mfma_f32_16x16x32_bf16 a[28:31], a[188:191], a[208:211], a[28:31]
    ds_read_b64_tr_b16 a[172:173], v55 offset:16384
    ds_read_b64_tr_b16 a[174:175], v55 offset:18432
    v_mfma_f32_16x16x32_bf16 a[60:63], a[188:191], a[212:215], a[60:63]
    v_mfma_f32_16x16x32_bf16 a[92:95], a[188:191], a[216:219], a[92:95]
    v_mfma_f32_16x16x32_bf16 a[124:127], a[188:191], a[220:223], a[124:127]
    s_waitcnt lgkmcnt(4)
    v_mfma_f32_16x16x32_bf16 v[128:131], a[160:163], a[192:195], v[128:131]
    ds_read_b64_tr_b16 a[176:177], v56 offset:16384
    ds_read_b64_tr_b16 a[178:179], v56 offset:18432
    v_mfma_f32_16x16x32_bf16 v[160:163], a[160:163], a[196:199], v[160:163]
    ds_read_b128 a[208:211], v49 offset:0
    ds_read_b128 a[216:219], v51 offset:0
    v_mfma_f32_16x16x32_bf16 v[192:195], a[160:163], a[200:203], v[192:195]
    ds_read_b128 a[212:215], v49 offset:2048
    ds_read_b128 a[220:223], v51 offset:2048
    v_mfma_f32_16x16x32_bf16 v[224:227], a[160:163], a[204:207], v[224:227]
    v_mfma_f32_16x16x32_bf16 v[132:135], a[164:167], a[192:195], v[132:135]
    ds_read_b64_tr_b16 a[180:181], v57 offset:16384
    ds_read_b64_tr_b16 a[182:183], v57 offset:18432
    v_mfma_f32_16x16x32_bf16 v[164:167], a[164:167], a[196:199], v[164:167]
    v_accvgpr_write_b32 a224, 0
    v_mfma_f32_16x16x32_bf16 v[196:199], a[164:167], a[200:203], v[196:199]
    v_accvgpr_write_b32 a225, 0
    v_mfma_f32_16x16x32_bf16 v[228:231], a[164:167], a[204:207], v[228:231]
    v_accvgpr_write_b32 a226, 0
    s_waitcnt lgkmcnt(8)
    v_mfma_f32_16x16x32_bf16 v[136:139], a[168:171], a[192:195], v[136:139]
    ds_read_b64_tr_b16 a[184:185], v58 offset:16384
    ds_read_b64_tr_b16 a[186:187], v58 offset:18432
    v_mfma_f32_16x16x32_bf16 v[168:171], a[168:171], a[196:199], v[168:171]
    v_accvgpr_write_b32 a227, 0
    v_accvgpr_write_b32 a228, 0
    v_mfma_f32_16x16x32_bf16 v[200:203], a[168:171], a[200:203], v[200:203]
    v_accvgpr_write_b32 a229, 0
    v_mfma_f32_16x16x32_bf16 v[232:235], a[168:171], a[204:207], v[232:235]
    v_accvgpr_write_b32 a230, s97
    v_mfma_f32_16x16x32_bf16 v[140:143], a[172:175], a[192:195], v[140:143]
    ds_read_b64_tr_b16 a[188:189], v59 offset:16384
    ds_read_b64_tr_b16 a[190:191], v59 offset:18432
    v_mfma_f32_16x16x32_bf16 v[172:175], a[172:175], a[196:199], v[172:175]
    v_accvgpr_write_b32 a231, 0
    v_mfma_f32_16x16x32_bf16 v[204:207], a[172:175], a[200:203], v[204:207]
    s_waitcnt vmcnt(4)
    s_barrier
    v_mfma_f32_16x16x32_bf16 v[236:239], a[172:175], a[204:207], v[236:239]
    s_waitcnt lgkmcnt(4)
    v_mfma_f32_16x16x32_bf16 v[144:147], a[176:179], a[192:195], v[144:147]
    ds_read_b64_tr_b16 a[160:161], v52 offset:0
    ds_read_b64_tr_b16 a[162:163], v52 offset:2048
    v_mfma_f32_16x16x32_bf16 v[176:179], a[176:179], a[196:199], v[176:179]
    s_xor_b32 s12, s81, s31
    s_add_u32 m0, s68, 49152
    v_mfma_f32_16x16x32_bf16 v[208:211], a[176:179], a[200:203], v[208:211]
    buffer_load_dwordx4 v13, s[32:35], s12 offen offset:0 nt lds
    v_mfma_f32_16x16x32_bf16 v[240:243], a[176:179], a[204:207], v[240:243]
    v_mfma_f32_16x16x32_bf16 v[148:151], a[180:183], a[192:195], v[148:151]
    ds_read_b64_tr_b16 a[164:165], v53 offset:0
    ds_read_b64_tr_b16 a[166:167], v53 offset:2048
    v_mfma_f32_16x16x32_bf16 v[180:183], a[180:183], a[196:199], v[180:183]
    buffer_load_dwordx4 v14, s[32:35], s12 offen offset:1024 nt lds
    v_mfma_f32_16x16x32_bf16 v[212:215], a[180:183], a[200:203], v[212:215]
    buffer_load_dwordx4 v15, s[32:35], s12 offen offset:2048 nt lds
    v_mfma_f32_16x16x32_bf16 v[244:247], a[180:183], a[204:207], v[244:247]
    s_waitcnt lgkmcnt(4)
    v_mfma_f32_16x16x32_bf16 v[152:155], a[184:187], a[192:195], v[152:155]
    ds_read_b64_tr_b16 a[168:169], v54 offset:0
    ds_read_b64_tr_b16 a[170:171], v54 offset:2048
    v_mfma_f32_16x16x32_bf16 v[184:187], a[184:187], a[196:199], v[184:187]
    buffer_load_dwordx4 v16, s[32:35], s12 offen offset:3072 nt lds
    v_mfma_f32_16x16x32_bf16 v[216:219], a[184:187], a[200:203], v[216:219]
    s_sub_u32 s81, s81, 4294734848
    s_and_b32 s81, s81, 4294734848
    v_mfma_f32_16x16x32_bf16 v[248:251], a[184:187], a[204:207], v[248:251]
    v_mfma_f32_16x16x32_bf16 v[156:159], a[188:191], a[192:195], v[156:159]
    ds_read_b64_tr_b16 a[172:173], v55 offset:0
    ds_read_b64_tr_b16 a[174:175], v55 offset:2048
    v_mfma_f32_16x16x32_bf16 v[188:191], a[188:191], a[196:199], v[188:191]
    v_mfma_f32_16x16x32_bf16 v[220:223], a[188:191], a[200:203], v[220:223]
    v_mfma_f32_16x16x32_bf16 v[252:255], a[188:191], a[204:207], v[252:255]
    s_waitcnt lgkmcnt(4)
    v_mfma_f32_16x16x32_bf16 v[128:131], a[160:163], a[208:211], v[128:131]
    ds_read_b64_tr_b16 a[176:177], v56 offset:0
    ds_read_b64_tr_b16 a[178:179], v56 offset:2048
    v_mfma_f32_16x16x32_bf16 v[160:163], a[160:163], a[212:215], v[160:163]
    v_mfma_f32_16x16x32_bf16 v[192:195], a[160:163], a[216:219], v[192:195]
    v_mfma_f32_16x16x32_bf16 v[224:227], a[160:163], a[220:223], v[224:227]
    v_mfma_f32_16x16x32_bf16 v[132:135], a[164:167], a[208:211], v[132:135]
    ds_read_b64_tr_b16 a[180:181], v57 offset:0
    ds_read_b64_tr_b16 a[182:183], v57 offset:2048
    v_mfma_f32_16x16x32_bf16 v[164:167], a[164:167], a[212:215], v[164:167]
    v_mfma_f32_16x16x32_bf16 v[196:199], a[164:167], a[216:219], v[196:199]
    v_mfma_f32_16x16x32_bf16 v[228:231], a[164:167], a[220:223], v[228:231]
    s_waitcnt lgkmcnt(4)
    v_mfma_f32_16x16x32_bf16 v[136:139], a[168:171], a[208:211], v[136:139]
    ds_read_b64_tr_b16 a[184:185], v58 offset:0
    ds_read_b64_tr_b16 a[186:187], v58 offset:2048
    v_mfma_f32_16x16x32_bf16 v[168:171], a[168:171], a[212:215], v[168:171]
    v_mul_f32 v128, s60, v128
    v_mul_f32 v129, s60, v129
    v_mfma_f32_16x16x32_bf16 v[200:203], a[168:171], a[216:219], v[200:203]
    v_mul_f32 v130, s60, v130
    v_mul_f32 v131, s60, v131
    v_mfma_f32_16x16x32_bf16 v[232:235], a[168:171], a[220:223], v[232:235]
    v_mul_f32 v132, s60, v132
    v_mul_f32 v133, s60, v133
    v_mfma_f32_16x16x32_bf16 v[140:143], a[172:175], a[208:211], v[140:143]
    ds_read_b64_tr_b16 a[188:189], v59 offset:0
    ds_read_b64_tr_b16 a[190:191], v59 offset:2048
    v_mfma_f32_16x16x32_bf16 v[172:175], a[172:175], a[212:215], v[172:175]
    v_mul_f32 v134, s60, v134
    v_mul_f32 v135, s60, v135
    v_mfma_f32_16x16x32_bf16 v[204:207], a[172:175], a[216:219], v[204:207]
    v_cvt_pk_bf16_f32 v64, v128, v129
    v_cvt_pk_bf16_f32 v65, v130, v131
    v_mfma_f32_16x16x32_bf16 v[236:239], a[172:175], a[220:223], v[236:239]
    v_cvt_pk_bf16_f32 v66, v132, v133
    s_waitcnt lgkmcnt(4)
    v_mfma_f32_16x16x32_bf16 v[144:147], a[176:179], a[208:211], v[144:147]
    ds_read_b64_tr_b16 a[160:161], v52 offset:16640
    ds_read_b64_tr_b16 a[162:163], v52 offset:18688
    v_mfma_f32_16x16x32_bf16 v[176:179], a[176:179], a[212:215], v[176:179]
    v_cvt_pk_bf16_f32 v67, v134, v135
    s_nop 0
    v_mfma_f32_16x16x32_bf16 v[208:211], a[176:179], a[216:219], v[208:211]
    s_xor_b32 s13, 4096, s31
    s_add_u32 m0, s68, 114688
    v_mfma_f32_16x16x32_bf16 v[240:243], a[176:179], a[220:223], v[240:243]
    buffer_load_dwordx4 v17, s[36:39], s13 offen offset:0 nt lds
    v_mfma_f32_16x16x32_bf16 v[148:151], a[180:183], a[208:211], v[148:151]
    ds_read_b64_tr_b16 a[164:165], v53 offset:16640
    ds_read_b64_tr_b16 a[166:167], v53 offset:18688
    v_mfma_f32_16x16x32_bf16 v[180:183], a[180:183], a[212:215], v[180:183]
    v_permlane16_swap_b32 v64, v66
    v_permlane16_swap_b32 v65, v67
    v_mfma_f32_16x16x32_bf16 v[212:215], a[180:183], a[216:219], v[212:215]
    buffer_load_dwordx4 v18, s[36:39], s13 offen offset:1024 nt lds
    v_mfma_f32_16x16x32_bf16 v[244:247], a[180:183], a[220:223], v[244:247]
    buffer_load_dwordx4 v17, s[36:39], s13 offen offset:2048 nt lds
    s_waitcnt lgkmcnt(4)
    v_mfma_f32_16x16x32_bf16 v[152:155], a[184:187], a[208:211], v[152:155]
    ds_read_b64_tr_b16 a[168:169], v54 offset:16640
    ds_read_b64_tr_b16 a[170:171], v54 offset:18688
    v_mfma_f32_16x16x32_bf16 v[184:187], a[184:187], a[212:215], v[184:187]
    v_mul_f32 v160, s60, v160
    v_mul_f32 v161, s60, v161
    v_mfma_f32_16x16x32_bf16 v[216:219], a[184:187], a[216:219], v[216:219]
    buffer_load_dwordx4 v18, s[36:39], s13 offen offset:3072 nt lds
    v_mfma_f32_16x16x32_bf16 v[248:251], a[184:187], a[220:223], v[248:251]
    v_mul_f32 v162, s60, v162
    v_mul_f32 v163, s60, v163
    v_mfma_f32_16x16x32_bf16 v[156:159], a[188:191], a[208:211], v[156:159]
    ds_read_b64_tr_b16 a[172:173], v55 offset:16640
    ds_read_b64_tr_b16 a[174:175], v55 offset:18688
    v_mfma_f32_16x16x32_bf16 v[188:191], a[188:191], a[212:215], v[188:191]
    v_mul_f32 v164, s60, v164
    v_mul_f32 v165, s60, v165
    v_mfma_f32_16x16x32_bf16 v[220:223], a[188:191], a[216:219], v[220:223]
    v_mul_f32 v166, s60, v166
    v_mul_f32 v167, s60, v167
    v_mfma_f32_16x16x32_bf16 v[252:255], a[188:191], a[220:223], v[252:255]
    v_cvt_pk_bf16_f32 v80, v160, v161
    s_waitcnt lgkmcnt(4)
    v_mfma_f32_16x16x32_bf16 a[0:3], a[160:163], a[192:195], a[0:3]
    ds_read_b64_tr_b16 a[176:177], v56 offset:16640
    ds_read_b64_tr_b16 a[178:179], v56 offset:18688
    v_mfma_f32_16x16x32_bf16 a[32:35], a[160:163], a[196:199], a[32:35]
    v_cvt_pk_bf16_f32 v81, v162, v163
    v_cvt_pk_bf16_f32 v82, v164, v165
    v_mfma_f32_16x16x32_bf16 a[64:67], a[160:163], a[200:203], a[64:67]
    v_cvt_pk_bf16_f32 v83, v166, v167
    s_nop 0
    v_mfma_f32_16x16x32_bf16 a[96:99], a[160:163], a[204:207], a[96:99]
    v_permlane16_swap_b32 v80, v82
    v_permlane16_swap_b32 v81, v83
    v_mfma_f32_16x16x32_bf16 a[4:7], a[164:167], a[192:195], a[4:7]
    ds_read_b64_tr_b16 a[180:181], v57 offset:16640
    ds_read_b64_tr_b16 a[182:183], v57 offset:18688
    v_mfma_f32_16x16x32_bf16 a[36:39], a[164:167], a[196:199], a[36:39]
    v_mul_f32 v192, s60, v192
    v_mul_f32 v193, s60, v193
    v_mfma_f32_16x16x32_bf16 a[68:71], a[164:167], a[200:203], a[68:71]
    v_mul_f32 v194, s60, v194
    v_mul_f32 v195, s60, v195
    v_mfma_f32_16x16x32_bf16 a[100:103], a[164:167], a[204:207], a[100:103]
    v_mul_f32 v196, s60, v196
    s_waitcnt lgkmcnt(4)
    v_mfma_f32_16x16x32_bf16 a[8:11], a[168:171], a[192:195], a[8:11]
    ds_read_b64_tr_b16 a[184:185], v58 offset:16640
    ds_read_b64_tr_b16 a[186:187], v58 offset:18688
    v_mfma_f32_16x16x32_bf16 a[40:43], a[168:171], a[196:199], a[40:43]
    v_mul_f32 v197, s60, v197
    v_mul_f32 v198, s60, v198
    v_mfma_f32_16x16x32_bf16 a[72:75], a[168:171], a[200:203], a[72:75]
    v_mul_f32 v199, s60, v199
    v_cvt_pk_bf16_f32 v96, v192, v193
    v_mfma_f32_16x16x32_bf16 a[104:107], a[168:171], a[204:207], a[104:107]
    v_cvt_pk_bf16_f32 v97, v194, v195
    v_cvt_pk_bf16_f32 v98, v196, v197
    v_mfma_f32_16x16x32_bf16 a[12:15], a[172:175], a[192:195], a[12:15]
    ds_read_b64_tr_b16 a[188:189], v59 offset:16640
    ds_read_b64_tr_b16 a[190:191], v59 offset:18688
    v_mfma_f32_16x16x32_bf16 a[44:47], a[172:175], a[196:199], a[44:47]
    v_cvt_pk_bf16_f32 v99, v198, v199
    s_nop 0
    v_mfma_f32_16x16x32_bf16 a[76:79], a[172:175], a[200:203], a[76:79]
    v_permlane16_swap_b32 v96, v98
    v_permlane16_swap_b32 v97, v99
    v_mfma_f32_16x16x32_bf16 a[108:111], a[172:175], a[204:207], a[108:111]
    v_mul_f32 v224, s60, v224
    s_waitcnt lgkmcnt(4)
    v_mfma_f32_16x16x32_bf16 a[16:19], a[176:179], a[192:195], a[16:19]
    ds_read_b64_tr_b16 a[160:161], v52 offset:256
    ds_read_b64_tr_b16 a[162:163], v52 offset:2304
    v_mfma_f32_16x16x32_bf16 a[48:51], a[176:179], a[196:199], a[48:51]
    v_mul_f32 v225, s60, v225
    v_mul_f32 v226, s60, v226
    v_mfma_f32_16x16x32_bf16 a[80:83], a[176:179], a[200:203], a[80:83]
    v_mul_f32 v227, s60, v227
    v_mul_f32 v228, s60, v228
    v_mfma_f32_16x16x32_bf16 a[112:115], a[176:179], a[204:207], a[112:115]
    v_mul_f32 v229, s60, v229
    v_mul_f32 v230, s60, v230
    v_mfma_f32_16x16x32_bf16 a[20:23], a[180:183], a[192:195], a[20:23]
    ds_read_b64_tr_b16 a[164:165], v53 offset:256
    ds_read_b64_tr_b16 a[166:167], v53 offset:2304
    v_mfma_f32_16x16x32_bf16 a[52:55], a[180:183], a[196:199], a[52:55]
    s_xor_b32 s12, s81, s31
    s_mov_b32 m0, s83
    v_mfma_f32_16x16x32_bf16 a[84:87], a[180:183], a[200:203], a[84:87]
    buffer_load_dwordx4 v13, s[32:35], s12 offen offset:0 nt lds
    v_mfma_f32_16x16x32_bf16 a[116:119], a[180:183], a[204:207], a[116:119]
    v_mul_f32 v231, s60, v231
    s_waitcnt lgkmcnt(4)
    v_mfma_f32_16x16x32_bf16 a[24:27], a[184:187], a[192:195], a[24:27]
    ds_read_b64_tr_b16 a[168:169], v54 offset:256
    ds_read_b64_tr_b16 a[170:171], v54 offset:2304
    v_mfma_f32_16x16x32_bf16 a[56:59], a[184:187], a[196:199], a[56:59]
    buffer_load_dwordx4 v14, s[32:35], s12 offen offset:1024 nt lds
    v_mfma_f32_16x16x32_bf16 a[88:91], a[184:187], a[200:203], a[88:91]
    buffer_load_dwordx4 v15, s[32:35], s12 offen offset:2048 nt lds
    v_mfma_f32_16x16x32_bf16 a[120:123], a[184:187], a[204:207], a[120:123]
    v_cvt_pk_bf16_f32 v112, v224, v225
    v_cvt_pk_bf16_f32 v113, v226, v227
    v_mfma_f32_16x16x32_bf16 a[28:31], a[188:191], a[192:195], a[28:31]
    ds_read_b64_tr_b16 a[172:173], v55 offset:256
    ds_read_b64_tr_b16 a[174:175], v55 offset:2304
    v_mfma_f32_16x16x32_bf16 a[60:63], a[188:191], a[196:199], a[60:63]
    buffer_load_dwordx4 v16, s[32:35], s12 offen offset:3072 nt lds
    v_mfma_f32_16x16x32_bf16 a[92:95], a[188:191], a[200:203], a[92:95]
    s_sub_u32 s81, s81, 4294734848
    s_and_b32 s81, s81, 4294734848
    v_mfma_f32_16x16x32_bf16 a[124:127], a[188:191], a[204:207], a[124:127]
    v_cvt_pk_bf16_f32 v114, v228, v229
    s_waitcnt lgkmcnt(4)
    v_mfma_f32_16x16x32_bf16 a[0:3], a[160:163], a[208:211], a[0:3]
    ds_read_b64_tr_b16 a[176:177], v56 offset:256
    ds_read_b64_tr_b16 a[178:179], v56 offset:2304
    v_mfma_f32_16x16x32_bf16 a[32:35], a[160:163], a[212:215], a[32:35]
    v_cvt_pk_bf16_f32 v115, v230, v231
    s_nop 0
    v_mfma_f32_16x16x32_bf16 a[64:67], a[160:163], a[216:219], a[64:67]
    v_permlane16_swap_b32 v112, v114
    v_permlane16_swap_b32 v113, v115
    v_mfma_f32_16x16x32_bf16 a[96:99], a[160:163], a[220:223], a[96:99]
    v_mul_f32 v136, s60, v136
    v_mul_f32 v137, s60, v137
    v_mfma_f32_16x16x32_bf16 a[4:7], a[164:167], a[208:211], a[4:7]
    ds_read_b64_tr_b16 a[180:181], v57 offset:256
    ds_read_b64_tr_b16 a[182:183], v57 offset:2304
    v_mfma_f32_16x16x32_bf16 a[36:39], a[164:167], a[212:215], a[36:39]
    v_mul_f32 v138, s60, v138
    v_mul_f32 v139, s60, v139
    v_mfma_f32_16x16x32_bf16 a[68:71], a[164:167], a[216:219], a[68:71]
    v_mul_f32 v140, s60, v140
    v_mul_f32 v141, s60, v141
    v_mfma_f32_16x16x32_bf16 a[100:103], a[164:167], a[220:223], a[100:103]
    v_mul_f32 v142, s60, v142
    s_waitcnt lgkmcnt(4)
    v_mfma_f32_16x16x32_bf16 a[8:11], a[168:171], a[208:211], a[8:11]
    ds_read_b64_tr_b16 a[184:185], v58 offset:256
    ds_read_b64_tr_b16 a[186:187], v58 offset:2304
    v_mfma_f32_16x16x32_bf16 a[40:43], a[168:171], a[212:215], a[40:43]
    v_mul_f32 v143, s60, v143
    v_cvt_pk_bf16_f32 v68, v136, v137
    v_mfma_f32_16x16x32_bf16 a[72:75], a[168:171], a[216:219], a[72:75]
    v_cvt_pk_bf16_f32 v69, v138, v139
    v_cvt_pk_bf16_f32 v70, v140, v141
    v_mfma_f32_16x16x32_bf16 a[104:107], a[168:171], a[220:223], a[104:107]
    v_cvt_pk_bf16_f32 v71, v142, v143
    s_nop 0
    v_mfma_f32_16x16x32_bf16 a[12:15], a[172:175], a[208:211], a[12:15]
    ds_read_b64_tr_b16 a[188:189], v59 offset:256
    ds_read_b64_tr_b16 a[190:191], v59 offset:2304
    v_mfma_f32_16x16x32_bf16 a[44:47], a[172:175], a[212:215], a[44:47]
    v_permlane16_swap_b32 v68, v70
    v_permlane16_swap_b32 v69, v71
    v_mfma_f32_16x16x32_bf16 a[76:79], a[172:175], a[216:219], a[76:79]
    v_mul_f32 v168, s60, v168
    v_mul_f32 v169, s60, v169
    v_mfma_f32_16x16x32_bf16 a[108:111], a[172:175], a[220:223], a[108:111]
    v_mul_f32 v170, s60, v170
    s_waitcnt lgkmcnt(4)
    v_mfma_f32_16x16x32_bf16 a[16:19], a[176:179], a[208:211], a[16:19]
    v_mul_f32 v171, s60, v171
    v_mul_f32 v172, s60, v172
    v_mfma_f32_16x16x32_bf16 a[48:51], a[176:179], a[212:215], a[48:51]
    v_mul_f32 v173, s60, v173
    v_mul_f32 v174, s60, v174
    v_mfma_f32_16x16x32_bf16 a[80:83], a[176:179], a[216:219], a[80:83]
    v_mul_f32 v175, s60, v175
    v_cvt_pk_bf16_f32 v84, v168, v169
    v_mfma_f32_16x16x32_bf16 a[112:115], a[176:179], a[220:223], a[112:115]
    v_cvt_pk_bf16_f32 v85, v170, v171
    v_cvt_pk_bf16_f32 v86, v172, v173
    v_mfma_f32_16x16x32_bf16 a[20:23], a[180:183], a[208:211], a[20:23]
    v_cvt_pk_bf16_f32 v87, v174, v175
    s_nop 0
    v_mfma_f32_16x16x32_bf16 a[52:55], a[180:183], a[212:215], a[52:55]
    v_permlane16_swap_b32 v84, v86
    v_permlane16_swap_b32 v85, v87
    v_mfma_f32_16x16x32_bf16 a[84:87], a[180:183], a[216:219], a[84:87]
    v_mul_f32 v200, s60, v200
    v_mul_f32 v201, s60, v201
    v_mfma_f32_16x16x32_bf16 a[116:119], a[180:183], a[220:223], a[116:119]
    s_waitcnt lgkmcnt(0)
    s_waitcnt vmcnt(24) lgkmcnt(0)
    s_barrier
    v_mfma_f32_16x16x32_bf16 a[24:27], a[184:187], a[208:211], a[24:27]
    ds_read_b128 a[128:131], v1 offset:0
    ds_read_b128 a[132:135], v2 offset:0
    v_mfma_f32_16x16x32_bf16 a[56:59], a[184:187], a[212:215], a[56:59]
    ds_read_b128 a[136:139], v3 offset:0
    ds_read_b128 a[140:143], v4 offset:0
    v_mfma_f32_16x16x32_bf16 a[88:91], a[184:187], a[216:219], a[88:91]
    ds_read_b128 a[144:147], v1 offset:4096
    ds_read_b128 a[148:151], v2 offset:4096
    v_mfma_f32_16x16x32_bf16 a[120:123], a[184:187], a[220:223], a[120:123]
    ds_read_b128 a[152:155], v3 offset:4096
    ds_read_b128 a[156:159], v4 offset:4096
    v_mfma_f32_16x16x32_bf16 a[28:31], a[188:191], a[208:211], a[28:31]
    v_mul_f32 v202, s60, v202
    v_mul_f32 v203, s60, v203
    v_mfma_f32_16x16x32_bf16 a[60:63], a[188:191], a[212:215], a[60:63]
    v_mul_f32 v204, s60, v204
    v_mul_f32 v205, s60, v205
    v_mfma_f32_16x16x32_bf16 a[92:95], a[188:191], a[216:219], a[92:95]
    v_mul_f32 v206, s60, v206
    v_mul_f32 v207, s60, v207
    v_cvt_pk_bf16_f32 v100, v200, v201
    v_cvt_pk_bf16_f32 v101, v202, v203
    v_cvt_pk_bf16_f32 v102, v204, v205
    v_cvt_pk_bf16_f32 v103, v206, v207
    s_nop 0
    v_permlane16_swap_b32 v100, v102
    v_permlane16_swap_b32 v101, v103
    v_mul_f32 v232, s60, v232
    v_mul_f32 v233, s60, v233
    v_mul_f32 v234, s60, v234
    v_mul_f32 v235, s60, v235
    v_mul_f32 v236, s60, v236
    v_mul_f32 v237, s60, v237
    v_mul_f32 v238, s60, v238
    v_mul_f32 v239, s60, v239
    v_cvt_pk_bf16_f32 v116, v232, v233
    v_cvt_pk_bf16_f32 v117, v234, v235
    v_cvt_pk_bf16_f32 v118, v236, v237
    v_cvt_pk_bf16_f32 v119, v238, v239
    s_nop 0
    v_permlane16_swap_b32 v116, v118
    v_permlane16_swap_b32 v117, v119
    v_mul_f32 v144, s60, v144
    v_mul_f32 v145, s60, v145
    v_mul_f32 v146, s60, v146
    v_mul_f32 v147, s60, v147
    v_mul_f32 v148, s60, v148
    v_mul_f32 v149, s60, v149
    v_mul_f32 v150, s60, v150
    v_mul_f32 v151, s60, v151
    v_cvt_pk_bf16_f32 v72, v144, v145
    v_cvt_pk_bf16_f32 v73, v146, v147
    v_cvt_pk_bf16_f32 v74, v148, v149
    v_cvt_pk_bf16_f32 v75, v150, v151
    s_nop 0
    v_permlane16_swap_b32 v72, v74
    v_permlane16_swap_b32 v73, v75
    v_mul_f32 v152, s60, v152
    v_mul_f32 v153, s60, v153
    v_mul_f32 v154, s60, v154
    v_mul_f32 v155, s60, v155
    v_mul_f32 v156, s60, v156
    v_mul_f32 v157, s60, v157
    v_mul_f32 v158, s60, v158
    v_mul_f32 v159, s60, v159
    v_cvt_pk_bf16_f32 v76, v152, v153
    v_cvt_pk_bf16_f32 v77, v154, v155
    v_cvt_pk_bf16_f32 v78, v156, v157
    v_cvt_pk_bf16_f32 v79, v158, v159
    s_nop 0
    v_permlane16_swap_b32 v76, v78
    v_permlane16_swap_b32 v77, v79
    v_mfma_f32_16x16x32_bf16 a[124:127], a[188:191], a[220:223], a[124:127]
    v_mul_f32 v176, s60, v176
    v_mul_f32 v177, s60, v177
    s_waitcnt lgkmcnt(4)
    v_mfma_f32_16x16x32_bf16 v[36:39], a[128:131], v[64:67], 0
    ds_read_b64_tr_b16 a[160:161], v5 offset:0
    ds_read_b64_tr_b16 a[162:163], v5 offset:4096
    v_mul_f32 v178, s60, v178
    v_mfma_f32_16x16x32_bf16 v[36:39], a[132:135], v[68:71], v[36:39]
    ds_read_b64_tr_b16 a[164:165], v6 offset:0
    ds_read_b64_tr_b16 a[166:167], v6 offset:4096
    v_mul_f32 v179, s60, v179
    v_mfma_f32_16x16x32_bf16 v[36:39], a[136:139], v[72:75], v[36:39]
    ds_read_b64_tr_b16 a[168:169], v7 offset:0
    ds_read_b64_tr_b16 a[170:171], v7 offset:4096
    v_mul_f32 v180, s60, v180
    v_mfma_f32_16x16x32_bf16 v[36:39], a[140:143], v[76:79], v[36:39]
    ds_read_b64_tr_b16 a[172:173], v8 offset:0
    ds_read_b64_tr_b16 a[174:175], v8 offset:4096
    s_waitcnt lgkmcnt(8)
    v_mfma_f32_16x16x32_bf16 v[32:35], a[144:147], v[64:67], 0
    ds_read_b64_tr_b16 a[176:177], v9 offset:0
    ds_read_b64_tr_b16 a[178:179], v9 offset:4096
    v_mul_f32 v181, s60, v181
    v_mfma_f32_16x16x32_bf16 v[32:35], a[148:151], v[68:71], v[32:35]
    ds_read_b64_tr_b16 a[180:181], v10 offset:0
    ds_read_b64_tr_b16 a[182:183], v10 offset:4096
    v_mul_f32 v182, s60, v182
    v_mfma_f32_16x16x32_bf16 v[32:35], a[152:155], v[72:75], v[32:35]
    ds_read_b64_tr_b16 a[184:185], v11 offset:0
    ds_read_b64_tr_b16 a[186:187], v11 offset:4096
    v_mul_f32 v183, s60, v183
    v_cvt_pk_bf16_f32 v88, v176, v177
    v_cvt_pk_bf16_f32 v89, v178, v179
    v_cvt_pk_bf16_f32 v90, v180, v181
    v_cvt_pk_bf16_f32 v91, v182, v183
    s_nop 0
    v_permlane16_swap_b32 v88, v90
    v_permlane16_swap_b32 v89, v91
    v_mul_f32 v184, s60, v184
    v_mul_f32 v185, s60, v185
    v_mul_f32 v186, s60, v186
    v_mul_f32 v187, s60, v187
    v_mul_f32 v188, s60, v188
    v_mul_f32 v189, s60, v189
    v_mul_f32 v190, s60, v190
    v_mul_f32 v191, s60, v191
    v_cvt_pk_bf16_f32 v92, v184, v185
    v_cvt_pk_bf16_f32 v93, v186, v187
    v_cvt_pk_bf16_f32 v94, v188, v189
    v_cvt_pk_bf16_f32 v95, v190, v191
    s_nop 0
    v_permlane16_swap_b32 v92, v94
    v_permlane16_swap_b32 v93, v95
    v_mfma_f32_16x16x32_bf16 v[32:35], a[156:159], v[76:79], v[32:35]
    ds_read_b64_tr_b16 a[188:189], v12 offset:0
    ds_read_b64_tr_b16 a[190:191], v12 offset:4096
    v_mfma_f32_16x16x32_bf16 v[40:43], a[128:131], v[80:83], 0
    v_mul_f32 v208, s60, v208
    v_mul_f32 v209, s60, v209
    v_mfma_f32_16x16x32_bf16 v[40:43], a[132:135], v[84:87], v[40:43]
    v_mul_f32 v210, s60, v210
    v_mul_f32 v211, s60, v211
    v_mfma_f32_16x16x32_bf16 v[40:43], a[136:139], v[88:91], v[40:43]
    v_mul_f32 v212, s60, v212
    v_mul_f32 v213, s60, v213
    v_mfma_f32_16x16x32_bf16 v[40:43], a[140:143], v[92:95], v[40:43]
    v_mul_f32 v214, s60, v214
    v_mul_f32 v215, s60, v215
    v_mfma_f32_16x16x32_bf16 v[44:47], a[144:147], v[80:83], 0
    v_cvt_pk_bf16_f32 v104, v208, v209
    v_cvt_pk_bf16_f32 v105, v210, v211
    v_mfma_f32_16x16x32_bf16 v[44:47], a[148:151], v[84:87], v[44:47]
    v_cvt_pk_bf16_f32 v106, v212, v213
    v_cvt_pk_bf16_f32 v107, v214, v215
    v_mfma_f32_16x16x32_bf16 v[44:47], a[152:155], v[88:91], v[44:47]
    s_nop 0
    v_permlane16_swap_b32 v104, v106
    v_permlane16_swap_b32 v105, v107
    v_mul_f32 v216, s60, v216
    v_mul_f32 v217, s60, v217
    v_mul_f32 v218, s60, v218
    v_mul_f32 v219, s60, v219
    v_mul_f32 v220, s60, v220
    v_mul_f32 v221, s60, v221
    v_mul_f32 v222, s60, v222
    v_mul_f32 v223, s60, v223
    v_cvt_pk_bf16_f32 v108, v216, v217
    v_cvt_pk_bf16_f32 v109, v218, v219
    v_cvt_pk_bf16_f32 v110, v220, v221
    v_cvt_pk_bf16_f32 v111, v222, v223
    s_nop 0
    v_permlane16_swap_b32 v108, v110
    v_permlane16_swap_b32 v109, v111
    v_mfma_f32_16x16x32_bf16 v[44:47], a[156:159], v[92:95], v[44:47]
    s_xor_b32 s13, s82, s31
    s_add_u32 m0, s83, 65536
    v_mfma_f32_16x16x32_bf16 v[52:55], a[128:131], v[96:99], 0
    buffer_load_dwordx4 v17, s[36:39], s13 offen offset:0 nt lds
    v_mfma_f32_16x16x32_bf16 v[52:55], a[132:135], v[100:103], v[52:55]
    v_mul_f32 v240, s60, v240
    v_mul_f32 v241, s60, v241
    v_mfma_f32_16x16x32_bf16 v[52:55], a[136:139], v[104:107], v[52:55]
    v_mul_f32 v242, s60, v242
    v_mul_f32 v243, s60, v243
    v_mfma_f32_16x16x32_bf16 v[52:55], a[140:143], v[108:111], v[52:55]
    v_mul_f32 v244, s60, v244
    v_mul_f32 v245, s60, v245
    v_mfma_f32_16x16x32_bf16 v[48:51], a[144:147], v[96:99], 0
    buffer_load_dwordx4 v18, s[36:39], s13 offen offset:1024 nt lds
    v_mfma_f32_16x16x32_bf16 v[48:51], a[148:151], v[100:103], v[48:51]
    v_mul_f32 v246, s60, v246
    v_mul_f32 v247, s60, v247
    v_mfma_f32_16x16x32_bf16 v[48:51], a[152:155], v[104:107], v[48:51]
    v_cvt_pk_bf16_f32 v120, v240, v241
    v_cvt_pk_bf16_f32 v121, v242, v243
    v_cvt_pk_bf16_f32 v122, v244, v245
    v_cvt_pk_bf16_f32 v123, v246, v247
    s_nop 0
    v_permlane16_swap_b32 v120, v122
    v_permlane16_swap_b32 v121, v123
    v_mul_f32 v248, s60, v248
    v_mul_f32 v249, s60, v249
    v_mul_f32 v250, s60, v250
    v_mul_f32 v251, s60, v251
    v_mul_f32 v252, s60, v252
    v_mul_f32 v253, s60, v253
    v_mul_f32 v254, s60, v254
    v_mul_f32 v255, s60, v255
    v_cvt_pk_bf16_f32 v124, v248, v249
    v_cvt_pk_bf16_f32 v125, v250, v251
    v_cvt_pk_bf16_f32 v126, v252, v253
    v_cvt_pk_bf16_f32 v127, v254, v255
    s_nop 0
    v_permlane16_swap_b32 v124, v126
    v_permlane16_swap_b32 v125, v127
    v_mfma_f32_16x16x32_bf16 v[48:51], a[156:159], v[108:111], v[48:51]
    v_exp_f32 v36, v36
    v_mfma_f32_16x16x32_bf16 v[56:59], a[128:131], v[112:115], v[20:23]
    v_exp_f32 v37, v37
    v_mfma_f32_16x16x32_bf16 v[56:59], a[132:135], v[116:119], v[56:59]
    v_exp_f32 v38, v38
    v_mfma_f32_16x16x32_bf16 v[56:59], a[136:139], v[120:123], v[56:59]
    v_exp_f32 v39, v39
    v_mfma_f32_16x16x32_bf16 v[56:59], a[140:143], v[124:127], v[56:59]
    v_exp_f32 v32, v32
    v_mfma_f32_16x16x32_bf16 v[60:63], a[144:147], v[112:115], v[20:23]
    v_exp_f32 v33, v33
    v_exp_f32 v34, v34
    v_exp_f32 v35, v35
    v_mfma_f32_16x16x32_bf16 v[60:63], a[148:151], v[116:119], v[60:63]
    v_cvt_pk_bf16_f32 v36, v36, v37
    v_cvt_pk_bf16_f32 v37, v38, v39
    v_cvt_pk_bf16_f32 v38, v32, v33
    v_cvt_pk_bf16_f32 v39, v34, v35
    v_mfma_f32_16x16x32_bf16 v[60:63], a[152:155], v[120:123], v[60:63]
    v_exp_f32 v40, v40
    v_mfma_f32_16x16x32_bf16 v[60:63], a[156:159], v[124:127], v[60:63]
    s_waitcnt lgkmcnt(0)
    v_mfma_f32_16x16x32_bf16 v[128:131], a[160:163], v[36:39], 0
    v_exp_f32 v41, v41
    v_mfma_f32_16x16x32_bf16 v[132:135], a[164:167], v[36:39], 0
    v_exp_f32 v42, v42
    v_mfma_f32_16x16x32_bf16 v[136:139], a[168:171], v[36:39], 0
    v_exp_f32 v43, v43
    v_mfma_f32_16x16x32_bf16 v[140:143], a[172:175], v[36:39], 0
    v_exp_f32 v44, v44
    v_mfma_f32_16x16x32_bf16 v[144:147], a[176:179], v[36:39], 0
    v_exp_f32 v45, v45
    v_exp_f32 v46, v46
    v_exp_f32 v47, v47
    v_mfma_f32_16x16x32_bf16 v[148:151], a[180:183], v[36:39], 0
    v_cvt_pk_bf16_f32 v40, v40, v41
    v_cvt_pk_bf16_f32 v41, v42, v43
    v_cvt_pk_bf16_f32 v42, v44, v45
    v_cvt_pk_bf16_f32 v43, v46, v47
    ds_read_b128 a[128:131], v1 offset:8192
    ds_read_b128 a[132:135], v2 offset:8192
    v_mfma_f32_16x16x32_bf16 v[152:155], a[184:187], v[36:39], 0
    v_exp_f32 v52, v52
    v_mfma_f32_16x16x32_bf16 v[156:159], a[188:191], v[36:39], 0
    v_exp_f32 v53, v53
    v_smfmac_f32_16x16x64_bf16 a[224:227], a[232:235], v[36:43], v19
    v_exp_f32 v54, v54
    v_mfma_f32_16x16x32_bf16 v[160:163], a[160:163], v[40:43], 0
    buffer_load_dwordx4 v17, s[36:39], s13 offen offset:2048 nt lds
    v_mfma_f32_16x16x32_bf16 v[164:167], a[164:167], v[40:43], 0
    v_exp_f32 v55, v55
    v_mfma_f32_16x16x32_bf16 v[168:171], a[168:171], v[40:43], 0
    v_exp_f32 v48, v48
    v_mfma_f32_16x16x32_bf16 v[172:175], a[172:175], v[40:43], 0
    v_exp_f32 v49, v49
    v_exp_f32 v50, v50
    v_mfma_f32_16x16x32_bf16 v[176:179], a[176:179], v[40:43], 0
    v_exp_f32 v51, v51
    buffer_load_dwordx4 v18, s[36:39], s13 offen offset:3072 nt lds
    v_mfma_f32_16x16x32_bf16 v[180:183], a[180:183], v[40:43], 0
    v_cvt_pk_bf16_f32 v52, v52, v53
    v_cvt_pk_bf16_f32 v53, v54, v55
    v_cvt_pk_bf16_f32 v54, v48, v49
    v_cvt_pk_bf16_f32 v55, v50, v51
    ds_read_b128 a[136:139], v3 offset:8192
    ds_read_b128 a[140:143], v4 offset:8192
    v_mfma_f32_16x16x32_bf16 v[184:187], a[184:187], v[40:43], 0
    ds_read_b128 a[144:147], v1 offset:12288
    ds_read_b128 a[148:151], v2 offset:12288
    v_mfma_f32_16x16x32_bf16 v[188:191], a[188:191], v[40:43], 0
    v_exp_f32 v56, v56
    v_mfma_f32_16x16x32_bf16 v[192:195], a[160:163], v[52:55], 0
    v_exp_f32 v57, v57
    v_mfma_f32_16x16x32_bf16 v[196:199], a[164:167], v[52:55], 0
    v_exp_f32 v58, v58
    v_mfma_f32_16x16x32_bf16 v[200:203], a[168:171], v[52:55], 0
    v_exp_f32 v59, v59
    v_mfma_f32_16x16x32_bf16 v[204:207], a[172:175], v[52:55], 0
    v_exp_f32 v60, v60
    v_mfma_f32_16x16x32_bf16 v[208:211], a[176:179], v[52:55], 0
    v_exp_f32 v61, v61
    v_exp_f32 v62, v62
    v_exp_f32 v63, v63
    v_mfma_f32_16x16x32_bf16 v[212:215], a[180:183], v[52:55], 0
    v_cvt_pk_bf16_f32 v56, v56, v57
    v_cvt_pk_bf16_f32 v57, v58, v59
    v_cvt_pk_bf16_f32 v58, v60, v61
    v_cvt_pk_bf16_f32 v59, v62, v63
    v_mfma_f32_16x16x32_bf16 v[216:219], a[184:187], v[52:55], 0
    ds_read_b128 a[152:155], v3 offset:12288
    ds_read_b128 a[156:159], v4 offset:12288
    v_mfma_f32_16x16x32_bf16 v[220:223], a[188:191], v[52:55], 0
    s_xor_b32 s83, s83, s84
    s_xor_b32 s84, s84, 49152
    v_smfmac_f32_16x16x64_bf16 a[228:231], a[232:235], v[52:59], v19
    v_xor_b32 v1, s84, v1
    v_xor_b32 v2, s84, v2
    v_mfma_f32_16x16x32_bf16 v[224:227], a[160:163], v[56:59], 0
    v_xor_b32 v3, s84, v3
    v_xor_b32 v4, s84, v4
    v_mfma_f32_16x16x32_bf16 v[228:231], a[164:167], v[56:59], 0
    v_mfma_f32_16x16x32_bf16 v[232:235], a[168:171], v[56:59], 0
    s_sub_u32 s82, s82, 4294734848
    s_and_b32 s82, s82, 4294734848
    v_mfma_f32_16x16x32_bf16 v[236:239], a[172:175], v[56:59], 0
    v_mfma_f32_16x16x32_bf16 v[240:243], a[176:179], v[56:59], 0
    v_mfma_f32_16x16x32_bf16 v[244:247], a[180:183], v[56:59], 0
    v_mfma_f32_16x16x32_bf16 v[248:251], a[184:187], v[56:59], 0
    v_mfma_f32_16x16x32_bf16 v[252:255], a[188:191], v[56:59], 0
    s_waitcnt lgkmcnt(0)
    s_cmp_eq_u32 s64, 3
    s_cbranch_scc1 L_atts
.p2align 6
L_att:
    v_mfma_f32_16x16x32_bf16 v[36:39], a[128:131], v[64:67], 0
    ds_read_b64_tr_b16 a[160:161], v5 offset:8192
    ds_read_b64_tr_b16 a[162:163], v5 offset:12288
    v_mfma_f32_16x16x32_bf16 v[36:39], a[132:135], v[68:71], v[36:39]
    ds_read_b64_tr_b16 a[164:165], v6 offset:8192
    ds_read_b64_tr_b16 a[166:167], v6 offset:12288
    v_mfma_f32_16x16x32_bf16 v[36:39], a[136:139], v[72:75], v[36:39]
    ds_read_b64_tr_b16 a[168:169], v7 offset:8192
    ds_read_b64_tr_b16 a[170:171], v7 offset:12288
    v_mfma_f32_16x16x32_bf16 v[36:39], a[140:143], v[76:79], v[36:39]
    ds_read_b64_tr_b16 a[172:173], v8 offset:8192
    ds_read_b64_tr_b16 a[174:175], v8 offset:12288
    v_mfma_f32_16x16x32_bf16 v[32:35], a[144:147], v[64:67], 0
    ds_read_b64_tr_b16 a[176:177], v9 offset:8192
    ds_read_b64_tr_b16 a[178:179], v9 offset:12288
    v_mfma_f32_16x16x32_bf16 v[32:35], a[148:151], v[68:71], v[32:35]
    ds_read_b64_tr_b16 a[180:181], v10 offset:8192
    ds_read_b64_tr_b16 a[182:183], v10 offset:12288
    v_mfma_f32_16x16x32_bf16 v[32:35], a[152:155], v[72:75], v[32:35]
    ds_read_b64_tr_b16 a[184:185], v11 offset:8192
    ds_read_b64_tr_b16 a[186:187], v11 offset:12288
    v_mfma_f32_16x16x32_bf16 v[32:35], a[156:159], v[76:79], v[32:35]
    ds_read_b64_tr_b16 a[188:189], v12 offset:8192
    ds_read_b64_tr_b16 a[190:191], v12 offset:12288
    v_mfma_f32_16x16x32_bf16 v[40:43], a[128:131], v[80:83], 0
    v_exp_f32 v36, v36
    v_mfma_f32_16x16x32_bf16 v[40:43], a[132:135], v[84:87], v[40:43]
    v_exp_f32 v37, v37
    v_mfma_f32_16x16x32_bf16 v[40:43], a[136:139], v[88:91], v[40:43]
    v_exp_f32 v38, v38
    v_mfma_f32_16x16x32_bf16 v[40:43], a[140:143], v[92:95], v[40:43]
    v_exp_f32 v39, v39
    v_mfma_f32_16x16x32_bf16 v[44:47], a[144:147], v[80:83], 0
    v_exp_f32 v32, v32
    v_mfma_f32_16x16x32_bf16 v[44:47], a[148:151], v[84:87], v[44:47]
    v_exp_f32 v33, v33
    v_mfma_f32_16x16x32_bf16 v[44:47], a[152:155], v[88:91], v[44:47]
    v_exp_f32 v34, v34
    v_mfma_f32_16x16x32_bf16 v[44:47], a[156:159], v[92:95], v[44:47]
    v_exp_f32 v35, v35
    v_mfma_f32_16x16x32_bf16 v[52:55], a[128:131], v[96:99], 0
    v_cvt_pk_bf16_f32 v36, v36, v37
    v_cvt_pk_bf16_f32 v37, v38, v39
    v_mfma_f32_16x16x32_bf16 v[52:55], a[132:135], v[100:103], v[52:55]
    v_cvt_pk_bf16_f32 v38, v32, v33
    v_cvt_pk_bf16_f32 v39, v34, v35
    v_mfma_f32_16x16x32_bf16 v[52:55], a[136:139], v[104:107], v[52:55]
    v_exp_f32 v40, v40
    v_mfma_f32_16x16x32_bf16 v[52:55], a[140:143], v[108:111], v[52:55]
    v_exp_f32 v41, v41
    v_mfma_f32_16x16x32_bf16 v[48:51], a[144:147], v[96:99], 0
    v_exp_f32 v42, v42
    v_mfma_f32_16x16x32_bf16 v[48:51], a[148:151], v[100:103], v[48:51]
    v_exp_f32 v43, v43
    v_mfma_f32_16x16x32_bf16 v[48:51], a[152:155], v[104:107], v[48:51]
    v_exp_f32 v44, v44
    v_mfma_f32_16x16x32_bf16 v[48:51], a[156:159], v[108:111], v[48:51]
    v_exp_f32 v45, v45
    v_mfma_f32_16x16x32_bf16 v[56:59], a[128:131], v[112:115], v[20:23]
    v_exp_f32 v46, v46
    v_mfma_f32_16x16x32_bf16 v[56:59], a[132:135], v[116:119], v[56:59]
    v_exp_f32 v47, v47
    v_mfma_f32_16x16x32_bf16 v[56:59], a[136:139], v[120:123], v[56:59]
    v_cvt_pk_bf16_f32 v40, v40, v41
    v_cvt_pk_bf16_f32 v41, v42, v43
    v_mfma_f32_16x16x32_bf16 v[56:59], a[140:143], v[124:127], v[56:59]
    v_cvt_pk_bf16_f32 v42, v44, v45
    v_cvt_pk_bf16_f32 v43, v46, v47
    v_mfma_f32_16x16x32_bf16 v[60:63], a[144:147], v[112:115], v[20:23]
    v_exp_f32 v52, v52
    v_mfma_f32_16x16x32_bf16 v[60:63], a[148:151], v[116:119], v[60:63]
    v_exp_f32 v53, v53
    v_mfma_f32_16x16x32_bf16 v[60:63], a[152:155], v[120:123], v[60:63]
    v_exp_f32 v54, v54
    v_mfma_f32_16x16x32_bf16 v[60:63], a[156:159], v[124:127], v[60:63]
    v_cvt_pk_bf16_f32 v52, v52, v53
    s_waitcnt lgkmcnt(0)
    v_mfma_f32_16x16x32_bf16 v[128:131], a[160:163], v[36:39], v[128:131]
    v_exp_f32 v55, v55
    v_mfma_f32_16x16x32_bf16 v[132:135], a[164:167], v[36:39], v[132:135]
    v_exp_f32 v48, v48
    v_mfma_f32_16x16x32_bf16 v[136:139], a[168:171], v[36:39], v[136:139]
    v_exp_f32 v49, v49
    v_mfma_f32_16x16x32_bf16 v[140:143], a[172:175], v[36:39], v[140:143]
    v_exp_f32 v50, v50
    v_mfma_f32_16x16x32_bf16 v[144:147], a[176:179], v[36:39], v[144:147]
    s_waitcnt vmcnt(16)
    s_barrier
    v_mfma_f32_16x16x32_bf16 v[148:151], a[180:183], v[36:39], v[148:151]
    ds_read_b128 a[128:131], v1 offset:0
    ds_read_b128 a[132:135], v2 offset:0
    v_mfma_f32_16x16x32_bf16 v[152:155], a[184:187], v[36:39], v[152:155]
    s_xor_b32 s12, s81, s31
    s_mov_b32 m0, s83
    v_mfma_f32_16x16x32_bf16 v[156:159], a[188:191], v[36:39], v[156:159]
    buffer_load_dwordx4 v13, s[32:35], s12 offen offset:0 nt lds
    v_smfmac_f32_16x16x64_bf16 a[224:227], a[232:235], v[36:43], v19
    v_exp_f32 v51, v51
    v_mfma_f32_16x16x32_bf16 v[160:163], a[160:163], v[40:43], v[160:163]
    v_cvt_pk_bf16_f32 v53, v54, v55
    v_cvt_pk_bf16_f32 v54, v48, v49
    v_mfma_f32_16x16x32_bf16 v[164:167], a[164:167], v[40:43], v[164:167]
    v_cvt_pk_bf16_f32 v55, v50, v51
    v_xor_b32 v5, s84, v5
    v_mfma_f32_16x16x32_bf16 v[168:171], a[168:171], v[40:43], v[168:171]
    buffer_load_dwordx4 v14, s[32:35], s12 offen offset:1024 nt lds
    v_mfma_f32_16x16x32_bf16 v[172:175], a[172:175], v[40:43], v[172:175]
    v_exp_f32 v56, v56
    v_mfma_f32_16x16x32_bf16 v[176:179], a[176:179], v[40:43], v[176:179]
    v_exp_f32 v57, v57
    v_mfma_f32_16x16x32_bf16 v[180:183], a[180:183], v[40:43], v[180:183]
    ds_read_b128 a[136:139], v3 offset:0
    ds_read_b128 a[140:143], v4 offset:0
    v_mfma_f32_16x16x32_bf16 v[184:187], a[184:187], v[40:43], v[184:187]
    ds_read_b128 a[144:147], v1 offset:4096
    ds_read_b128 a[148:151], v2 offset:4096
    v_mfma_f32_16x16x32_bf16 v[188:191], a[188:191], v[40:43], v[188:191]
    v_exp_f32 v58, v58
    v_mfma_f32_16x16x32_bf16 v[192:195], a[160:163], v[52:55], v[192:195]
    v_exp_f32 v59, v59
    v_mfma_f32_16x16x32_bf16 v[196:199], a[164:167], v[52:55], v[196:199]
    v_exp_f32 v60, v60
    v_mfma_f32_16x16x32_bf16 v[200:203], a[168:171], v[52:55], v[200:203]
    v_exp_f32 v61, v61
    v_mfma_f32_16x16x32_bf16 v[204:207], a[172:175], v[52:55], v[204:207]
    v_exp_f32 v62, v62
    v_mfma_f32_16x16x32_bf16 v[208:211], a[176:179], v[52:55], v[208:211]
    v_exp_f32 v63, v63
    v_mfma_f32_16x16x32_bf16 v[212:215], a[180:183], v[52:55], v[212:215]
    v_cvt_pk_bf16_f32 v56, v56, v57
    v_cvt_pk_bf16_f32 v57, v58, v59
    v_cvt_pk_bf16_f32 v58, v60, v61
    v_cvt_pk_bf16_f32 v59, v62, v63
    v_mfma_f32_16x16x32_bf16 v[216:219], a[184:187], v[52:55], v[216:219]
    ds_read_b128 a[152:155], v3 offset:4096
    ds_read_b128 a[156:159], v4 offset:4096
    v_mfma_f32_16x16x32_bf16 v[220:223], a[188:191], v[52:55], v[220:223]
    v_xor_b32 v6, s84, v6
    v_xor_b32 v7, s84, v7
    v_smfmac_f32_16x16x64_bf16 a[228:231], a[232:235], v[52:59], v19
    buffer_load_dwordx4 v15, s[32:35], s12 offen offset:2048 nt lds
    v_mfma_f32_16x16x32_bf16 v[224:227], a[160:163], v[56:59], v[224:227]
    v_xor_b32 v8, s84, v8
    v_xor_b32 v9, s84, v9
    v_mfma_f32_16x16x32_bf16 v[228:231], a[164:167], v[56:59], v[228:231]
    v_xor_b32 v10, s84, v10
    v_xor_b32 v11, s84, v11
    v_mfma_f32_16x16x32_bf16 v[232:235], a[168:171], v[56:59], v[232:235]
    v_xor_b32 v12, s84, v12
    v_mfma_f32_16x16x32_bf16 v[236:239], a[172:175], v[56:59], v[236:239]
    buffer_load_dwordx4 v16, s[32:35], s12 offen offset:3072 nt lds
    v_mfma_f32_16x16x32_bf16 v[240:243], a[176:179], v[56:59], v[240:243]
    s_sub_u32 s81, s81, 4294734848
    s_and_b32 s81, s81, 4294734848
    v_mfma_f32_16x16x32_bf16 v[244:247], a[180:183], v[56:59], v[244:247]
    v_mfma_f32_16x16x32_bf16 v[248:251], a[184:187], v[56:59], v[248:251]
    v_mfma_f32_16x16x32_bf16 v[252:255], a[188:191], v[56:59], v[252:255]
    s_waitcnt lgkmcnt(0)
    v_mfma_f32_16x16x32_bf16 v[36:39], a[128:131], v[64:67], 0
    ds_read_b64_tr_b16 a[160:161], v5 offset:0
    ds_read_b64_tr_b16 a[162:163], v5 offset:4096
    v_mfma_f32_16x16x32_bf16 v[36:39], a[132:135], v[68:71], v[36:39]
    ds_read_b64_tr_b16 a[164:165], v6 offset:0
    ds_read_b64_tr_b16 a[166:167], v6 offset:4096
    v_mfma_f32_16x16x32_bf16 v[36:39], a[136:139], v[72:75], v[36:39]
    ds_read_b64_tr_b16 a[168:169], v7 offset:0
    ds_read_b64_tr_b16 a[170:171], v7 offset:4096
    v_mfma_f32_16x16x32_bf16 v[36:39], a[140:143], v[76:79], v[36:39]
    ds_read_b64_tr_b16 a[172:173], v8 offset:0
    ds_read_b64_tr_b16 a[174:175], v8 offset:4096
    v_mfma_f32_16x16x32_bf16 v[32:35], a[144:147], v[64:67], 0
    ds_read_b64_tr_b16 a[176:177], v9 offset:0
    ds_read_b64_tr_b16 a[178:179], v9 offset:4096
    v_mfma_f32_16x16x32_bf16 v[32:35], a[148:151], v[68:71], v[32:35]
    ds_read_b64_tr_b16 a[180:181], v10 offset:0
    ds_read_b64_tr_b16 a[182:183], v10 offset:4096
    v_mfma_f32_16x16x32_bf16 v[32:35], a[152:155], v[72:75], v[32:35]
    ds_read_b64_tr_b16 a[184:185], v11 offset:0
    ds_read_b64_tr_b16 a[186:187], v11 offset:4096
    v_mfma_f32_16x16x32_bf16 v[32:35], a[156:159], v[76:79], v[32:35]
    ds_read_b64_tr_b16 a[188:189], v12 offset:0
    ds_read_b64_tr_b16 a[190:191], v12 offset:4096
    v_mfma_f32_16x16x32_bf16 v[40:43], a[128:131], v[80:83], 0
    v_exp_f32 v36, v36
    v_mfma_f32_16x16x32_bf16 v[40:43], a[132:135], v[84:87], v[40:43]
    v_exp_f32 v37, v37
    v_mfma_f32_16x16x32_bf16 v[40:43], a[136:139], v[88:91], v[40:43]
    v_exp_f32 v38, v38
    v_mfma_f32_16x16x32_bf16 v[40:43], a[140:143], v[92:95], v[40:43]
    v_exp_f32 v39, v39
    v_mfma_f32_16x16x32_bf16 v[44:47], a[144:147], v[80:83], 0
    v_exp_f32 v32, v32
    v_mfma_f32_16x16x32_bf16 v[44:47], a[148:151], v[84:87], v[44:47]
    v_exp_f32 v33, v33
    v_mfma_f32_16x16x32_bf16 v[44:47], a[152:155], v[88:91], v[44:47]
    v_exp_f32 v34, v34
    v_mfma_f32_16x16x32_bf16 v[44:47], a[156:159], v[92:95], v[44:47]
    s_xor_b32 s13, s82, s31
    s_add_u32 m0, s83, 65536
    v_mfma_f32_16x16x32_bf16 v[52:55], a[128:131], v[96:99], 0
    buffer_load_dwordx4 v17, s[36:39], s13 offen offset:0 nt lds
    v_mfma_f32_16x16x32_bf16 v[52:55], a[132:135], v[100:103], v[52:55]
    v_exp_f32 v35, v35
    v_mfma_f32_16x16x32_bf16 v[52:55], a[136:139], v[104:107], v[52:55]
    v_cvt_pk_bf16_f32 v36, v36, v37
    v_cvt_pk_bf16_f32 v37, v38, v39
    v_mfma_f32_16x16x32_bf16 v[52:55], a[140:143], v[108:111], v[52:55]
    v_cvt_pk_bf16_f32 v38, v32, v33
    v_cvt_pk_bf16_f32 v39, v34, v35
    v_mfma_f32_16x16x32_bf16 v[48:51], a[144:147], v[96:99], 0
    buffer_load_dwordx4 v18, s[36:39], s13 offen offset:1024 nt lds
    v_mfma_f32_16x16x32_bf16 v[48:51], a[148:151], v[100:103], v[48:51]
    v_exp_f32 v40, v40
    v_mfma_f32_16x16x32_bf16 v[48:51], a[152:155], v[104:107], v[48:51]
    v_exp_f32 v41, v41
    v_mfma_f32_16x16x32_bf16 v[48:51], a[156:159], v[108:111], v[48:51]
    v_exp_f32 v42, v42
    v_mfma_f32_16x16x32_bf16 v[56:59], a[128:131], v[112:115], v[20:23]
    v_exp_f32 v43, v43
    v_mfma_f32_16x16x32_bf16 v[56:59], a[132:135], v[116:119], v[56:59]
    v_exp_f32 v44, v44
    v_mfma_f32_16x16x32_bf16 v[56:59], a[136:139], v[120:123], v[56:59]
    v_exp_f32 v45, v45
    v_mfma_f32_16x16x32_bf16 v[56:59], a[140:143], v[124:127], v[56:59]
    v_exp_f32 v46, v46
    v_mfma_f32_16x16x32_bf16 v[60:63], a[144:147], v[112:115], v[20:23]
    v_exp_f32 v47, v47
    v_mfma_f32_16x16x32_bf16 v[60:63], a[148:151], v[116:119], v[60:63]
    v_cvt_pk_bf16_f32 v40, v40, v41
    v_cvt_pk_bf16_f32 v41, v42, v43
    v_mfma_f32_16x16x32_bf16 v[60:63], a[152:155], v[120:123], v[60:63]
    v_cvt_pk_bf16_f32 v42, v44, v45
    v_cvt_pk_bf16_f32 v43, v46, v47
    v_mfma_f32_16x16x32_bf16 v[60:63], a[156:159], v[124:127], v[60:63]
    s_waitcnt lgkmcnt(0)
    v_mfma_f32_16x16x32_bf16 v[128:131], a[160:163], v[36:39], v[128:131]
    v_exp_f32 v52, v52
    v_mfma_f32_16x16x32_bf16 v[132:135], a[164:167], v[36:39], v[132:135]
    v_exp_f32 v53, v53
    v_mfma_f32_16x16x32_bf16 v[136:139], a[168:171], v[36:39], v[136:139]
    v_exp_f32 v54, v54
    v_mfma_f32_16x16x32_bf16 v[140:143], a[172:175], v[36:39], v[140:143]
    v_exp_f32 v55, v55
    v_mfma_f32_16x16x32_bf16 v[144:147], a[176:179], v[36:39], v[144:147]
    v_exp_f32 v48, v48
    v_mfma_f32_16x16x32_bf16 v[148:151], a[180:183], v[36:39], v[148:151]
    ds_read_b128 a[128:131], v1 offset:8192
    ds_read_b128 a[132:135], v2 offset:8192
    v_mfma_f32_16x16x32_bf16 v[152:155], a[184:187], v[36:39], v[152:155]
    v_exp_f32 v49, v49
    v_mfma_f32_16x16x32_bf16 v[156:159], a[188:191], v[36:39], v[156:159]
    v_exp_f32 v50, v50
    v_smfmac_f32_16x16x64_bf16 a[224:227], a[232:235], v[36:43], v19
    v_exp_f32 v51, v51
    v_mfma_f32_16x16x32_bf16 v[160:163], a[160:163], v[40:43], v[160:163]
    buffer_load_dwordx4 v17, s[36:39], s13 offen offset:2048 nt lds
    v_mfma_f32_16x16x32_bf16 v[164:167], a[164:167], v[40:43], v[164:167]
    v_cvt_pk_bf16_f32 v52, v52, v53
    v_cvt_pk_bf16_f32 v53, v54, v55
    v_mfma_f32_16x16x32_bf16 v[168:171], a[168:171], v[40:43], v[168:171]
    v_cvt_pk_bf16_f32 v54, v48, v49
    v_cvt_pk_bf16_f32 v55, v50, v51
    v_mfma_f32_16x16x32_bf16 v[172:175], a[172:175], v[40:43], v[172:175]
    v_exp_f32 v56, v56
    v_mfma_f32_16x16x32_bf16 v[176:179], a[176:179], v[40:43], v[176:179]
    buffer_load_dwordx4 v18, s[36:39], s13 offen offset:3072 nt lds
    v_mfma_f32_16x16x32_bf16 v[180:183], a[180:183], v[40:43], v[180:183]
    ds_read_b128 a[136:139], v3 offset:8192
    ds_read_b128 a[140:143], v4 offset:8192
    v_mfma_f32_16x16x32_bf16 v[184:187], a[184:187], v[40:43], v[184:187]
    ds_read_b128 a[144:147], v1 offset:12288
    ds_read_b128 a[148:151], v2 offset:12288
    v_mfma_f32_16x16x32_bf16 v[188:191], a[188:191], v[40:43], v[188:191]
    v_exp_f32 v57, v57
    v_mfma_f32_16x16x32_bf16 v[192:195], a[160:163], v[52:55], v[192:195]
    v_exp_f32 v58, v58
    v_mfma_f32_16x16x32_bf16 v[196:199], a[164:167], v[52:55], v[196:199]
    v_exp_f32 v59, v59
    v_mfma_f32_16x16x32_bf16 v[200:203], a[168:171], v[52:55], v[200:203]
    v_exp_f32 v60, v60
    v_mfma_f32_16x16x32_bf16 v[204:207], a[172:175], v[52:55], v[204:207]
    v_exp_f32 v61, v61
    v_mfma_f32_16x16x32_bf16 v[208:211], a[176:179], v[52:55], v[208:211]
    v_exp_f32 v62, v62
    v_exp_f32 v63, v63
    v_mfma_f32_16x16x32_bf16 v[212:215], a[180:183], v[52:55], v[212:215]
    v_cvt_pk_bf16_f32 v56, v56, v57
    v_cvt_pk_bf16_f32 v57, v58, v59
    v_cvt_pk_bf16_f32 v58, v60, v61
    v_cvt_pk_bf16_f32 v59, v62, v63
    v_mfma_f32_16x16x32_bf16 v[216:219], a[184:187], v[52:55], v[216:219]
    ds_read_b128 a[152:155], v3 offset:12288
    ds_read_b128 a[156:159], v4 offset:12288
    v_mfma_f32_16x16x32_bf16 v[220:223], a[188:191], v[52:55], v[220:223]
    s_xor_b32 s83, s83, s84
    s_xor_b32 s84, s84, 49152
    v_smfmac_f32_16x16x64_bf16 a[228:231], a[232:235], v[52:59], v19
    v_xor_b32 v1, s84, v1
    v_xor_b32 v2, s84, v2
    v_mfma_f32_16x16x32_bf16 v[224:227], a[160:163], v[56:59], v[224:227]
    v_xor_b32 v3, s84, v3
    v_xor_b32 v4, s84, v4
    v_mfma_f32_16x16x32_bf16 v[228:231], a[164:167], v[56:59], v[228:231]
    v_mfma_f32_16x16x32_bf16 v[232:235], a[168:171], v[56:59], v[232:235]
    s_sub_u32 s82, s82, 4294734848
    s_and_b32 s82, s82, 4294734848
    v_mfma_f32_16x16x32_bf16 v[236:239], a[172:175], v[56:59], v[236:239]
    v_mfma_f32_16x16x32_bf16 v[240:243], a[176:179], v[56:59], v[240:243]
    v_mfma_f32_16x16x32_bf16 v[244:247], a[180:183], v[56:59], v[244:247]
    v_mfma_f32_16x16x32_bf16 v[248:251], a[184:187], v[56:59], v[248:251]
    v_mfma_f32_16x16x32_bf16 v[252:255], a[188:191], v[56:59], v[252:255]
    s_waitcnt lgkmcnt(0)
    s_cmp_lg_u32 s81, s85
    s_cbranch_scc1 L_att
L_after:
    s_cmp_lg_u32 s86, 0
    s_cbranch_scc1 L_last
L_mid:
    v_mfma_f32_16x16x32_bf16 v[36:39], a[128:131], v[64:67], 0
    ds_read_b64_tr_b16 a[160:161], v5 offset:8192
    ds_read_b64_tr_b16 a[162:163], v5 offset:12288
    v_mfma_f32_16x16x32_bf16 v[36:39], a[132:135], v[68:71], v[36:39]
    ds_read_b64_tr_b16 a[164:165], v6 offset:8192
    ds_read_b64_tr_b16 a[166:167], v6 offset:12288
    v_mfma_f32_16x16x32_bf16 v[36:39], a[136:139], v[72:75], v[36:39]
    ds_read_b64_tr_b16 a[168:169], v7 offset:8192
    ds_read_b64_tr_b16 a[170:171], v7 offset:12288
    v_mfma_f32_16x16x32_bf16 v[36:39], a[140:143], v[76:79], v[36:39]
    ds_read_b64_tr_b16 a[172:173], v8 offset:8192
    ds_read_b64_tr_b16 a[174:175], v8 offset:12288
    v_mfma_f32_16x16x32_bf16 v[32:35], a[144:147], v[64:67], 0
    ds_read_b64_tr_b16 a[176:177], v9 offset:8192
    ds_read_b64_tr_b16 a[178:179], v9 offset:12288
    v_mfma_f32_16x16x32_bf16 v[32:35], a[148:151], v[68:71], v[32:35]
    ds_read_b64_tr_b16 a[180:181], v10 offset:8192
    ds_read_b64_tr_b16 a[182:183], v10 offset:12288
    v_mfma_f32_16x16x32_bf16 v[32:35], a[152:155], v[72:75], v[32:35]
    ds_read_b64_tr_b16 a[184:185], v11 offset:8192
    ds_read_b64_tr_b16 a[186:187], v11 offset:12288
    v_mfma_f32_16x16x32_bf16 v[32:35], a[156:159], v[76:79], v[32:35]
    ds_read_b64_tr_b16 a[188:189], v12 offset:8192
    ds_read_b64_tr_b16 a[190:191], v12 offset:12288
    v_mfma_f32_16x16x32_bf16 v[40:43], a[128:131], v[80:83], 0
    v_exp_f32 v36, v36
    v_mfma_f32_16x16x32_bf16 v[40:43], a[132:135], v[84:87], v[40:43]
    v_exp_f32 v37, v37
    v_mfma_f32_16x16x32_bf16 v[40:43], a[136:139], v[88:91], v[40:43]
    v_exp_f32 v38, v38
    v_mfma_f32_16x16x32_bf16 v[40:43], a[140:143], v[92:95], v[40:43]
    v_exp_f32 v39, v39
    v_mfma_f32_16x16x32_bf16 v[44:47], a[144:147], v[80:83], 0
    v_exp_f32 v32, v32
    v_mfma_f32_16x16x32_bf16 v[44:47], a[148:151], v[84:87], v[44:47]
    v_exp_f32 v33, v33
    v_mfma_f32_16x16x32_bf16 v[44:47], a[152:155], v[88:91], v[44:47]
    v_exp_f32 v34, v34
    v_mfma_f32_16x16x32_bf16 v[44:47], a[156:159], v[92:95], v[44:47]
    v_exp_f32 v35, v35
    v_mfma_f32_16x16x32_bf16 v[52:55], a[128:131], v[96:99], 0
    v_cvt_pk_bf16_f32 v36, v36, v37
    v_cvt_pk_bf16_f32 v37, v38, v39
    v_mfma_f32_16x16x32_bf16 v[52:55], a[132:135], v[100:103], v[52:55]
    v_cvt_pk_bf16_f32 v38, v32, v33
    v_cvt_pk_bf16_f32 v39, v34, v35
    v_mfma_f32_16x16x32_bf16 v[52:55], a[136:139], v[104:107], v[52:55]
    v_exp_f32 v40, v40
    v_mfma_f32_16x16x32_bf16 v[52:55], a[140:143], v[108:111], v[52:55]
    v_exp_f32 v41, v41
    v_mfma_f32_16x16x32_bf16 v[48:51], a[144:147], v[96:99], 0
    v_exp_f32 v42, v42
    v_mfma_f32_16x16x32_bf16 v[48:51], a[148:151], v[100:103], v[48:51]
    v_exp_f32 v43, v43
    v_mfma_f32_16x16x32_bf16 v[48:51], a[152:155], v[104:107], v[48:51]
    v_exp_f32 v44, v44
    v_mfma_f32_16x16x32_bf16 v[48:51], a[156:159], v[108:111], v[48:51]
    v_exp_f32 v45, v45
    v_mfma_f32_16x16x32_bf16 v[56:59], a[128:131], v[112:115], v[20:23]
    v_exp_f32 v46, v46
    v_mfma_f32_16x16x32_bf16 v[56:59], a[132:135], v[116:119], v[56:59]
    v_exp_f32 v47, v47
    v_mfma_f32_16x16x32_bf16 v[56:59], a[136:139], v[120:123], v[56:59]
    v_cvt_pk_bf16_f32 v40, v40, v41
    v_cvt_pk_bf16_f32 v41, v42, v43
    v_mfma_f32_16x16x32_bf16 v[56:59], a[140:143], v[124:127], v[56:59]
    v_cvt_pk_bf16_f32 v42, v44, v45
    v_cvt_pk_bf16_f32 v43, v46, v47
    v_mfma_f32_16x16x32_bf16 v[60:63], a[144:147], v[112:115], v[20:23]
    v_exp_f32 v52, v52
    v_mfma_f32_16x16x32_bf16 v[60:63], a[148:151], v[116:119], v[60:63]
    v_exp_f32 v53, v53
    v_mfma_f32_16x16x32_bf16 v[60:63], a[152:155], v[120:123], v[60:63]
    v_exp_f32 v54, v54
    v_mfma_f32_16x16x32_bf16 v[60:63], a[156:159], v[124:127], v[60:63]
    v_cvt_pk_bf16_f32 v52, v52, v53
    s_waitcnt lgkmcnt(0)
    v_mfma_f32_16x16x32_bf16 v[128:131], a[160:163], v[36:39], v[128:131]
    v_exp_f32 v55, v55
    v_mfma_f32_16x16x32_bf16 v[132:135], a[164:167], v[36:39], v[132:135]
    v_exp_f32 v48, v48
    v_mfma_f32_16x16x32_bf16 v[136:139], a[168:171], v[36:39], v[136:139]
    v_exp_f32 v49, v49
    v_mfma_f32_16x16x32_bf16 v[140:143], a[172:175], v[36:39], v[140:143]
    v_exp_f32 v50, v50
    v_mfma_f32_16x16x32_bf16 v[144:147], a[176:179], v[36:39], v[144:147]
    s_waitcnt vmcnt(16)
    s_barrier
    v_mfma_f32_16x16x32_bf16 v[148:151], a[180:183], v[36:39], v[148:151]
    ds_read_b128 a[128:131], v1 offset:0
    ds_read_b128 a[132:135], v2 offset:0
    v_mfma_f32_16x16x32_bf16 v[152:155], a[184:187], v[36:39], v[152:155]
    s_xor_b32 s12, s81, s31
    s_mov_b32 m0, s83
    v_mfma_f32_16x16x32_bf16 v[156:159], a[188:191], v[36:39], v[156:159]
    buffer_load_dwordx4 v13, s[32:35], s12 offen offset:0 nt lds
    v_smfmac_f32_16x16x64_bf16 a[224:227], a[232:235], v[36:43], v19
    v_exp_f32 v51, v51
    v_mfma_f32_16x16x32_bf16 v[160:163], a[160:163], v[40:43], v[160:163]
    v_cvt_pk_bf16_f32 v53, v54, v55
    v_cvt_pk_bf16_f32 v54, v48, v49
    v_mfma_f32_16x16x32_bf16 v[164:167], a[164:167], v[40:43], v[164:167]
    v_cvt_pk_bf16_f32 v55, v50, v51
    v_xor_b32 v5, s84, v5
    v_mfma_f32_16x16x32_bf16 v[168:171], a[168:171], v[40:43], v[168:171]
    buffer_load_dwordx4 v14, s[32:35], s12 offen offset:1024 nt lds
    v_mfma_f32_16x16x32_bf16 v[172:175], a[172:175], v[40:43], v[172:175]
    v_exp_f32 v56, v56
    v_mfma_f32_16x16x32_bf16 v[176:179], a[176:179], v[40:43], v[176:179]
    v_exp_f32 v57, v57
    v_mfma_f32_16x16x32_bf16 v[180:183], a[180:183], v[40:43], v[180:183]
    ds_read_b128 a[136:139], v3 offset:0
    ds_read_b128 a[140:143], v4 offset:0
    v_mfma_f32_16x16x32_bf16 v[184:187], a[184:187], v[40:43], v[184:187]
    ds_read_b128 a[144:147], v1 offset:4096
    ds_read_b128 a[148:151], v2 offset:4096
    v_mfma_f32_16x16x32_bf16 v[188:191], a[188:191], v[40:43], v[188:191]
    v_exp_f32 v58, v58
    v_mfma_f32_16x16x32_bf16 v[192:195], a[160:163], v[52:55], v[192:195]
    v_exp_f32 v59, v59
    v_mfma_f32_16x16x32_bf16 v[196:199], a[164:167], v[52:55], v[196:199]
    v_exp_f32 v60, v60
    v_mfma_f32_16x16x32_bf16 v[200:203], a[168:171], v[52:55], v[200:203]
    v_exp_f32 v61, v61
    v_mfma_f32_16x16x32_bf16 v[204:207], a[172:175], v[52:55], v[204:207]
    v_exp_f32 v62, v62
    v_mfma_f32_16x16x32_bf16 v[208:211], a[176:179], v[52:55], v[208:211]
    v_exp_f32 v63, v63
    v_mfma_f32_16x16x32_bf16 v[212:215], a[180:183], v[52:55], v[212:215]
    v_cvt_pk_bf16_f32 v56, v56, v57
    v_cvt_pk_bf16_f32 v57, v58, v59
    v_cvt_pk_bf16_f32 v58, v60, v61
    v_cvt_pk_bf16_f32 v59, v62, v63
    v_mfma_f32_16x16x32_bf16 v[216:219], a[184:187], v[52:55], v[216:219]
    ds_read_b128 a[152:155], v3 offset:4096
    ds_read_b128 a[156:159], v4 offset:4096
    v_mfma_f32_16x16x32_bf16 v[220:223], a[188:191], v[52:55], v[220:223]
    v_accvgpr_read_b32 v32, a224
    v_accvgpr_read_b32 v33, a225
    v_smfmac_f32_16x16x64_bf16 a[228:231], a[232:235], v[52:59], v19
    buffer_load_dwordx4 v15, s[32:35], s12 offen offset:2048 nt lds
    v_mfma_f32_16x16x32_bf16 v[224:227], a[160:163], v[56:59], v[224:227]
    v_accvgpr_read_b32 v34, a226
    v_accvgpr_read_b32 v35, a227
    v_mfma_f32_16x16x32_bf16 v[228:231], a[164:167], v[56:59], v[228:231]
    v_xor_b32 v6, s84, v6
    v_xor_b32 v7, s84, v7
    v_mfma_f32_16x16x32_bf16 v[232:235], a[168:171], v[56:59], v[232:235]
    v_xor_b32 v8, s84, v8
    v_xor_b32 v9, s84, v9
    v_mfma_f32_16x16x32_bf16 v[236:239], a[172:175], v[56:59], v[236:239]
    buffer_load_dwordx4 v16, s[32:35], s12 offen offset:3072 nt lds
    v_mfma_f32_16x16x32_bf16 v[240:243], a[176:179], v[56:59], v[240:243]
    s_sub_u32 s81, s81, 4294734848
    s_and_b32 s81, s81, 4294734848
    v_mfma_f32_16x16x32_bf16 v[244:247], a[180:183], v[56:59], v[244:247]
    v_xor_b32 v10, s84, v10
    v_xor_b32 v11, s84, v11
    v_mfma_f32_16x16x32_bf16 v[248:251], a[184:187], v[56:59], v[248:251]
    v_xor_b32 v12, s84, v12
    s_nop 1
    v_mfma_f32_16x16x32_bf16 v[252:255], a[188:191], v[56:59], v[252:255]
    v_accvgpr_read_b32 v36, a228
    v_accvgpr_read_b32 v37, a229
    v_accvgpr_read_b32 v38, a230
    v_accvgpr_read_b32 v39, a231
    v_add_f32 v28, v32, v33
    v_add_f32 v29, v34, v35
    v_add_f32 v30, v36, v37
    v_add_f32 v31, v38, v39
    v_add_f32 v32, v28, v29
    v_add_f32 v33, v30, v31
    v_min3_f32 v34, v28, v29, v30
    v_add_f32 v32, v32, v33
    v_min_f32 v34, v34, v31
    v_cmp_ngt_f32 vcc, s94, v32
    v_cmp_gt_f32_e64 s[4:5], s95, v34
    s_waitcnt lgkmcnt(0)
    s_nop 0
    s_or_b64 s[4:5], s[4:5], vcc
    s_cbranch_scc1 L_tramp0
L_ret0:
    v_rcp_f32 v28, v28
    v_rcp_f32 v29, v29
    v_rcp_f32 v30, v30
    v_rcp_f32 v31, v31
    v_accvgpr_write_b32 a224, 0
    v_accvgpr_write_b32 a225, 0
    v_accvgpr_write_b32 a226, 0
    v_accvgpr_write_b32 a227, 0
    v_accvgpr_write_b32 a228, 0
    v_accvgpr_write_b32 a229, 0
    v_accvgpr_write_b32 a230, s97
    v_accvgpr_write_b32 a231, 0
    s_mov_b32 s86, 1
    s_mov_b32 s98, 262144
    s_mov_b32 s85, 525312
    s_mov_b32 s10, s99
    s_mov_b32 s11, s100
    v_accvgpr_read_b32 v48, a236
    v_accvgpr_read_b32 v49, a237
    v_accvgpr_read_b32 v50, a238
    s_add_u32 m0, s96, 0
    s_nop 0
    buffer_load_dwordx4 v48, s[16:19], s24 offen offset:0 lds
    v_accvgpr_read_b32 v56, a0
    v_accvgpr_read_b32 v57, a1
    v_accvgpr_read_b32 v58, a2
    v_accvgpr_read_b32 v59, a3
    v_accvgpr_read_b32 v60, a4
    v_accvgpr_read_b32 v61, a5
    v_accvgpr_read_b32 v62, a6
    v_accvgpr_read_b32 v63, a7
    v_pk_mul_f32 v[56:57], s[60:61], v[56:57] op_sel_hi:[0,1]
    v_pk_mul_f32 v[58:59], s[60:61], v[58:59] op_sel_hi:[0,1]
    buffer_load_dwordx4 v49, s[16:19], s24 offen offset:1024 lds
    v_pk_mul_f32 v[60:61], s[60:61], v[60:61] op_sel_hi:[0,1]
    v_pk_mul_f32 v[62:63], s[60:61], v[62:63] op_sel_hi:[0,1]
    v_cvt_pk_bf16_f32 v64, v56, v57
    v_cvt_pk_bf16_f32 v65, v58, v59
    v_cvt_pk_bf16_f32 v66, v60, v61
    v_cvt_pk_bf16_f32 v67, v62, v63
    v_accvgpr_read_b32 v56, a8
    v_accvgpr_read_b32 v57, a9
    v_permlane16_swap_b32 v64, v66
    v_permlane16_swap_b32 v65, v67
    buffer_load_dwordx4 v50, s[16:19], s24 offen offset:2048 lds
    v_accvgpr_read_b32 v58, a10
    v_accvgpr_read_b32 v59, a11
    v_accvgpr_read_b32 v60, a12
    v_accvgpr_read_b32 v61, a13
    v_accvgpr_read_b32 v62, a14
    v_accvgpr_read_b32 v63, a15
    v_pk_mul_f32 v[56:57], s[60:61], v[56:57] op_sel_hi:[0,1]
    v_pk_mul_f32 v[58:59], s[60:61], v[58:59] op_sel_hi:[0,1]
    v_pk_mul_f32 v[60:61], s[60:61], v[60:61] op_sel_hi:[0,1]
    v_pk_mul_f32 v[62:63], s[60:61], v[62:63] op_sel_hi:[0,1]
    s_add_u32 m0, s96, 3072
    s_nop 0
    v_cvt_pk_bf16_f32 v68, v56, v57
    v_cvt_pk_bf16_f32 v69, v58, v59
    v_cvt_pk_bf16_f32 v70, v60, v61
    v_cvt_pk_bf16_f32 v71, v62, v63
    v_accvgpr_read_b32 v56, a16
    v_accvgpr_read_b32 v57, a17
    v_permlane16_swap_b32 v68, v70
    v_permlane16_swap_b32 v69, v71
    v_accvgpr_read_b32 v58, a18
    v_accvgpr_read_b32 v59, a19
    buffer_load_dwordx4 v48, s[16:19], s25 offen offset:0 lds
    v_accvgpr_read_b32 v60, a20
    v_accvgpr_read_b32 v61, a21
    v_accvgpr_read_b32 v62, a22
    v_accvgpr_read_b32 v63, a23
    v_pk_mul_f32 v[56:57], s[60:61], v[56:57] op_sel_hi:[0,1]
    v_pk_mul_f32 v[58:59], s[60:61], v[58:59] op_sel_hi:[0,1]
    v_pk_mul_f32 v[60:61], s[60:61], v[60:61] op_sel_hi:[0,1]
    v_pk_mul_f32 v[62:63], s[60:61], v[62:63] op_sel_hi:[0,1]
    v_cvt_pk_bf16_f32 v72, v56, v57
    v_cvt_pk_bf16_f32 v73, v58, v59
    buffer_load_dwordx4 v49, s[16:19], s25 offen offset:1024 lds
    v_cvt_pk_bf16_f32 v74, v60, v61
    v_cvt_pk_bf16_f32 v75, v62, v63
    v_accvgpr_read_b32 v56, a24
    v_accvgpr_read_b32 v57, a25
    v_permlane16_swap_b32 v72, v74
    v_permlane16_swap_b32 v73, v75
    v_accvgpr_read_b32 v58, a26
    v_accvgpr_read_b32 v59, a27
    v_accvgpr_read_b32 v60, a28
    v_accvgpr_read_b32 v61, a29
    buffer_load_dwordx4 v50, s[16:19], s25 offen offset:2048 lds
    v_accvgpr_read_b32 v62, a30
    v_accvgpr_read_b32 v63, a31
    v_pk_mul_f32 v[56:57], s[60:61], v[56:57] op_sel_hi:[0,1]
    v_pk_mul_f32 v[58:59], s[60:61], v[58:59] op_sel_hi:[0,1]
    v_pk_mul_f32 v[60:61], s[60:61], v[60:61] op_sel_hi:[0,1]
    v_pk_mul_f32 v[62:63], s[60:61], v[62:63] op_sel_hi:[0,1]
    v_cvt_pk_bf16_f32 v76, v56, v57
    v_cvt_pk_bf16_f32 v77, v58, v59
    v_cvt_pk_bf16_f32 v78, v60, v61
    v_cvt_pk_bf16_f32 v79, v62, v63
    s_nop 1
    v_permlane16_swap_b32 v76, v78
    v_permlane16_swap_b32 v77, v79
    v_pk_mul_f32 v[128:129], v[128:129], v[28:29] op_sel_hi:[1,0]
    v_pk_mul_f32 v[130:131], v[130:131], v[28:29] op_sel_hi:[1,0]
    v_pk_mul_f32 v[132:133], v[132:133], v[28:29] op_sel_hi:[1,0]
    v_pk_mul_f32 v[134:135], v[134:135], v[28:29] op_sel_hi:[1,0]
    v_cvt_pk_bf16_f32 v128, v128, v129
    v_cvt_pk_bf16_f32 v129, v130, v131
    v_cvt_pk_bf16_f32 v130, v132, v133
    v_cvt_pk_bf16_f32 v131, v134, v135
    v_accvgpr_write_b32 a0, v128
    v_accvgpr_write_b32 a1, v129
    v_accvgpr_write_b32 a2, v130
    v_accvgpr_write_b32 a3, v131
    v_pk_mul_f32 v[136:137], v[136:137], v[28:29] op_sel_hi:[1,0]
    v_pk_mul_f32 v[138:139], v[138:139], v[28:29] op_sel_hi:[1,0]
    v_pk_mul_f32 v[140:141], v[140:141], v[28:29] op_sel_hi:[1,0]
    v_pk_mul_f32 v[142:143], v[142:143], v[28:29] op_sel_hi:[1,0]
    v_cvt_pk_bf16_f32 v136, v136, v137
    v_cvt_pk_bf16_f32 v137, v138, v139
    v_cvt_pk_bf16_f32 v138, v140, v141
    v_cvt_pk_bf16_f32 v139, v142, v143
    v_accvgpr_write_b32 a4, v136
    v_accvgpr_write_b32 a5, v137
    v_accvgpr_write_b32 a6, v138
    v_accvgpr_write_b32 a7, v139
    v_pk_mul_f32 v[144:145], v[144:145], v[28:29] op_sel_hi:[1,0]
    v_pk_mul_f32 v[146:147], v[146:147], v[28:29] op_sel_hi:[1,0]
    v_pk_mul_f32 v[148:149], v[148:149], v[28:29] op_sel_hi:[1,0]
    v_pk_mul_f32 v[150:151], v[150:151], v[28:29] op_sel_hi:[1,0]
    v_cvt_pk_bf16_f32 v144, v144, v145
    v_cvt_pk_bf16_f32 v145, v146, v147
    v_cvt_pk_bf16_f32 v146, v148, v149
    v_cvt_pk_bf16_f32 v147, v150, v151
    v_accvgpr_write_b32 a8, v144
    v_accvgpr_write_b32 a9, v145
    v_accvgpr_write_b32 a10, v146
    v_accvgpr_write_b32 a11, v147
    v_pk_mul_f32 v[152:153], v[152:153], v[28:29] op_sel_hi:[1,0]
    v_pk_mul_f32 v[154:155], v[154:155], v[28:29] op_sel_hi:[1,0]
    v_pk_mul_f32 v[156:157], v[156:157], v[28:29] op_sel_hi:[1,0]
    v_pk_mul_f32 v[158:159], v[158:159], v[28:29] op_sel_hi:[1,0]
    v_cvt_pk_bf16_f32 v152, v152, v153
    v_cvt_pk_bf16_f32 v153, v154, v155
    v_cvt_pk_bf16_f32 v154, v156, v157
    v_cvt_pk_bf16_f32 v155, v158, v159
    v_accvgpr_write_b32 a12, v152
    v_accvgpr_write_b32 a13, v153
    v_accvgpr_write_b32 a14, v154
    v_accvgpr_write_b32 a15, v155
    s_nop 1
    v_mfma_f32_16x16x32_bf16 v[36:39], a[128:131], v[64:67], 0
    ds_read_b64_tr_b16 a[160:161], v5 offset:0
    ds_read_b64_tr_b16 a[162:163], v5 offset:4096
    v_accvgpr_read_b32 v56, a32
    v_mfma_f32_16x16x32_bf16 v[36:39], a[132:135], v[68:71], v[36:39]
    ds_read_b64_tr_b16 a[164:165], v6 offset:0
    ds_read_b64_tr_b16 a[166:167], v6 offset:4096
    v_accvgpr_read_b32 v57, a33
    v_mfma_f32_16x16x32_bf16 v[36:39], a[136:139], v[72:75], v[36:39]
    ds_read_b64_tr_b16 a[168:169], v7 offset:0
    ds_read_b64_tr_b16 a[170:171], v7 offset:4096
    v_accvgpr_read_b32 v58, a34
    v_mfma_f32_16x16x32_bf16 v[36:39], a[140:143], v[76:79], v[36:39]
    ds_read_b64_tr_b16 a[172:173], v8 offset:0
    ds_read_b64_tr_b16 a[174:175], v8 offset:4096
    v_accvgpr_read_b32 v59, a35
    v_mfma_f32_16x16x32_bf16 v[32:35], a[144:147], v[64:67], 0
    ds_read_b64_tr_b16 a[176:177], v9 offset:0
    ds_read_b64_tr_b16 a[178:179], v9 offset:4096
    v_accvgpr_read_b32 v60, a36
    v_mfma_f32_16x16x32_bf16 v[32:35], a[148:151], v[68:71], v[32:35]
    ds_read_b64_tr_b16 a[180:181], v10 offset:0
    ds_read_b64_tr_b16 a[182:183], v10 offset:4096
    v_accvgpr_read_b32 v61, a37
    v_mfma_f32_16x16x32_bf16 v[32:35], a[152:155], v[72:75], v[32:35]
    v_accvgpr_read_b32 v62, a38
    v_accvgpr_read_b32 v63, a39
    v_pk_mul_f32 v[56:57], s[60:61], v[56:57] op_sel_hi:[0,1]
    v_pk_mul_f32 v[58:59], s[60:61], v[58:59] op_sel_hi:[0,1]
    v_pk_mul_f32 v[60:61], s[60:61], v[60:61] op_sel_hi:[0,1]
    v_pk_mul_f32 v[62:63], s[60:61], v[62:63] op_sel_hi:[0,1]
    v_cvt_pk_bf16_f32 v80, v56, v57
    v_cvt_pk_bf16_f32 v81, v58, v59
    v_cvt_pk_bf16_f32 v82, v60, v61
    v_cvt_pk_bf16_f32 v83, v62, v63
    v_accvgpr_read_b32 v56, a40
    v_accvgpr_read_b32 v57, a41
    v_permlane16_swap_b32 v80, v82
    v_permlane16_swap_b32 v81, v83
    v_accvgpr_read_b32 v58, a42
    v_accvgpr_read_b32 v59, a43
    v_accvgpr_read_b32 v60, a44
    v_accvgpr_read_b32 v61, a45
    v_accvgpr_read_b32 v62, a46
    v_accvgpr_read_b32 v63, a47
    v_pk_mul_f32 v[56:57], s[60:61], v[56:57] op_sel_hi:[0,1]
    v_pk_mul_f32 v[58:59], s[60:61], v[58:59] op_sel_hi:[0,1]
    v_pk_mul_f32 v[60:61], s[60:61], v[60:61] op_sel_hi:[0,1]
    v_pk_mul_f32 v[62:63], s[60:61], v[62:63] op_sel_hi:[0,1]
    v_cvt_pk_bf16_f32 v84, v56, v57
    v_cvt_pk_bf16_f32 v85, v58, v59
    v_cvt_pk_bf16_f32 v86, v60, v61
    v_cvt_pk_bf16_f32 v87, v62, v63
    v_accvgpr_read_b32 v56, a48
    v_accvgpr_read_b32 v57, a49
    v_permlane16_swap_b32 v84, v86
    v_permlane16_swap_b32 v85, v87
    v_accvgpr_read_b32 v58, a50
    v_accvgpr_read_b32 v59, a51
    v_accvgpr_read_b32 v60, a52
    v_accvgpr_read_b32 v61, a53
    v_accvgpr_read_b32 v62, a54
    v_accvgpr_read_b32 v63, a55
    v_pk_mul_f32 v[56:57], s[60:61], v[56:57] op_sel_hi:[0,1]
    v_pk_mul_f32 v[58:59], s[60:61], v[58:59] op_sel_hi:[0,1]
    v_pk_mul_f32 v[60:61], s[60:61], v[60:61] op_sel_hi:[0,1]
    v_pk_mul_f32 v[62:63], s[60:61], v[62:63] op_sel_hi:[0,1]
    v_cvt_pk_bf16_f32 v88, v56, v57
    v_cvt_pk_bf16_f32 v89, v58, v59
    v_cvt_pk_bf16_f32 v90, v60, v61
    v_cvt_pk_bf16_f32 v91, v62, v63
    v_accvgpr_read_b32 v56, a56
    v_accvgpr_read_b32 v57, a57
    v_permlane16_swap_b32 v88, v90
    v_permlane16_swap_b32 v89, v91
    v_accvgpr_read_b32 v58, a58
    v_accvgpr_read_b32 v59, a59
    v_accvgpr_read_b32 v60, a60
    v_accvgpr_read_b32 v61, a61
    v_accvgpr_read_b32 v62, a62
    v_accvgpr_read_b32 v63, a63
    v_pk_mul_f32 v[56:57], s[60:61], v[56:57] op_sel_hi:[0,1]
    v_pk_mul_f32 v[58:59], s[60:61], v[58:59] op_sel_hi:[0,1]
    v_pk_mul_f32 v[60:61], s[60:61], v[60:61] op_sel_hi:[0,1]
    v_pk_mul_f32 v[62:63], s[60:61], v[62:63] op_sel_hi:[0,1]
    v_cvt_pk_bf16_f32 v92, v56, v57
    v_cvt_pk_bf16_f32 v93, v58, v59
    v_cvt_pk_bf16_f32 v94, v60, v61
    v_cvt_pk_bf16_f32 v95, v62, v63
    s_nop 1
    v_permlane16_swap_b32 v92, v94
    v_permlane16_swap_b32 v93, v95
    ds_read_b64_tr_b16 a[184:185], v11 offset:0
    ds_read_b64_tr_b16 a[186:187], v11 offset:4096
    v_mfma_f32_16x16x32_bf16 v[32:35], a[156:159], v[76:79], v[32:35]
    ds_read_b64_tr_b16 a[188:189], v12 offset:0
    ds_read_b64_tr_b16 a[190:191], v12 offset:4096
    v_mfma_f32_16x16x32_bf16 v[40:43], a[128:131], v[80:83], 0
    v_accvgpr_read_b32 v56, a64
    v_accvgpr_read_b32 v57, a65
    v_mfma_f32_16x16x32_bf16 v[40:43], a[132:135], v[84:87], v[40:43]
    v_accvgpr_read_b32 v58, a66
    v_accvgpr_read_b32 v59, a67
    v_mfma_f32_16x16x32_bf16 v[40:43], a[136:139], v[88:91], v[40:43]
    v_accvgpr_read_b32 v60, a68
    v_accvgpr_read_b32 v61, a69
    v_mfma_f32_16x16x32_bf16 v[40:43], a[140:143], v[92:95], v[40:43]
    v_accvgpr_read_b32 v62, a70
    v_accvgpr_read_b32 v63, a71
    v_mfma_f32_16x16x32_bf16 v[44:47], a[144:147], v[80:83], 0
    v_pk_mul_f32 v[56:57], s[60:61], v[56:57] op_sel_hi:[0,1]
    v_mfma_f32_16x16x32_bf16 v[44:47], a[148:151], v[84:87], v[44:47]
    v_pk_mul_f32 v[58:59], s[60:61], v[58:59] op_sel_hi:[0,1]
    v_mfma_f32_16x16x32_bf16 v[44:47], a[152:155], v[88:91], v[44:47]
    v_pk_mul_f32 v[60:61], s[60:61], v[60:61] op_sel_hi:[0,1]
    v_pk_mul_f32 v[62:63], s[60:61], v[62:63] op_sel_hi:[0,1]
    v_cvt_pk_bf16_f32 v96, v56, v57
    v_cvt_pk_bf16_f32 v97, v58, v59
    v_cvt_pk_bf16_f32 v98, v60, v61
    v_cvt_pk_bf16_f32 v99, v62, v63
    v_accvgpr_read_b32 v56, a72
    v_accvgpr_read_b32 v57, a73
    v_permlane16_swap_b32 v96, v98
    v_permlane16_swap_b32 v97, v99
    v_accvgpr_read_b32 v58, a74
    v_accvgpr_read_b32 v59, a75
    v_accvgpr_read_b32 v60, a76
    v_accvgpr_read_b32 v61, a77
    v_accvgpr_read_b32 v62, a78
    v_accvgpr_read_b32 v63, a79
    v_pk_mul_f32 v[56:57], s[60:61], v[56:57] op_sel_hi:[0,1]
    v_pk_mul_f32 v[58:59], s[60:61], v[58:59] op_sel_hi:[0,1]
    v_pk_mul_f32 v[60:61], s[60:61], v[60:61] op_sel_hi:[0,1]
    v_pk_mul_f32 v[62:63], s[60:61], v[62:63] op_sel_hi:[0,1]
    v_cvt_pk_bf16_f32 v100, v56, v57
    v_cvt_pk_bf16_f32 v101, v58, v59
    v_cvt_pk_bf16_f32 v102, v60, v61
    v_cvt_pk_bf16_f32 v103, v62, v63
    v_accvgpr_read_b32 v56, a80
    v_accvgpr_read_b32 v57, a81
    v_permlane16_swap_b32 v100, v102
    v_permlane16_swap_b32 v101, v103
    v_accvgpr_read_b32 v58, a82
    v_accvgpr_read_b32 v59, a83
    v_accvgpr_read_b32 v60, a84
    v_accvgpr_read_b32 v61, a85
    v_accvgpr_read_b32 v62, a86
    v_accvgpr_read_b32 v63, a87
    v_pk_mul_f32 v[56:57], s[60:61], v[56:57] op_sel_hi:[0,1]
    v_pk_mul_f32 v[58:59], s[60:61], v[58:59] op_sel_hi:[0,1]
    v_pk_mul_f32 v[60:61], s[60:61], v[60:61] op_sel_hi:[0,1]
    v_pk_mul_f32 v[62:63], s[60:61], v[62:63] op_sel_hi:[0,1]
    v_cvt_pk_bf16_f32 v104, v56, v57
    v_cvt_pk_bf16_f32 v105, v58, v59
    v_cvt_pk_bf16_f32 v106, v60, v61
    v_cvt_pk_bf16_f32 v107, v62, v63
    v_accvgpr_read_b32 v56, a88
    v_accvgpr_read_b32 v57, a89
    v_permlane16_swap_b32 v104, v106
    v_permlane16_swap_b32 v105, v107
    v_accvgpr_read_b32 v58, a90
    v_accvgpr_read_b32 v59, a91
    v_accvgpr_read_b32 v60, a92
    v_accvgpr_read_b32 v61, a93
    v_accvgpr_read_b32 v62, a94
    v_accvgpr_read_b32 v63, a95
    v_pk_mul_f32 v[56:57], s[60:61], v[56:57] op_sel_hi:[0,1]
    v_pk_mul_f32 v[58:59], s[60:61], v[58:59] op_sel_hi:[0,1]
    v_pk_mul_f32 v[60:61], s[60:61], v[60:61] op_sel_hi:[0,1]
    v_pk_mul_f32 v[62:63], s[60:61], v[62:63] op_sel_hi:[0,1]
    v_cvt_pk_bf16_f32 v108, v56, v57
    v_cvt_pk_bf16_f32 v109, v58, v59
    v_cvt_pk_bf16_f32 v110, v60, v61
    v_cvt_pk_bf16_f32 v111, v62, v63
    s_nop 1
    v_permlane16_swap_b32 v108, v110
    v_permlane16_swap_b32 v109, v111
    v_mfma_f32_16x16x32_bf16 v[44:47], a[156:159], v[92:95], v[44:47]
    s_xor_b32 s13, s82, s31
    s_add_u32 m0, s83, 65536
    v_mfma_f32_16x16x32_bf16 v[52:55], a[128:131], v[96:99], 0
    buffer_load_dwordx4 v17, s[36:39], s13 offen offset:0 nt lds
    v_mfma_f32_16x16x32_bf16 v[52:55], a[132:135], v[100:103], v[52:55]
    v_accvgpr_read_b32 v56, a96
    v_accvgpr_read_b32 v57, a97
    v_mfma_f32_16x16x32_bf16 v[52:55], a[136:139], v[104:107], v[52:55]
    v_accvgpr_read_b32 v58, a98
    v_accvgpr_read_b32 v59, a99
    v_mfma_f32_16x16x32_bf16 v[52:55], a[140:143], v[108:111], v[52:55]
    v_accvgpr_read_b32 v60, a100
    v_accvgpr_read_b32 v61, a101
    v_mfma_f32_16x16x32_bf16 v[48:51], a[144:147], v[96:99], 0
    buffer_load_dwordx4 v18, s[36:39], s13 offen offset:1024 nt lds
    v_mfma_f32_16x16x32_bf16 v[48:51], a[148:151], v[100:103], v[48:51]
    v_accvgpr_read_b32 v62, a102
    v_accvgpr_read_b32 v63, a103
    v_mfma_f32_16x16x32_bf16 v[48:51], a[152:155], v[104:107], v[48:51]
    v_pk_mul_f32 v[56:57], s[60:61], v[56:57] op_sel_hi:[0,1]
    v_pk_mul_f32 v[58:59], s[60:61], v[58:59] op_sel_hi:[0,1]
    v_pk_mul_f32 v[60:61], s[60:61], v[60:61] op_sel_hi:[0,1]
    v_pk_mul_f32 v[62:63], s[60:61], v[62:63] op_sel_hi:[0,1]
    v_cvt_pk_bf16_f32 v112, v56, v57
    v_cvt_pk_bf16_f32 v113, v58, v59
    v_cvt_pk_bf16_f32 v114, v60, v61
    v_cvt_pk_bf16_f32 v115, v62, v63
    v_accvgpr_read_b32 v56, a104
    v_accvgpr_read_b32 v57, a105
    v_permlane16_swap_b32 v112, v114
    v_permlane16_swap_b32 v113, v115
    v_accvgpr_read_b32 v58, a106
    v_accvgpr_read_b32 v59, a107
    v_accvgpr_read_b32 v60, a108
    v_accvgpr_read_b32 v61, a109
    v_accvgpr_read_b32 v62, a110
    v_accvgpr_read_b32 v63, a111
    v_pk_mul_f32 v[56:57], s[60:61], v[56:57] op_sel_hi:[0,1]
    v_pk_mul_f32 v[58:59], s[60:61], v[58:59] op_sel_hi:[0,1]
    v_pk_mul_f32 v[60:61], s[60:61], v[60:61] op_sel_hi:[0,1]
    v_pk_mul_f32 v[62:63], s[60:61], v[62:63] op_sel_hi:[0,1]
    v_cvt_pk_bf16_f32 v116, v56, v57
    v_cvt_pk_bf16_f32 v117, v58, v59
    v_cvt_pk_bf16_f32 v118, v60, v61
    v_cvt_pk_bf16_f32 v119, v62, v63
    v_accvgpr_read_b32 v56, a112
    v_accvgpr_read_b32 v57, a113
    v_permlane16_swap_b32 v116, v118
    v_permlane16_swap_b32 v117, v119
    v_accvgpr_read_b32 v58, a114
    v_accvgpr_read_b32 v59, a115
    v_accvgpr_read_b32 v60, a116
    v_accvgpr_read_b32 v61, a117
    v_accvgpr_read_b32 v62, a118
    v_accvgpr_read_b32 v63, a119
    v_pk_mul_f32 v[56:57], s[60:61], v[56:57] op_sel_hi:[0,1]
    v_pk_mul_f32 v[58:59], s[60:61], v[58:59] op_sel_hi:[0,1]
    v_pk_mul_f32 v[60:61], s[60:61], v[60:61] op_sel_hi:[0,1]
    v_pk_mul_f32 v[62:63], s[60:61], v[62:63] op_sel_hi:[0,1]
    v_cvt_pk_bf16_f32 v120, v56, v57
    v_cvt_pk_bf16_f32 v121, v58, v59
    v_cvt_pk_bf16_f32 v122, v60, v61
    v_cvt_pk_bf16_f32 v123, v62, v63
    v_accvgpr_read_b32 v56, a120
    v_accvgpr_read_b32 v57, a121
    v_permlane16_swap_b32 v120, v122
    v_permlane16_swap_b32 v121, v123
    v_accvgpr_read_b32 v58, a122
    v_accvgpr_read_b32 v59, a123
    v_accvgpr_read_b32 v60, a124
    v_accvgpr_read_b32 v61, a125
    v_accvgpr_read_b32 v62, a126
    v_accvgpr_read_b32 v63, a127
    v_pk_mul_f32 v[56:57], s[60:61], v[56:57] op_sel_hi:[0,1]
    v_pk_mul_f32 v[58:59], s[60:61], v[58:59] op_sel_hi:[0,1]
    v_pk_mul_f32 v[60:61], s[60:61], v[60:61] op_sel_hi:[0,1]
    v_pk_mul_f32 v[62:63], s[60:61], v[62:63] op_sel_hi:[0,1]
    v_cvt_pk_bf16_f32 v124, v56, v57
    v_cvt_pk_bf16_f32 v125, v58, v59
    v_cvt_pk_bf16_f32 v126, v60, v61
    v_cvt_pk_bf16_f32 v127, v62, v63
    s_nop 1
    v_permlane16_swap_b32 v124, v126
    v_permlane16_swap_b32 v125, v127
    v_mfma_f32_16x16x32_bf16 v[48:51], a[156:159], v[108:111], v[48:51]
    v_exp_f32 v36, v36
    v_mfma_f32_16x16x32_bf16 v[56:59], a[128:131], v[112:115], v[20:23]
    v_exp_f32 v37, v37
    v_mfma_f32_16x16x32_bf16 v[56:59], a[132:135], v[116:119], v[56:59]
    v_exp_f32 v38, v38
    v_mfma_f32_16x16x32_bf16 v[56:59], a[136:139], v[120:123], v[56:59]
    v_exp_f32 v39, v39
    v_mfma_f32_16x16x32_bf16 v[56:59], a[140:143], v[124:127], v[56:59]
    v_exp_f32 v32, v32
    v_mfma_f32_16x16x32_bf16 v[60:63], a[144:147], v[112:115], v[20:23]
    v_exp_f32 v33, v33
    v_exp_f32 v34, v34
    v_exp_f32 v35, v35
    v_mfma_f32_16x16x32_bf16 v[60:63], a[148:151], v[116:119], v[60:63]
    v_cvt_pk_bf16_f32 v36, v36, v37
    v_cvt_pk_bf16_f32 v37, v38, v39
    v_cvt_pk_bf16_f32 v38, v32, v33
    v_cvt_pk_bf16_f32 v39, v34, v35
    v_mfma_f32_16x16x32_bf16 v[60:63], a[152:155], v[120:123], v[60:63]
    v_exp_f32 v40, v40
    v_mfma_f32_16x16x32_bf16 v[60:63], a[156:159], v[124:127], v[60:63]
    s_waitcnt lgkmcnt(0)
    v_mfma_f32_16x16x32_bf16 v[128:131], a[160:163], v[36:39], 0
    v_exp_f32 v41, v41
    v_mfma_f32_16x16x32_bf16 v[132:135], a[164:167], v[36:39], 0
    v_exp_f32 v42, v42
    v_mfma_f32_16x16x32_bf16 v[136:139], a[168:171], v[36:39], 0
    v_exp_f32 v43, v43
    v_mfma_f32_16x16x32_bf16 v[140:143], a[172:175], v[36:39], 0
    v_exp_f32 v44, v44
    v_mfma_f32_16x16x32_bf16 v[144:147], a[176:179], v[36:39], 0
    v_exp_f32 v45, v45
    v_exp_f32 v46, v46
    v_exp_f32 v47, v47
    v_mfma_f32_16x16x32_bf16 v[148:151], a[180:183], v[36:39], 0
    v_pk_mul_f32 v[160:161], v[160:161], v[28:29] op_sel:[0,1]
    v_pk_mul_f32 v[162:163], v[162:163], v[28:29] op_sel:[0,1]
    v_pk_mul_f32 v[164:165], v[164:165], v[28:29] op_sel:[0,1]
    v_pk_mul_f32 v[166:167], v[166:167], v[28:29] op_sel:[0,1]
    v_cvt_pk_bf16_f32 v160, v160, v161
    v_cvt_pk_bf16_f32 v161, v162, v163
    v_cvt_pk_bf16_f32 v162, v164, v165
    v_cvt_pk_bf16_f32 v163, v166, v167
    v_accvgpr_write_b32 a32, v160
    v_accvgpr_write_b32 a33, v161
    v_accvgpr_write_b32 a34, v162
    v_accvgpr_write_b32 a35, v163
    v_pk_mul_f32 v[168:169], v[168:169], v[28:29] op_sel:[0,1]
    v_pk_mul_f32 v[170:171], v[170:171], v[28:29] op_sel:[0,1]
    v_pk_mul_f32 v[172:173], v[172:173], v[28:29] op_sel:[0,1]
    v_pk_mul_f32 v[174:175], v[174:175], v[28:29] op_sel:[0,1]
    v_cvt_pk_bf16_f32 v168, v168, v169
    v_cvt_pk_bf16_f32 v169, v170, v171
    v_cvt_pk_bf16_f32 v170, v172, v173
    v_cvt_pk_bf16_f32 v171, v174, v175
    v_accvgpr_write_b32 a36, v168
    v_accvgpr_write_b32 a37, v169
    v_accvgpr_write_b32 a38, v170
    v_accvgpr_write_b32 a39, v171
    v_pk_mul_f32 v[176:177], v[176:177], v[28:29] op_sel:[0,1]
    v_pk_mul_f32 v[178:179], v[178:179], v[28:29] op_sel:[0,1]
    v_pk_mul_f32 v[180:181], v[180:181], v[28:29] op_sel:[0,1]
    v_pk_mul_f32 v[182:183], v[182:183], v[28:29] op_sel:[0,1]
    v_cvt_pk_bf16_f32 v176, v176, v177
    v_cvt_pk_bf16_f32 v177, v178, v179
    v_cvt_pk_bf16_f32 v178, v180, v181
    v_cvt_pk_bf16_f32 v179, v182, v183
    v_accvgpr_write_b32 a40, v176
    v_accvgpr_write_b32 a41, v177
    v_accvgpr_write_b32 a42, v178
    v_accvgpr_write_b32 a43, v179
    v_pk_mul_f32 v[184:185], v[184:185], v[28:29] op_sel:[0,1]
    v_pk_mul_f32 v[186:187], v[186:187], v[28:29] op_sel:[0,1]
    v_pk_mul_f32 v[188:189], v[188:189], v[28:29] op_sel:[0,1]
    v_pk_mul_f32 v[190:191], v[190:191], v[28:29] op_sel:[0,1]
    v_cvt_pk_bf16_f32 v184, v184, v185
    v_cvt_pk_bf16_f32 v185, v186, v187
    v_cvt_pk_bf16_f32 v186, v188, v189
    v_cvt_pk_bf16_f32 v187, v190, v191
    v_accvgpr_write_b32 a44, v184
    v_accvgpr_write_b32 a45, v185
    v_accvgpr_write_b32 a46, v186
    v_accvgpr_write_b32 a47, v187
    v_cvt_pk_bf16_f32 v40, v40, v41
    v_cvt_pk_bf16_f32 v41, v42, v43
    v_cvt_pk_bf16_f32 v42, v44, v45
    v_cvt_pk_bf16_f32 v43, v46, v47
    ds_read_b128 a[128:131], v1 offset:8192
    ds_read_b128 a[132:135], v2 offset:8192
    v_mfma_f32_16x16x32_bf16 v[152:155], a[184:187], v[36:39], 0
    v_exp_f32 v52, v52
    v_mfma_f32_16x16x32_bf16 v[156:159], a[188:191], v[36:39], 0
    v_exp_f32 v53, v53
    v_smfmac_f32_16x16x64_bf16 a[224:227], a[232:235], v[36:43], v19
    v_exp_f32 v54, v54
    v_mfma_f32_16x16x32_bf16 v[160:163], a[160:163], v[40:43], 0
    buffer_load_dwordx4 v17, s[36:39], s13 offen offset:2048 nt lds
    v_mfma_f32_16x16x32_bf16 v[164:167], a[164:167], v[40:43], 0
    v_exp_f32 v55, v55
    v_mfma_f32_16x16x32_bf16 v[168:171], a[168:171], v[40:43], 0
    v_exp_f32 v48, v48
    v_mfma_f32_16x16x32_bf16 v[172:175], a[172:175], v[40:43], 0
    v_exp_f32 v49, v49
    v_exp_f32 v50, v50
    v_mfma_f32_16x16x32_bf16 v[176:179], a[176:179], v[40:43], 0
    v_exp_f32 v51, v51
    buffer_load_dwordx4 v18, s[36:39], s13 offen offset:3072 nt lds
    v_mfma_f32_16x16x32_bf16 v[180:183], a[180:183], v[40:43], 0
    v_pk_mul_f32 v[192:193], v[192:193], v[30:31] op_sel_hi:[1,0]
    v_pk_mul_f32 v[194:195], v[194:195], v[30:31] op_sel_hi:[1,0]
    v_pk_mul_f32 v[196:197], v[196:197], v[30:31] op_sel_hi:[1,0]
    v_pk_mul_f32 v[198:199], v[198:199], v[30:31] op_sel_hi:[1,0]
    v_cvt_pk_bf16_f32 v192, v192, v193
    v_cvt_pk_bf16_f32 v193, v194, v195
    v_cvt_pk_bf16_f32 v194, v196, v197
    v_cvt_pk_bf16_f32 v195, v198, v199
    v_accvgpr_write_b32 a64, v192
    v_accvgpr_write_b32 a65, v193
    v_accvgpr_write_b32 a66, v194
    v_accvgpr_write_b32 a67, v195
    v_pk_mul_f32 v[200:201], v[200:201], v[30:31] op_sel_hi:[1,0]
    v_pk_mul_f32 v[202:203], v[202:203], v[30:31] op_sel_hi:[1,0]
    v_pk_mul_f32 v[204:205], v[204:205], v[30:31] op_sel_hi:[1,0]
    v_pk_mul_f32 v[206:207], v[206:207], v[30:31] op_sel_hi:[1,0]
    v_cvt_pk_bf16_f32 v200, v200, v201
    v_cvt_pk_bf16_f32 v201, v202, v203
    v_cvt_pk_bf16_f32 v202, v204, v205
    v_cvt_pk_bf16_f32 v203, v206, v207
    v_accvgpr_write_b32 a68, v200
    v_accvgpr_write_b32 a69, v201
    v_accvgpr_write_b32 a70, v202
    v_accvgpr_write_b32 a71, v203
    v_pk_mul_f32 v[208:209], v[208:209], v[30:31] op_sel_hi:[1,0]
    v_pk_mul_f32 v[210:211], v[210:211], v[30:31] op_sel_hi:[1,0]
    v_pk_mul_f32 v[212:213], v[212:213], v[30:31] op_sel_hi:[1,0]
    v_pk_mul_f32 v[214:215], v[214:215], v[30:31] op_sel_hi:[1,0]
    v_cvt_pk_bf16_f32 v208, v208, v209
    v_cvt_pk_bf16_f32 v209, v210, v211
    v_cvt_pk_bf16_f32 v210, v212, v213
    v_cvt_pk_bf16_f32 v211, v214, v215
    v_accvgpr_write_b32 a72, v208
    v_accvgpr_write_b32 a73, v209
    v_accvgpr_write_b32 a74, v210
    v_accvgpr_write_b32 a75, v211
    v_pk_mul_f32 v[216:217], v[216:217], v[30:31] op_sel_hi:[1,0]
    v_pk_mul_f32 v[218:219], v[218:219], v[30:31] op_sel_hi:[1,0]
    v_pk_mul_f32 v[220:221], v[220:221], v[30:31] op_sel_hi:[1,0]
    v_pk_mul_f32 v[222:223], v[222:223], v[30:31] op_sel_hi:[1,0]
    v_cvt_pk_bf16_f32 v216, v216, v217
    v_cvt_pk_bf16_f32 v217, v218, v219
    v_cvt_pk_bf16_f32 v218, v220, v221
    v_cvt_pk_bf16_f32 v219, v222, v223
    v_accvgpr_write_b32 a76, v216
    v_accvgpr_write_b32 a77, v217
    v_accvgpr_write_b32 a78, v218
    v_accvgpr_write_b32 a79, v219
    v_cvt_pk_bf16_f32 v52, v52, v53
    v_cvt_pk_bf16_f32 v53, v54, v55
    v_cvt_pk_bf16_f32 v54, v48, v49
    v_cvt_pk_bf16_f32 v55, v50, v51
    ds_read_b128 a[136:139], v3 offset:8192
    ds_read_b128 a[140:143], v4 offset:8192
    v_mfma_f32_16x16x32_bf16 v[184:187], a[184:187], v[40:43], 0
    ds_read_b128 a[144:147], v1 offset:12288
    ds_read_b128 a[148:151], v2 offset:12288
    v_mfma_f32_16x16x32_bf16 v[188:191], a[188:191], v[40:43], 0
    v_exp_f32 v56, v56
    v_mfma_f32_16x16x32_bf16 v[192:195], a[160:163], v[52:55], 0
    v_exp_f32 v57, v57
    v_mfma_f32_16x16x32_bf16 v[196:199], a[164:167], v[52:55], 0
    v_exp_f32 v58, v58
    v_mfma_f32_16x16x32_bf16 v[200:203], a[168:171], v[52:55], 0
    v_exp_f32 v59, v59
    v_mfma_f32_16x16x32_bf16 v[204:207], a[172:175], v[52:55], 0
    v_exp_f32 v60, v60
    v_mfma_f32_16x16x32_bf16 v[208:211], a[176:179], v[52:55], 0
    v_exp_f32 v61, v61
    v_exp_f32 v62, v62
    v_exp_f32 v63, v63
    v_mfma_f32_16x16x32_bf16 v[212:215], a[180:183], v[52:55], 0
    v_pk_mul_f32 v[224:225], v[224:225], v[30:31] op_sel:[0,1]
    v_pk_mul_f32 v[226:227], v[226:227], v[30:31] op_sel:[0,1]
    v_pk_mul_f32 v[228:229], v[228:229], v[30:31] op_sel:[0,1]
    v_pk_mul_f32 v[230:231], v[230:231], v[30:31] op_sel:[0,1]
    v_cvt_pk_bf16_f32 v224, v224, v225
    v_cvt_pk_bf16_f32 v225, v226, v227
    v_cvt_pk_bf16_f32 v226, v228, v229
    v_cvt_pk_bf16_f32 v227, v230, v231
    v_accvgpr_write_b32 a96, v224
    v_accvgpr_write_b32 a97, v225
    v_accvgpr_write_b32 a98, v226
    v_accvgpr_write_b32 a99, v227
    v_pk_mul_f32 v[232:233], v[232:233], v[30:31] op_sel:[0,1]
    v_pk_mul_f32 v[234:235], v[234:235], v[30:31] op_sel:[0,1]
    v_pk_mul_f32 v[236:237], v[236:237], v[30:31] op_sel:[0,1]
    v_pk_mul_f32 v[238:239], v[238:239], v[30:31] op_sel:[0,1]
    v_cvt_pk_bf16_f32 v232, v232, v233
    v_cvt_pk_bf16_f32 v233, v234, v235
    v_cvt_pk_bf16_f32 v234, v236, v237
    v_cvt_pk_bf16_f32 v235, v238, v239
    v_accvgpr_write_b32 a100, v232
    v_accvgpr_write_b32 a101, v233
    v_accvgpr_write_b32 a102, v234
    v_accvgpr_write_b32 a103, v235
    v_pk_mul_f32 v[240:241], v[240:241], v[30:31] op_sel:[0,1]
    v_pk_mul_f32 v[242:243], v[242:243], v[30:31] op_sel:[0,1]
    v_pk_mul_f32 v[244:245], v[244:245], v[30:31] op_sel:[0,1]
    v_pk_mul_f32 v[246:247], v[246:247], v[30:31] op_sel:[0,1]
    v_cvt_pk_bf16_f32 v240, v240, v241
    v_cvt_pk_bf16_f32 v241, v242, v243
    v_cvt_pk_bf16_f32 v242, v244, v245
    v_cvt_pk_bf16_f32 v243, v246, v247
    v_accvgpr_write_b32 a104, v240
    v_accvgpr_write_b32 a105, v241
    v_accvgpr_write_b32 a106, v242
    v_accvgpr_write_b32 a107, v243
    v_pk_mul_f32 v[248:249], v[248:249], v[30:31] op_sel:[0,1]
    v_pk_mul_f32 v[250:251], v[250:251], v[30:31] op_sel:[0,1]
    v_pk_mul_f32 v[252:253], v[252:253], v[30:31] op_sel:[0,1]
    v_pk_mul_f32 v[254:255], v[254:255], v[30:31] op_sel:[0,1]
    v_cvt_pk_bf16_f32 v248, v248, v249
    v_cvt_pk_bf16_f32 v249, v250, v251
    v_cvt_pk_bf16_f32 v250, v252, v253
    v_cvt_pk_bf16_f32 v251, v254, v255
    v_accvgpr_write_b32 a108, v248
    v_accvgpr_write_b32 a109, v249
    v_accvgpr_write_b32 a110, v250
    v_accvgpr_write_b32 a111, v251
    v_cvt_pk_bf16_f32 v56, v56, v57
    v_cvt_pk_bf16_f32 v57, v58, v59
    v_cvt_pk_bf16_f32 v58, v60, v61
    v_cvt_pk_bf16_f32 v59, v62, v63
    v_mfma_f32_16x16x32_bf16 v[216:219], a[184:187], v[52:55], 0
    ds_read_b128 a[152:155], v3 offset:12288
    ds_read_b128 a[156:159], v4 offset:12288
    v_mfma_f32_16x16x32_bf16 v[220:223], a[188:191], v[52:55], 0
    s_xor_b32 s83, s83, s84
    s_xor_b32 s84, s84, 49152
    v_smfmac_f32_16x16x64_bf16 a[228:231], a[232:235], v[52:59], v19
    s_add_u32 s99, s99, 4096
    s_add_u32 s100, s100, 4096
    v_mfma_f32_16x16x32_bf16 v[224:227], a[160:163], v[56:59], 0
    v_accvgpr_read_b32 v31, a239
    s_waitcnt vmcnt(4)
    v_mfma_f32_16x16x32_bf16 v[228:231], a[164:167], v[56:59], 0
    ds_read_b64_tr_b16 a[192:193], v31 offset:0
    ds_read_b64_tr_b16 a[194:195], v31 offset:1536
    v_mfma_f32_16x16x32_bf16 v[232:235], a[168:171], v[56:59], 0
    s_sub_u32 s82, s82, 4294734848
    s_and_b32 s82, s82, 4294734848
    v_mfma_f32_16x16x32_bf16 v[236:239], a[172:175], v[56:59], 0
    ds_read_b64_tr_b16 a[196:197], v31 offset:8
    ds_read_b64_tr_b16 a[198:199], v31 offset:1544
    v_mfma_f32_16x16x32_bf16 v[240:243], a[176:179], v[56:59], 0
    ds_read_b64_tr_b16 a[200:201], v31 offset:16
    ds_read_b64_tr_b16 a[202:203], v31 offset:1552
    v_mfma_f32_16x16x32_bf16 v[244:247], a[180:183], v[56:59], 0
    ds_read_b64_tr_b16 a[204:205], v31 offset:3072
    ds_read_b64_tr_b16 a[206:207], v31 offset:4608
    v_mfma_f32_16x16x32_bf16 v[248:251], a[184:187], v[56:59], 0
    ds_read_b64_tr_b16 a[208:209], v31 offset:3080
    ds_read_b64_tr_b16 a[210:211], v31 offset:4616
    v_mfma_f32_16x16x32_bf16 v[252:255], a[188:191], v[56:59], 0
    ds_read_b64_tr_b16 a[212:213], v31 offset:3088
    ds_read_b64_tr_b16 a[214:215], v31 offset:4624
    v_accvgpr_read_b32 v28, a236
    v_accvgpr_read_b32 v29, a237
    v_accvgpr_read_b32 v30, a238
    s_waitcnt lgkmcnt(0)
    s_add_u32 m0, s96, 0
    s_nop 0
    buffer_load_dwordx4 v28, s[16:19], s26 offen offset:0 lds
    buffer_load_dwordx4 v29, s[16:19], s26 offen offset:1024 lds
    buffer_load_dwordx4 v30, s[16:19], s26 offen offset:2048 lds
    v_xor_b32 v1, s84, v1
    v_xor_b32 v2, s84, v2
    v_xor_b32 v3, s84, v3
    v_xor_b32 v4, s84, v4
    s_waitcnt lgkmcnt(0)
    s_cmp_eq_u32 s64, 3
    s_cbranch_scc1 L_atts
    s_branch L_att
L_last:
    v_mfma_f32_16x16x32_bf16 v[36:39], a[128:131], v[64:67], 0
    ds_read_b64_tr_b16 a[160:161], v5 offset:8192
    ds_read_b64_tr_b16 a[162:163], v5 offset:12288
    v_accvgpr_read_b32 v31, a239
    s_waitcnt vmcnt(63)
    v_mfma_f32_16x16x32_bf16 v[36:39], a[132:135], v[68:71], v[36:39]
    ds_read_b64_tr_b16 a[164:165], v6 offset:8192
    ds_read_b64_tr_b16 a[166:167], v6 offset:12288
    ds_read_b64_tr_b16 a[216:217], v31 offset:0
    ds_read_b64_tr_b16 a[218:219], v31 offset:1536
    v_mfma_f32_16x16x32_bf16 v[36:39], a[136:139], v[72:75], v[36:39]
    ds_read_b64_tr_b16 a[168:169], v7 offset:8192
    ds_read_b64_tr_b16 a[170:171], v7 offset:12288
    ds_read_b64_tr_b16 a[220:221], v31 offset:8
    ds_read_b64_tr_b16 a[222:223], v31 offset:1544
    v_mfma_f32_16x16x32_bf16 v[36:39], a[140:143], v[76:79], v[36:39]
    ds_read_b64_tr_b16 a[172:173], v8 offset:8192
    ds_read_b64_tr_b16 a[174:175], v8 offset:12288
    ds_read_b64_tr_b16 a[244:245], v31 offset:16
    ds_read_b64_tr_b16 a[246:247], v31 offset:1552
    v_mfma_f32_16x16x32_bf16 v[32:35], a[144:147], v[64:67], 0
    ds_read_b64_tr_b16 a[176:177], v9 offset:8192
    ds_read_b64_tr_b16 a[178:179], v9 offset:12288
    v_mfma_f32_16x16x32_bf16 v[32:35], a[148:151], v[68:71], v[32:35]
    ds_read_b64_tr_b16 a[180:181], v10 offset:8192
    ds_read_b64_tr_b16 a[182:183], v10 offset:12288
    v_mfma_f32_16x16x32_bf16 v[32:35], a[152:155], v[72:75], v[32:35]
    ds_read_b64_tr_b16 a[184:185], v11 offset:8192
    ds_read_b64_tr_b16 a[186:187], v11 offset:12288
    v_mfma_f32_16x16x32_bf16 v[32:35], a[156:159], v[76:79], v[32:35]
    ds_read_b64_tr_b16 a[188:189], v12 offset:8192
    ds_read_b64_tr_b16 a[190:191], v12 offset:12288
    v_mfma_f32_16x16x32_bf16 v[40:43], a[128:131], v[80:83], 0
    buffer_store_dwordx4 a[0:3], v24, s[40:43], s10 offen offset:0 sc1
    v_mfma_f32_16x16x32_bf16 v[40:43], a[132:135], v[84:87], v[40:43]
    v_exp_f32 v36, v36
    v_mfma_f32_16x16x32_bf16 v[40:43], a[136:139], v[88:91], v[40:43]
    v_exp_f32 v37, v37
    v_mfma_f32_16x16x32_bf16 v[40:43], a[140:143], v[92:95], v[40:43]
    v_exp_f32 v38, v38
    v_mfma_f32_16x16x32_bf16 v[44:47], a[144:147], v[80:83], 0
    v_exp_f32 v39, v39
    v_mfma_f32_16x16x32_bf16 v[44:47], a[148:151], v[84:87], v[44:47]
    v_exp_f32 v32, v32
    v_mfma_f32_16x16x32_bf16 v[44:47], a[152:155], v[88:91], v[44:47]
    buffer_store_dwordx4 a[4:7], v24, s[40:43], s10 offen offset:1024 sc1
    v_mfma_f32_16x16x32_bf16 v[44:47], a[156:159], v[92:95], v[44:47]
    v_exp_f32 v33, v33
    v_mfma_f32_16x16x32_bf16 v[52:55], a[128:131], v[96:99], 0
    v_exp_f32 v34, v34
    v_mfma_f32_16x16x32_bf16 v[52:55], a[132:135], v[100:103], v[52:55]
    v_exp_f32 v35, v35
    v_mfma_f32_16x16x32_bf16 v[52:55], a[136:139], v[104:107], v[52:55]
    v_cvt_pk_bf16_f32 v36, v36, v37
    v_cvt_pk_bf16_f32 v37, v38, v39
    v_mfma_f32_16x16x32_bf16 v[52:55], a[140:143], v[108:111], v[52:55]
    v_cvt_pk_bf16_f32 v38, v32, v33
    v_cvt_pk_bf16_f32 v39, v34, v35
    v_mfma_f32_16x16x32_bf16 v[48:51], a[144:147], v[96:99], 0
    v_exp_f32 v40, v40
    v_mfma_f32_16x16x32_bf16 v[48:51], a[148:151], v[100:103], v[48:51]
    v_exp_f32 v41, v41
    v_mfma_f32_16x16x32_bf16 v[48:51], a[152:155], v[104:107], v[48:51]
    v_exp_f32 v42, v42
    v_mfma_f32_16x16x32_bf16 v[48:51], a[156:159], v[108:111], v[48:51]
    v_exp_f32 v43, v43
    v_mfma_f32_16x16x32_bf16 v[56:59], a[128:131], v[112:115], v[20:23]
    v_exp_f32 v44, v44
    v_mfma_f32_16x16x32_bf16 v[56:59], a[132:135], v[116:119], v[56:59]
    v_exp_f32 v45, v45
    v_mfma_f32_16x16x32_bf16 v[56:59], a[136:139], v[120:123], v[56:59]
    v_exp_f32 v46, v46
    v_mfma_f32_16x16x32_bf16 v[56:59], a[140:143], v[124:127], v[56:59]
    buffer_store_dwordx4 a[8:11], v24, s[40:43], s11 offen offset:0 sc1
    v_mfma_f32_16x16x32_bf16 v[60:63], a[144:147], v[112:115], v[20:23]
    v_exp_f32 v47, v47
    v_mfma_f32_16x16x32_bf16 v[60:63], a[148:151], v[116:119], v[60:63]
    v_cvt_pk_bf16_f32 v40, v40, v41
    v_cvt_pk_bf16_f32 v41, v42, v43
    v_mfma_f32_16x16x32_bf16 v[60:63], a[152:155], v[120:123], v[60:63]
    v_cvt_pk_bf16_f32 v42, v44, v45
    v_cvt_pk_bf16_f32 v43, v46, v47
    v_mfma_f32_16x16x32_bf16 v[60:63], a[156:159], v[124:127], v[60:63]
    s_waitcnt lgkmcnt(8)
    s_waitcnt lgkmcnt(0)
    v_mfma_f32_16x16x32_bf16 v[128:131], a[160:163], v[36:39], v[128:131]
    v_exp_f32 v52, v52
    v_mfma_f32_16x16x32_bf16 v[132:135], a[164:167], v[36:39], v[132:135]
    v_exp_f32 v53, v53
    v_mfma_f32_16x16x32_bf16 v[136:139], a[168:171], v[36:39], v[136:139]
    v_exp_f32 v54, v54
    v_mfma_f32_16x16x32_bf16 v[140:143], a[172:175], v[36:39], v[140:143]
    v_exp_f32 v55, v55
    v_mfma_f32_16x16x32_bf16 v[144:147], a[176:179], v[36:39], v[144:147]
    s_waitcnt vmcnt(19)
    s_barrier
    v_mfma_f32_16x16x32_bf16 v[148:151], a[180:183], v[36:39], v[148:151]
    ds_read_b128 a[128:131], v1 offset:0
    ds_read_b128 a[132:135], v2 offset:0
    v_mfma_f32_16x16x32_bf16 v[152:155], a[184:187], v[36:39], v[152:155]
    v_exp_f32 v48, v48
    v_mfma_f32_16x16x32_bf16 v[156:159], a[188:191], v[36:39], v[156:159]
    v_exp_f32 v49, v49
    v_smfmac_f32_16x16x64_bf16 a[224:227], a[232:235], v[36:43], v19
    v_exp_f32 v50, v50
    v_mfma_f32_16x16x32_bf16 v[160:163], a[160:163], v[40:43], v[160:163]
    v_exp_f32 v51, v51
    v_mfma_f32_16x16x32_bf16 v[164:167], a[164:167], v[40:43], v[164:167]
    v_cvt_pk_bf16_f32 v52, v52, v53
    v_cvt_pk_bf16_f32 v53, v54, v55
    v_mfma_f32_16x16x32_bf16 v[168:171], a[168:171], v[40:43], v[168:171]
    v_cvt_pk_bf16_f32 v54, v48, v49
    v_cvt_pk_bf16_f32 v55, v50, v51
    v_mfma_f32_16x16x32_bf16 v[172:175], a[172:175], v[40:43], v[172:175]
    buffer_store_dwordx4 a[12:15], v24, s[40:43], s11 offen offset:1024 sc1
    v_mfma_f32_16x16x32_bf16 v[176:179], a[176:179], v[40:43], v[176:179]
    v_exp_f32 v56, v56
    v_mfma_f32_16x16x32_bf16 v[180:183], a[180:183], v[40:43], v[180:183]
    ds_read_b128 a[136:139], v3 offset:0
    ds_read_b128 a[140:143], v4 offset:0
    v_mfma_f32_16x16x32_bf16 v[184:187], a[184:187], v[40:43], v[184:187]
    ds_read_b128 a[144:147], v1 offset:4096
    ds_read_b128 a[148:151], v2 offset:4096
    v_mfma_f32_16x16x32_bf16 v[188:191], a[188:191], v[40:43], v[188:191]
    v_exp_f32 v57, v57
    v_mfma_f32_16x16x32_bf16 v[192:195], a[160:163], v[52:55], v[192:195]
    v_exp_f32 v58, v58
    v_mfma_f32_16x16x32_bf16 v[196:199], a[164:167], v[52:55], v[196:199]
    v_exp_f32 v59, v59
    v_mfma_f32_16x16x32_bf16 v[200:203], a[168:171], v[52:55], v[200:203]
    v_exp_f32 v60, v60
    v_mfma_f32_16x16x32_bf16 v[204:207], a[172:175], v[52:55], v[204:207]
    v_exp_f32 v61, v61
    v_mfma_f32_16x16x32_bf16 v[208:211], a[176:179], v[52:55], v[208:211]
    v_exp_f32 v62, v62
    v_exp_f32 v63, v63
    v_mfma_f32_16x16x32_bf16 v[212:215], a[180:183], v[52:55], v[212:215]
    v_cvt_pk_bf16_f32 v56, v56, v57
    v_cvt_pk_bf16_f32 v57, v58, v59
    v_cvt_pk_bf16_f32 v58, v60, v61
    v_cvt_pk_bf16_f32 v59, v62, v63
    v_mfma_f32_16x16x32_bf16 v[216:219], a[184:187], v[52:55], v[216:219]
    ds_read_b128 a[152:155], v3 offset:4096
    ds_read_b128 a[156:159], v4 offset:4096
    v_mfma_f32_16x16x32_bf16 v[220:223], a[188:191], v[52:55], v[220:223]
    buffer_store_dwordx4 a[32:35], v25, s[40:43], s10 offen offset:0 sc1
    v_smfmac_f32_16x16x64_bf16 a[228:231], a[232:235], v[52:59], v19
    v_xor_b32 v5, s84, v5
    v_xor_b32 v6, s84, v6
    v_mfma_f32_16x16x32_bf16 v[224:227], a[160:163], v[56:59], v[224:227]
    v_xor_b32 v7, s84, v7
    v_xor_b32 v8, s84, v8
    v_mfma_f32_16x16x32_bf16 v[228:231], a[164:167], v[56:59], v[228:231]
    v_xor_b32 v9, s84, v9
    v_xor_b32 v10, s84, v10
    v_mfma_f32_16x16x32_bf16 v[232:235], a[168:171], v[56:59], v[232:235]
    v_xor_b32 v11, s84, v11
    v_xor_b32 v12, s84, v12
    v_mfma_f32_16x16x32_bf16 v[236:239], a[172:175], v[56:59], v[236:239]
    v_mfma_f32_16x16x32_bf16 v[240:243], a[176:179], v[56:59], v[240:243]
    v_mfma_f32_16x16x32_bf16 v[244:247], a[180:183], v[56:59], v[244:247]
    v_mfma_f32_16x16x32_bf16 v[248:251], a[184:187], v[56:59], v[248:251]
    v_mfma_f32_16x16x32_bf16 v[252:255], a[188:191], v[56:59], v[252:255]
    s_waitcnt lgkmcnt(0)
    v_mfma_f32_16x16x32_bf16 v[36:39], a[128:131], v[64:67], 0
    ds_read_b64_tr_b16 a[160:161], v5 offset:0
    ds_read_b64_tr_b16 a[162:163], v5 offset:4096
    buffer_store_dwordx4 a[36:39], v25, s[40:43], s10 offen offset:1024 sc1
    v_mfma_f32_16x16x32_bf16 v[36:39], a[132:135], v[68:71], v[36:39]
    ds_read_b64_tr_b16 a[164:165], v6 offset:0
    ds_read_b64_tr_b16 a[166:167], v6 offset:4096
    v_mfma_f32_16x16x32_bf16 v[36:39], a[136:139], v[72:75], v[36:39]
    ds_read_b64_tr_b16 a[168:169], v7 offset:0
    ds_read_b64_tr_b16 a[170:171], v7 offset:4096
    v_mfma_f32_16x16x32_bf16 v[36:39], a[140:143], v[76:79], v[36:39]
    ds_read_b64_tr_b16 a[172:173], v8 offset:0
    ds_read_b64_tr_b16 a[174:175], v8 offset:4096
    v_mfma_f32_16x16x32_bf16 v[32:35], a[144:147], v[64:67], 0
    ds_read_b64_tr_b16 a[176:177], v9 offset:0
    ds_read_b64_tr_b16 a[178:179], v9 offset:4096
    v_mfma_f32_16x16x32_bf16 v[32:35], a[148:151], v[68:71], v[32:35]
    ds_read_b64_tr_b16 a[180:181], v10 offset:0
    ds_read_b64_tr_b16 a[182:183], v10 offset:4096
    v_mfma_f32_16x16x32_bf16 v[32:35], a[152:155], v[72:75], v[32:35]
    ds_read_b64_tr_b16 a[184:185], v11 offset:0
    ds_read_b64_tr_b16 a[186:187], v11 offset:4096
    v_mfma_f32_16x16x32_bf16 v[32:35], a[156:159], v[76:79], v[32:35]
    ds_read_b64_tr_b16 a[188:189], v12 offset:0
    ds_read_b64_tr_b16 a[190:191], v12 offset:4096
    v_mfma_f32_16x16x32_bf16 v[40:43], a[128:131], v[80:83], 0
    v_exp_f32 v36, v36
    v_mfma_f32_16x16x32_bf16 v[40:43], a[132:135], v[84:87], v[40:43]
    v_exp_f32 v37, v37
    v_mfma_f32_16x16x32_bf16 v[40:43], a[136:139], v[88:91], v[40:43]
    v_exp_f32 v38, v38
    v_mfma_f32_16x16x32_bf16 v[40:43], a[140:143], v[92:95], v[40:43]
    v_exp_f32 v39, v39
    v_mfma_f32_16x16x32_bf16 v[44:47], a[144:147], v[80:83], 0
    buffer_store_dwordx4 a[40:43], v25, s[40:43], s11 offen offset:0 sc1
    v_mfma_f32_16x16x32_bf16 v[44:47], a[148:151], v[84:87], v[44:47]
    v_exp_f32 v32, v32
    v_mfma_f32_16x16x32_bf16 v[44:47], a[152:155], v[88:91], v[44:47]
    v_exp_f32 v33, v33
    v_mfma_f32_16x16x32_bf16 v[44:47], a[156:159], v[92:95], v[44:47]
    v_exp_f32 v34, v34
    v_mfma_f32_16x16x32_bf16 v[52:55], a[128:131], v[96:99], 0
    v_exp_f32 v35, v35
    v_mfma_f32_16x16x32_bf16 v[52:55], a[132:135], v[100:103], v[52:55]
    v_cvt_pk_bf16_f32 v36, v36, v37
    v_cvt_pk_bf16_f32 v37, v38, v39
    v_mfma_f32_16x16x32_bf16 v[52:55], a[136:139], v[104:107], v[52:55]
    v_cvt_pk_bf16_f32 v38, v32, v33
    v_cvt_pk_bf16_f32 v39, v34, v35
    v_mfma_f32_16x16x32_bf16 v[52:55], a[140:143], v[108:111], v[52:55]
    v_exp_f32 v40, v40
    v_mfma_f32_16x16x32_bf16 v[48:51], a[144:147], v[96:99], 0
    v_exp_f32 v41, v41
    v_mfma_f32_16x16x32_bf16 v[48:51], a[148:151], v[100:103], v[48:51]
    v_exp_f32 v42, v42
    v_mfma_f32_16x16x32_bf16 v[48:51], a[152:155], v[104:107], v[48:51]
    v_exp_f32 v43, v43
    v_mfma_f32_16x16x32_bf16 v[48:51], a[156:159], v[108:111], v[48:51]
    v_exp_f32 v44, v44
    v_mfma_f32_16x16x32_bf16 v[56:59], a[128:131], v[112:115], v[20:23]
    v_exp_f32 v45, v45
    v_mfma_f32_16x16x32_bf16 v[56:59], a[132:135], v[116:119], v[56:59]
    buffer_store_dwordx4 a[44:47], v25, s[40:43], s11 offen offset:1024 sc1
    v_mfma_f32_16x16x32_bf16 v[56:59], a[136:139], v[120:123], v[56:59]
    v_exp_f32 v46, v46
    v_mfma_f32_16x16x32_bf16 v[56:59], a[140:143], v[124:127], v[56:59]
    v_exp_f32 v47, v47
    v_mfma_f32_16x16x32_bf16 v[60:63], a[144:147], v[112:115], v[20:23]
    v_cvt_pk_bf16_f32 v40, v40, v41
    v_cvt_pk_bf16_f32 v41, v42, v43
    v_mfma_f32_16x16x32_bf16 v[60:63], a[148:151], v[116:119], v[60:63]
    v_cvt_pk_bf16_f32 v42, v44, v45
    v_cvt_pk_bf16_f32 v43, v46, v47
    v_mfma_f32_16x16x32_bf16 v[60:63], a[152:155], v[120:123], v[60:63]
    v_exp_f32 v52, v52
    v_mfma_f32_16x16x32_bf16 v[60:63], a[156:159], v[124:127], v[60:63]
    s_waitcnt lgkmcnt(0)
    v_mfma_f32_16x16x32_bf16 v[128:131], a[160:163], v[36:39], v[128:131]
    v_exp_f32 v53, v53
    v_mfma_f32_16x16x32_bf16 v[132:135], a[164:167], v[36:39], v[132:135]
    v_exp_f32 v54, v54
    v_mfma_f32_16x16x32_bf16 v[136:139], a[168:171], v[36:39], v[136:139]
    v_exp_f32 v55, v55
    v_mfma_f32_16x16x32_bf16 v[140:143], a[172:175], v[36:39], v[140:143]
    v_exp_f32 v48, v48
    v_mfma_f32_16x16x32_bf16 v[144:147], a[176:179], v[36:39], v[144:147]
    v_exp_f32 v49, v49
    v_mfma_f32_16x16x32_bf16 v[148:151], a[180:183], v[36:39], v[148:151]
    ds_read_b128 a[128:131], v1 offset:8192
    ds_read_b128 a[132:135], v2 offset:8192
    v_mfma_f32_16x16x32_bf16 v[152:155], a[184:187], v[36:39], v[152:155]
    buffer_store_dwordx4 a[64:67], v26, s[40:43], s10 offen offset:0 sc1
    v_mfma_f32_16x16x32_bf16 v[156:159], a[188:191], v[36:39], v[156:159]
    v_exp_f32 v50, v50
    v_smfmac_f32_16x16x64_bf16 a[224:227], a[232:235], v[36:43], v19
    v_exp_f32 v51, v51
    v_mfma_f32_16x16x32_bf16 v[160:163], a[160:163], v[40:43], v[160:163]
    v_cvt_pk_bf16_f32 v52, v52, v53
    v_cvt_pk_bf16_f32 v53, v54, v55
    v_mfma_f32_16x16x32_bf16 v[164:167], a[164:167], v[40:43], v[164:167]
    v_cvt_pk_bf16_f32 v54, v48, v49
    v_cvt_pk_bf16_f32 v55, v50, v51
    v_mfma_f32_16x16x32_bf16 v[168:171], a[168:171], v[40:43], v[168:171]
    v_exp_f32 v56, v56
    v_mfma_f32_16x16x32_bf16 v[172:175], a[172:175], v[40:43], v[172:175]
    v_exp_f32 v57, v57
    v_mfma_f32_16x16x32_bf16 v[176:179], a[176:179], v[40:43], v[176:179]
    v_exp_f32 v58, v58
    v_mfma_f32_16x16x32_bf16 v[180:183], a[180:183], v[40:43], v[180:183]
    ds_read_b128 a[136:139], v3 offset:8192
    ds_read_b128 a[140:143], v4 offset:8192
    v_mfma_f32_16x16x32_bf16 v[184:187], a[184:187], v[40:43], v[184:187]
    ds_read_b128 a[144:147], v1 offset:12288
    ds_read_b128 a[148:151], v2 offset:12288
    v_mfma_f32_16x16x32_bf16 v[188:191], a[188:191], v[40:43], v[188:191]
    v_exp_f32 v59, v59
    v_mfma_f32_16x16x32_bf16 v[192:195], a[160:163], v[52:55], v[192:195]
    v_exp_f32 v60, v60
    v_mfma_f32_16x16x32_bf16 v[196:199], a[164:167], v[52:55], v[196:199]
    v_exp_f32 v61, v61
    v_mfma_f32_16x16x32_bf16 v[200:203], a[168:171], v[52:55], v[200:203]
    v_exp_f32 v62, v62
    v_mfma_f32_16x16x32_bf16 v[204:207], a[172:175], v[52:55], v[204:207]
    v_exp_f32 v63, v63
    v_mfma_f32_16x16x32_bf16 v[208:211], a[176:179], v[52:55], v[208:211]
    v_cvt_pk_bf16_f32 v56, v56, v57
    v_cvt_pk_bf16_f32 v57, v58, v59
    v_mfma_f32_16x16x32_bf16 v[212:215], a[180:183], v[52:55], v[212:215]
    v_cvt_pk_bf16_f32 v58, v60, v61
    v_cvt_pk_bf16_f32 v59, v62, v63
    v_mfma_f32_16x16x32_bf16 v[216:219], a[184:187], v[52:55], v[216:219]
    ds_read_b128 a[152:155], v3 offset:12288
    ds_read_b128 a[156:159], v4 offset:12288
    v_mfma_f32_16x16x32_bf16 v[220:223], a[188:191], v[52:55], v[220:223]
    buffer_store_dwordx4 a[68:71], v26, s[40:43], s10 offen offset:1024 sc1
    v_smfmac_f32_16x16x64_bf16 a[228:231], a[232:235], v[52:59], v19
    s_xor_b32 s83, s83, s84
    s_xor_b32 s84, s84, 49152
    v_mfma_f32_16x16x32_bf16 v[224:227], a[160:163], v[56:59], v[224:227]
    v_xor_b32 v1, s84, v1
    v_xor_b32 v2, s84, v2
    v_mfma_f32_16x16x32_bf16 v[228:231], a[164:167], v[56:59], v[228:231]
    v_xor_b32 v3, s84, v3
    v_xor_b32 v4, s84, v4
    v_mfma_f32_16x16x32_bf16 v[232:235], a[168:171], v[56:59], v[232:235]
    v_mfma_f32_16x16x32_bf16 v[236:239], a[172:175], v[56:59], v[236:239]
    v_mfma_f32_16x16x32_bf16 v[240:243], a[176:179], v[56:59], v[240:243]
    v_mfma_f32_16x16x32_bf16 v[244:247], a[180:183], v[56:59], v[244:247]
    v_mfma_f32_16x16x32_bf16 v[248:251], a[184:187], v[56:59], v[248:251]
    buffer_store_dwordx4 a[72:75], v26, s[40:43], s11 offen offset:0 sc1
    v_mfma_f32_16x16x32_bf16 v[252:255], a[188:191], v[56:59], v[252:255]
    s_waitcnt lgkmcnt(0)
    v_mfma_f32_16x16x32_bf16 v[36:39], a[128:131], v[64:67], 0
    ds_read_b64_tr_b16 a[160:161], v5 offset:8192
    ds_read_b64_tr_b16 a[162:163], v5 offset:12288
    v_mfma_f32_16x16x32_bf16 v[36:39], a[132:135], v[68:71], v[36:39]
    ds_read_b64_tr_b16 a[164:165], v6 offset:8192
    ds_read_b64_tr_b16 a[166:167], v6 offset:12288
    v_mfma_f32_16x16x32_bf16 v[36:39], a[136:139], v[72:75], v[36:39]
    ds_read_b64_tr_b16 a[168:169], v7 offset:8192
    ds_read_b64_tr_b16 a[170:171], v7 offset:12288
    v_mfma_f32_16x16x32_bf16 v[36:39], a[140:143], v[76:79], v[36:39]
    ds_read_b64_tr_b16 a[172:173], v8 offset:8192
    ds_read_b64_tr_b16 a[174:175], v8 offset:12288
    v_mfma_f32_16x16x32_bf16 v[32:35], a[144:147], v[64:67], 0
    ds_read_b64_tr_b16 a[176:177], v9 offset:8192
    ds_read_b64_tr_b16 a[178:179], v9 offset:12288
    v_mfma_f32_16x16x32_bf16 v[32:35], a[148:151], v[68:71], v[32:35]
    ds_read_b64_tr_b16 a[180:181], v10 offset:8192
    ds_read_b64_tr_b16 a[182:183], v10 offset:12288
    v_mfma_f32_16x16x32_bf16 v[32:35], a[152:155], v[72:75], v[32:35]
    ds_read_b64_tr_b16 a[184:185], v11 offset:8192
    ds_read_b64_tr_b16 a[186:187], v11 offset:12288
    v_mfma_f32_16x16x32_bf16 v[32:35], a[156:159], v[76:79], v[32:35]
    ds_read_b64_tr_b16 a[188:189], v12 offset:8192
    ds_read_b64_tr_b16 a[190:191], v12 offset:12288
    v_mfma_f32_16x16x32_bf16 v[40:43], a[128:131], v[80:83], 0
    v_exp_f32 v36, v36
    v_mfma_f32_16x16x32_bf16 v[40:43], a[132:135], v[84:87], v[40:43]
    v_exp_f32 v37, v37
    v_mfma_f32_16x16x32_bf16 v[40:43], a[136:139], v[88:91], v[40:43]
    buffer_store_dwordx4 a[76:79], v26, s[40:43], s11 offen offset:1024 sc1
    v_mfma_f32_16x16x32_bf16 v[40:43], a[140:143], v[92:95], v[40:43]
    v_exp_f32 v38, v38
    v_mfma_f32_16x16x32_bf16 v[44:47], a[144:147], v[80:83], 0
    v_exp_f32 v39, v39
    v_mfma_f32_16x16x32_bf16 v[44:47], a[148:151], v[84:87], v[44:47]
    v_exp_f32 v32, v32
    v_mfma_f32_16x16x32_bf16 v[44:47], a[152:155], v[88:91], v[44:47]
    v_exp_f32 v33, v33
    v_mfma_f32_16x16x32_bf16 v[44:47], a[156:159], v[92:95], v[44:47]
    v_exp_f32 v34, v34
    v_mfma_f32_16x16x32_bf16 v[52:55], a[128:131], v[96:99], 0
    v_exp_f32 v35, v35
    v_mfma_f32_16x16x32_bf16 v[52:55], a[132:135], v[100:103], v[52:55]
    v_cvt_pk_bf16_f32 v36, v36, v37
    v_cvt_pk_bf16_f32 v37, v38, v39
    v_mfma_f32_16x16x32_bf16 v[52:55], a[136:139], v[104:107], v[52:55]
    v_cvt_pk_bf16_f32 v38, v32, v33
    v_cvt_pk_bf16_f32 v39, v34, v35
    v_mfma_f32_16x16x32_bf16 v[52:55], a[140:143], v[108:111], v[52:55]
    v_exp_f32 v40, v40
    v_mfma_f32_16x16x32_bf16 v[48:51], a[144:147], v[96:99], 0
    v_exp_f32 v41, v41
    v_mfma_f32_16x16x32_bf16 v[48:51], a[148:151], v[100:103], v[48:51]
    v_exp_f32 v42, v42
    v_mfma_f32_16x16x32_bf16 v[48:51], a[152:155], v[104:107], v[48:51]
    v_exp_f32 v43, v43
    v_mfma_f32_16x16x32_bf16 v[48:51], a[156:159], v[108:111], v[48:51]
    buffer_store_dwordx4 a[96:99], v27, s[40:43], s10 offen offset:0 sc1
    v_mfma_f32_16x16x32_bf16 v[56:59], a[128:131], v[112:115], v[20:23]
    v_exp_f32 v44, v44
    v_mfma_f32_16x16x32_bf16 v[56:59], a[132:135], v[116:119], v[56:59]
    v_exp_f32 v45, v45
    v_mfma_f32_16x16x32_bf16 v[56:59], a[136:139], v[120:123], v[56:59]
    v_exp_f32 v46, v46
    v_mfma_f32_16x16x32_bf16 v[56:59], a[140:143], v[124:127], v[56:59]
    v_exp_f32 v47, v47
    v_mfma_f32_16x16x32_bf16 v[60:63], a[144:147], v[112:115], v[20:23]
    v_cvt_pk_bf16_f32 v40, v40, v41
    v_cvt_pk_bf16_f32 v41, v42, v43
    v_mfma_f32_16x16x32_bf16 v[60:63], a[148:151], v[116:119], v[60:63]
    v_cvt_pk_bf16_f32 v42, v44, v45
    v_cvt_pk_bf16_f32 v43, v46, v47
    v_mfma_f32_16x16x32_bf16 v[60:63], a[152:155], v[120:123], v[60:63]
    v_exp_f32 v52, v52
    v_mfma_f32_16x16x32_bf16 v[60:63], a[156:159], v[124:127], v[60:63]
    v_xor_b32 v5, s84, v5
    s_waitcnt lgkmcnt(0)
    v_mfma_f32_16x16x32_bf16 v[128:131], a[160:163], v[36:39], v[128:131]
    v_exp_f32 v53, v53
    v_mfma_f32_16x16x32_bf16 v[132:135], a[164:167], v[36:39], v[132:135]
    v_exp_f32 v54, v54
    v_mfma_f32_16x16x32_bf16 v[136:139], a[168:171], v[36:39], v[136:139]
    v_exp_f32 v55, v55
    v_mfma_f32_16x16x32_bf16 v[140:143], a[172:175], v[36:39], v[140:143]
    v_exp_f32 v48, v48
    v_mfma_f32_16x16x32_bf16 v[144:147], a[176:179], v[36:39], v[144:147]
    s_waitcnt vmcnt(21)
    s_barrier
    v_mfma_f32_16x16x32_bf16 v[148:151], a[180:183], v[36:39], v[148:151]
    ds_read_b128 a[128:131], v1 offset:0
    ds_read_b128 a[132:135], v2 offset:0
    v_mfma_f32_16x16x32_bf16 v[152:155], a[184:187], v[36:39], v[152:155]
    buffer_store_dwordx4 a[100:103], v27, s[40:43], s10 offen offset:1024 sc1
    v_mfma_f32_16x16x32_bf16 v[156:159], a[188:191], v[36:39], v[156:159]
    v_exp_f32 v49, v49
    v_smfmac_f32_16x16x64_bf16 a[224:227], a[232:235], v[36:43], v19
    v_exp_f32 v50, v50
    v_mfma_f32_16x16x32_bf16 v[160:163], a[160:163], v[40:43], v[160:163]
    v_exp_f32 v51, v51
    v_mfma_f32_16x16x32_bf16 v[164:167], a[164:167], v[40:43], v[164:167]
    v_cvt_pk_bf16_f32 v52, v52, v53
    v_cvt_pk_bf16_f32 v53, v54, v55
    v_mfma_f32_16x16x32_bf16 v[168:171], a[168:171], v[40:43], v[168:171]
    v_cvt_pk_bf16_f32 v54, v48, v49
    v_cvt_pk_bf16_f32 v55, v50, v51
    v_mfma_f32_16x16x32_bf16 v[172:175], a[172:175], v[40:43], v[172:175]
    v_exp_f32 v56, v56
    v_mfma_f32_16x16x32_bf16 v[176:179], a[176:179], v[40:43], v[176:179]
    v_exp_f32 v57, v57
    v_mfma_f32_16x16x32_bf16 v[180:183], a[180:183], v[40:43], v[180:183]
    ds_read_b128 a[136:139], v3 offset:0
    ds_read_b128 a[140:143], v4 offset:0
    v_mfma_f32_16x16x32_bf16 v[184:187], a[184:187], v[40:43], v[184:187]
    ds_read_b128 a[144:147], v1 offset:4096
    ds_read_b128 a[148:151], v2 offset:4096
    v_mfma_f32_16x16x32_bf16 v[188:191], a[188:191], v[40:43], v[188:191]
    v_exp_f32 v58, v58
    v_mfma_f32_16x16x32_bf16 v[192:195], a[160:163], v[52:55], v[192:195]
    v_exp_f32 v59, v59
    v_mfma_f32_16x16x32_bf16 v[196:199], a[164:167], v[52:55], v[196:199]
    v_exp_f32 v60, v60
    v_mfma_f32_16x16x32_bf16 v[200:203], a[168:171], v[52:55], v[200:203]
    v_exp_f32 v61, v61
    v_mfma_f32_16x16x32_bf16 v[204:207], a[172:175], v[52:55], v[204:207]
    v_exp_f32 v62, v62
    v_mfma_f32_16x16x32_bf16 v[208:211], a[176:179], v[52:55], v[208:211]
    v_exp_f32 v63, v63
    v_mfma_f32_16x16x32_bf16 v[212:215], a[180:183], v[52:55], v[212:215]
    v_cvt_pk_bf16_f32 v56, v56, v57
    v_cvt_pk_bf16_f32 v57, v58, v59
    v_cvt_pk_bf16_f32 v58, v60, v61
    v_cvt_pk_bf16_f32 v59, v62, v63
    v_mfma_f32_16x16x32_bf16 v[216:219], a[184:187], v[52:55], v[216:219]
    ds_read_b128 a[152:155], v3 offset:4096
    ds_read_b128 a[156:159], v4 offset:4096
    buffer_store_dwordx4 a[104:107], v27, s[40:43], s11 offen offset:0 sc1
    v_mfma_f32_16x16x32_bf16 v[220:223], a[188:191], v[52:55], v[220:223]
    v_xor_b32 v6, s84, v6
    v_xor_b32 v7, s84, v7
    v_smfmac_f32_16x16x64_bf16 a[228:231], a[232:235], v[52:59], v19
    v_xor_b32 v8, s84, v8
    v_xor_b32 v9, s84, v9
    v_mfma_f32_16x16x32_bf16 v[224:227], a[160:163], v[56:59], v[224:227]
    v_xor_b32 v10, s84, v10
    v_xor_b32 v11, s84, v11
    v_mfma_f32_16x16x32_bf16 v[228:231], a[164:167], v[56:59], v[228:231]
    v_xor_b32 v12, s84, v12
    v_mfma_f32_16x16x32_bf16 v[232:235], a[168:171], v[56:59], v[232:235]
    v_mfma_f32_16x16x32_bf16 v[236:239], a[172:175], v[56:59], v[236:239]
    v_mfma_f32_16x16x32_bf16 v[240:243], a[176:179], v[56:59], v[240:243]
    buffer_store_dwordx4 a[108:111], v27, s[40:43], s11 offen offset:1024 sc1
    v_mfma_f32_16x16x32_bf16 v[244:247], a[180:183], v[56:59], v[244:247]
    v_mfma_f32_16x16x32_bf16 v[248:251], a[184:187], v[56:59], v[248:251]
    v_mfma_f32_16x16x32_bf16 v[252:255], a[188:191], v[56:59], v[252:255]
    s_waitcnt lgkmcnt(0)
    v_mfma_f32_16x16x32_bf16 v[36:39], a[128:131], v[64:67], 0
    ds_read_b64_tr_b16 a[160:161], v5 offset:0
    ds_read_b64_tr_b16 a[162:163], v5 offset:4096
    v_mfma_f32_16x16x32_bf16 v[36:39], a[132:135], v[68:71], v[36:39]
    ds_read_b64_tr_b16 a[164:165], v6 offset:0
    ds_read_b64_tr_b16 a[166:167], v6 offset:4096
    v_mfma_f32_16x16x32_bf16 v[36:39], a[136:139], v[72:75], v[36:39]
    ds_read_b64_tr_b16 a[168:169], v7 offset:0
    ds_read_b64_tr_b16 a[170:171], v7 offset:4096
    v_mfma_f32_16x16x32_bf16 v[36:39], a[140:143], v[76:79], v[36:39]
    ds_read_b64_tr_b16 a[172:173], v8 offset:0
    ds_read_b64_tr_b16 a[174:175], v8 offset:4096
    v_mfma_f32_16x16x32_bf16 v[32:35], a[144:147], v[64:67], 0
    ds_read_b64_tr_b16 a[176:177], v9 offset:0
    ds_read_b64_tr_b16 a[178:179], v9 offset:4096
    v_mfma_f32_16x16x32_bf16 v[32:35], a[148:151], v[68:71], v[32:35]
    ds_read_b64_tr_b16 a[180:181], v10 offset:0
    ds_read_b64_tr_b16 a[182:183], v10 offset:4096
    v_mfma_f32_16x16x32_bf16 v[32:35], a[152:155], v[72:75], v[32:35]
    ds_read_b64_tr_b16 a[184:185], v11 offset:0
    ds_read_b64_tr_b16 a[186:187], v11 offset:4096
    v_mfma_f32_16x16x32_bf16 v[32:35], a[156:159], v[76:79], v[32:35]
    ds_read_b64_tr_b16 a[188:189], v12 offset:0
    ds_read_b64_tr_b16 a[190:191], v12 offset:4096
    v_mfma_f32_16x16x32_bf16 v[40:43], a[128:131], v[80:83], 0
    buffer_store_dwordx4 a[192:195], v0, s[20:23], s27 offen offset:0 sc1
    v_mfma_f32_16x16x32_bf16 v[40:43], a[132:135], v[84:87], v[40:43]
    v_exp_f32 v36, v36
    v_mfma_f32_16x16x32_bf16 v[40:43], a[136:139], v[88:91], v[40:43]
    v_exp_f32 v37, v37
    v_mfma_f32_16x16x32_bf16 v[40:43], a[140:143], v[92:95], v[40:43]
    v_exp_f32 v38, v38
    v_mfma_f32_16x16x32_bf16 v[44:47], a[144:147], v[80:83], 0
    v_exp_f32 v39, v39
    v_mfma_f32_16x16x32_bf16 v[44:47], a[148:151], v[84:87], v[44:47]
    v_exp_f32 v32, v32
    v_mfma_f32_16x16x32_bf16 v[44:47], a[152:155], v[88:91], v[44:47]
    v_exp_f32 v33, v33
    v_mfma_f32_16x16x32_bf16 v[44:47], a[156:159], v[92:95], v[44:47]
    v_exp_f32 v34, v34
    v_mfma_f32_16x16x32_bf16 v[52:55], a[128:131], v[96:99], 0
    v_exp_f32 v35, v35
    v_mfma_f32_16x16x32_bf16 v[52:55], a[132:135], v[100:103], v[52:55]
    v_cvt_pk_bf16_f32 v36, v36, v37
    v_cvt_pk_bf16_f32 v37, v38, v39
    v_mfma_f32_16x16x32_bf16 v[52:55], a[136:139], v[104:107], v[52:55]
    v_cvt_pk_bf16_f32 v38, v32, v33
    v_cvt_pk_bf16_f32 v39, v34, v35
    v_mfma_f32_16x16x32_bf16 v[52:55], a[140:143], v[108:111], v[52:55]
    v_exp_f32 v40, v40
    v_mfma_f32_16x16x32_bf16 v[48:51], a[144:147], v[96:99], 0
    v_exp_f32 v41, v41
    v_mfma_f32_16x16x32_bf16 v[48:51], a[148:151], v[100:103], v[48:51]
    buffer_store_dwordx4 a[196:199], v0, s[20:23], s27 offen offset:1024 sc1
    v_mfma_f32_16x16x32_bf16 v[48:51], a[152:155], v[104:107], v[48:51]
    v_exp_f32 v42, v42
    v_mfma_f32_16x16x32_bf16 v[48:51], a[156:159], v[108:111], v[48:51]
    v_exp_f32 v43, v43
    v_mfma_f32_16x16x32_bf16 v[56:59], a[128:131], v[112:115], v[20:23]
    v_exp_f32 v44, v44
    v_mfma_f32_16x16x32_bf16 v[56:59], a[132:135], v[116:119], v[56:59]
    v_exp_f32 v45, v45
    v_mfma_f32_16x16x32_bf16 v[56:59], a[136:139], v[120:123], v[56:59]
    v_exp_f32 v46, v46
    v_mfma_f32_16x16x32_bf16 v[56:59], a[140:143], v[124:127], v[56:59]
    v_exp_f32 v47, v47
    v_mfma_f32_16x16x32_bf16 v[60:63], a[144:147], v[112:115], v[20:23]
    v_cvt_pk_bf16_f32 v40, v40, v41
    v_cvt_pk_bf16_f32 v41, v42, v43
    v_mfma_f32_16x16x32_bf16 v[60:63], a[148:151], v[116:119], v[60:63]
    v_cvt_pk_bf16_f32 v42, v44, v45
    v_cvt_pk_bf16_f32 v43, v46, v47
    v_mfma_f32_16x16x32_bf16 v[60:63], a[152:155], v[120:123], v[60:63]
    v_exp_f32 v52, v52
    v_mfma_f32_16x16x32_bf16 v[60:63], a[156:159], v[124:127], v[60:63]
    s_waitcnt lgkmcnt(0)
    v_mfma_f32_16x16x32_bf16 v[128:131], a[160:163], v[36:39], v[128:131]
    v_exp_f32 v53, v53
    v_mfma_f32_16x16x32_bf16 v[132:135], a[164:167], v[36:39], v[132:135]
    v_exp_f32 v54, v54
    v_mfma_f32_16x16x32_bf16 v[136:139], a[168:171], v[36:39], v[136:139]
    buffer_store_dwordx4 a[200:203], v0, s[20:23], s27 offen offset:2048 sc1
    v_mfma_f32_16x16x32_bf16 v[140:143], a[172:175], v[36:39], v[140:143]
    v_exp_f32 v55, v55
    v_mfma_f32_16x16x32_bf16 v[144:147], a[176:179], v[36:39], v[144:147]
    v_exp_f32 v48, v48
    v_mfma_f32_16x16x32_bf16 v[148:151], a[180:183], v[36:39], v[148:151]
    ds_read_b128 a[128:131], v1 offset:8192
    ds_read_b128 a[132:135], v2 offset:8192
    v_mfma_f32_16x16x32_bf16 v[152:155], a[184:187], v[36:39], v[152:155]
    v_exp_f32 v49, v49
    v_mfma_f32_16x16x32_bf16 v[156:159], a[188:191], v[36:39], v[156:159]
    v_exp_f32 v50, v50
    v_smfmac_f32_16x16x64_bf16 a[224:227], a[232:235], v[36:43], v19
    v_exp_f32 v51, v51
    v_mfma_f32_16x16x32_bf16 v[160:163], a[160:163], v[40:43], v[160:163]
    v_cvt_pk_bf16_f32 v52, v52, v53
    v_cvt_pk_bf16_f32 v53, v54, v55
    v_mfma_f32_16x16x32_bf16 v[164:167], a[164:167], v[40:43], v[164:167]
    v_cvt_pk_bf16_f32 v54, v48, v49
    v_cvt_pk_bf16_f32 v55, v50, v51
    v_mfma_f32_16x16x32_bf16 v[168:171], a[168:171], v[40:43], v[168:171]
    v_exp_f32 v56, v56
    v_mfma_f32_16x16x32_bf16 v[172:175], a[172:175], v[40:43], v[172:175]
    v_exp_f32 v57, v57
    v_mfma_f32_16x16x32_bf16 v[176:179], a[176:179], v[40:43], v[176:179]
    v_exp_f32 v58, v58
    v_mfma_f32_16x16x32_bf16 v[180:183], a[180:183], v[40:43], v[180:183]
    ds_read_b128 a[136:139], v3 offset:8192
    ds_read_b128 a[140:143], v4 offset:8192
    v_mfma_f32_16x16x32_bf16 v[184:187], a[184:187], v[40:43], v[184:187]
    ds_read_b128 a[144:147], v1 offset:12288
    ds_read_b128 a[148:151], v2 offset:12288
    v_mfma_f32_16x16x32_bf16 v[188:191], a[188:191], v[40:43], v[188:191]
    v_exp_f32 v59, v59
    v_mfma_f32_16x16x32_bf16 v[192:195], a[160:163], v[52:55], v[192:195]
    v_exp_f32 v60, v60
    v_mfma_f32_16x16x32_bf16 v[196:199], a[164:167], v[52:55], v[196:199]
    v_exp_f32 v61, v61
    v_mfma_f32_16x16x32_bf16 v[200:203], a[168:171], v[52:55], v[200:203]
    v_exp_f32 v62, v62
    v_mfma_f32_16x16x32_bf16 v[204:207], a[172:175], v[52:55], v[204:207]
    v_exp_f32 v63, v63
    v_mfma_f32_16x16x32_bf16 v[208:211], a[176:179], v[52:55], v[208:211]
    buffer_store_dwordx4 a[204:207], v0, s[20:23], s28 offen offset:0 sc1
    v_mfma_f32_16x16x32_bf16 v[212:215], a[180:183], v[52:55], v[212:215]
    v_cvt_pk_bf16_f32 v56, v56, v57
    v_cvt_pk_bf16_f32 v57, v58, v59
    v_cvt_pk_bf16_f32 v58, v60, v61
    v_cvt_pk_bf16_f32 v59, v62, v63
    v_mfma_f32_16x16x32_bf16 v[216:219], a[184:187], v[52:55], v[216:219]
    ds_read_b128 a[152:155], v3 offset:12288
    ds_read_b128 a[156:159], v4 offset:12288
    v_mfma_f32_16x16x32_bf16 v[220:223], a[188:191], v[52:55], v[220:223]
    s_xor_b32 s83, s83, s84
    s_xor_b32 s84, s84, 49152
    v_smfmac_f32_16x16x64_bf16 a[228:231], a[232:235], v[52:59], v19
    v_xor_b32 v1, s84, v1
    v_xor_b32 v2, s84, v2
    v_mfma_f32_16x16x32_bf16 v[224:227], a[160:163], v[56:59], v[224:227]
    v_xor_b32 v3, s84, v3
    v_xor_b32 v4, s84, v4
    v_mfma_f32_16x16x32_bf16 v[228:231], a[164:167], v[56:59], v[228:231]
    v_mfma_f32_16x16x32_bf16 v[232:235], a[168:171], v[56:59], v[232:235]
    buffer_store_dwordx4 a[208:211], v0, s[20:23], s28 offen offset:1024 sc1
    v_mfma_f32_16x16x32_bf16 v[236:239], a[172:175], v[56:59], v[236:239]
    v_mfma_f32_16x16x32_bf16 v[240:243], a[176:179], v[56:59], v[240:243]
    v_mfma_f32_16x16x32_bf16 v[244:247], a[180:183], v[56:59], v[244:247]
    v_mfma_f32_16x16x32_bf16 v[248:251], a[184:187], v[56:59], v[248:251]
    v_mfma_f32_16x16x32_bf16 v[252:255], a[188:191], v[56:59], v[252:255]
    s_waitcnt lgkmcnt(0)
    v_mfma_f32_16x16x32_bf16 v[36:39], a[128:131], v[64:67], 0
    ds_read_b64_tr_b16 a[160:161], v5 offset:8192
    ds_read_b64_tr_b16 a[162:163], v5 offset:12288
    v_mfma_f32_16x16x32_bf16 v[36:39], a[132:135], v[68:71], v[36:39]
    ds_read_b64_tr_b16 a[164:165], v6 offset:8192
    ds_read_b64_tr_b16 a[166:167], v6 offset:12288
    v_mfma_f32_16x16x32_bf16 v[36:39], a[136:139], v[72:75], v[36:39]
    ds_read_b64_tr_b16 a[168:169], v7 offset:8192
    ds_read_b64_tr_b16 a[170:171], v7 offset:12288
    v_mfma_f32_16x16x32_bf16 v[36:39], a[140:143], v[76:79], v[36:39]
    ds_read_b64_tr_b16 a[172:173], v8 offset:8192
    ds_read_b64_tr_b16 a[174:175], v8 offset:12288
    v_mfma_f32_16x16x32_bf16 v[32:35], a[144:147], v[64:67], 0
    ds_read_b64_tr_b16 a[176:177], v9 offset:8192
    ds_read_b64_tr_b16 a[178:179], v9 offset:12288
    v_mfma_f32_16x16x32_bf16 v[32:35], a[148:151], v[68:71], v[32:35]
    ds_read_b64_tr_b16 a[180:181], v10 offset:8192
    ds_read_b64_tr_b16 a[182:183], v10 offset:12288
    v_mfma_f32_16x16x32_bf16 v[32:35], a[152:155], v[72:75], v[32:35]
    ds_read_b64_tr_b16 a[184:185], v11 offset:8192
    ds_read_b64_tr_b16 a[186:187], v11 offset:12288
    v_mfma_f32_16x16x32_bf16 v[32:35], a[156:159], v[76:79], v[32:35]
    ds_read_b64_tr_b16 a[188:189], v12 offset:8192
    ds_read_b64_tr_b16 a[190:191], v12 offset:12288
    v_mfma_f32_16x16x32_bf16 v[40:43], a[128:131], v[80:83], 0
    buffer_store_dwordx4 a[212:215], v0, s[20:23], s28 offen offset:2048 sc1
    v_mfma_f32_16x16x32_bf16 v[40:43], a[132:135], v[84:87], v[40:43]
    v_exp_f32 v36, v36
    v_mfma_f32_16x16x32_bf16 v[40:43], a[136:139], v[88:91], v[40:43]
    v_exp_f32 v37, v37
    v_mfma_f32_16x16x32_bf16 v[40:43], a[140:143], v[92:95], v[40:43]
    v_exp_f32 v38, v38
    v_mfma_f32_16x16x32_bf16 v[44:47], a[144:147], v[80:83], 0
    v_exp_f32 v39, v39
    v_mfma_f32_16x16x32_bf16 v[44:47], a[148:151], v[84:87], v[44:47]
    v_exp_f32 v32, v32
    v_mfma_f32_16x16x32_bf16 v[44:47], a[152:155], v[88:91], v[44:47]
    v_exp_f32 v33, v33
    v_mfma_f32_16x16x32_bf16 v[44:47], a[156:159], v[92:95], v[44:47]
    v_exp_f32 v34, v34
    v_mfma_f32_16x16x32_bf16 v[52:55], a[128:131], v[96:99], 0
    v_exp_f32 v35, v35
    v_mfma_f32_16x16x32_bf16 v[52:55], a[132:135], v[100:103], v[52:55]
    v_cvt_pk_bf16_f32 v36, v36, v37
    v_cvt_pk_bf16_f32 v37, v38, v39
    v_mfma_f32_16x16x32_bf16 v[52:55], a[136:139], v[104:107], v[52:55]
    v_cvt_pk_bf16_f32 v38, v32, v33
    v_cvt_pk_bf16_f32 v39, v34, v35
    v_mfma_f32_16x16x32_bf16 v[52:55], a[140:143], v[108:111], v[52:55]
    buffer_store_dwordx4 a[216:219], v0, s[20:23], s29 offen offset:0 sc1
    v_mfma_f32_16x16x32_bf16 v[48:51], a[144:147], v[96:99], 0
    v_exp_f32 v40, v40
    v_mfma_f32_16x16x32_bf16 v[48:51], a[148:151], v[100:103], v[48:51]
    v_exp_f32 v41, v41
    v_mfma_f32_16x16x32_bf16 v[48:51], a[152:155], v[104:107], v[48:51]
    v_exp_f32 v42, v42
    v_mfma_f32_16x16x32_bf16 v[48:51], a[156:159], v[108:111], v[48:51]
    v_exp_f32 v43, v43
    v_mfma_f32_16x16x32_bf16 v[56:59], a[128:131], v[112:115], v[20:23]
    v_exp_f32 v44, v44
    v_mfma_f32_16x16x32_bf16 v[56:59], a[132:135], v[116:119], v[56:59]
    v_exp_f32 v45, v45
    v_mfma_f32_16x16x32_bf16 v[56:59], a[136:139], v[120:123], v[56:59]
    v_exp_f32 v46, v46
    v_mfma_f32_16x16x32_bf16 v[56:59], a[140:143], v[124:127], v[56:59]
    v_exp_f32 v47, v47
    v_mfma_f32_16x16x32_bf16 v[60:63], a[144:147], v[112:115], v[20:23]
    v_cvt_pk_bf16_f32 v40, v40, v41
    v_cvt_pk_bf16_f32 v41, v42, v43
    v_mfma_f32_16x16x32_bf16 v[60:63], a[148:151], v[116:119], v[60:63]
    v_cvt_pk_bf16_f32 v42, v44, v45
    v_cvt_pk_bf16_f32 v43, v46, v47
    v_mfma_f32_16x16x32_bf16 v[60:63], a[152:155], v[120:123], v[60:63]
    v_exp_f32 v52, v52
    v_mfma_f32_16x16x32_bf16 v[60:63], a[156:159], v[124:127], v[60:63]
    s_waitcnt lgkmcnt(0)
    v_mfma_f32_16x16x32_bf16 v[128:131], a[160:163], v[36:39], v[128:131]
    buffer_store_dwordx4 a[220:223], v0, s[20:23], s29 offen offset:1024 sc1
    v_mfma_f32_16x16x32_bf16 v[132:135], a[164:167], v[36:39], v[132:135]
    v_exp_f32 v53, v53
    v_mfma_f32_16x16x32_bf16 v[136:139], a[168:171], v[36:39], v[136:139]
    v_exp_f32 v54, v54
    v_mfma_f32_16x16x32_bf16 v[140:143], a[172:175], v[36:39], v[140:143]
    v_exp_f32 v55, v55
    v_mfma_f32_16x16x32_bf16 v[144:147], a[176:179], v[36:39], v[144:147]
    v_exp_f32 v48, v48
    v_mfma_f32_16x16x32_bf16 v[148:151], a[180:183], v[36:39], v[148:151]
    v_exp_f32 v49, v49
    v_mfma_f32_16x16x32_bf16 v[152:155], a[184:187], v[36:39], v[152:155]
    v_exp_f32 v50, v50
    v_mfma_f32_16x16x32_bf16 v[156:159], a[188:191], v[36:39], v[156:159]
    v_exp_f32 v51, v51
    v_smfmac_f32_16x16x64_bf16 a[224:227], a[232:235], v[36:43], v19
    v_cvt_pk_bf16_f32 v52, v52, v53
    v_cvt_pk_bf16_f32 v53, v54, v55
    v_mfma_f32_16x16x32_bf16 v[160:163], a[160:163], v[40:43], v[160:163]
    v_cvt_pk_bf16_f32 v54, v48, v49
    v_cvt_pk_bf16_f32 v55, v50, v51
    v_mfma_f32_16x16x32_bf16 v[164:167], a[164:167], v[40:43], v[164:167]
    v_exp_f32 v56, v56
    v_mfma_f32_16x16x32_bf16 v[168:171], a[168:171], v[40:43], v[168:171]
    v_exp_f32 v57, v57
    v_mfma_f32_16x16x32_bf16 v[172:175], a[172:175], v[40:43], v[172:175]
    v_exp_f32 v58, v58
    v_mfma_f32_16x16x32_bf16 v[176:179], a[176:179], v[40:43], v[176:179]
    buffer_store_dwordx4 a[244:247], v0, s[20:23], s29 offen offset:2048 sc1
    v_mfma_f32_16x16x32_bf16 v[180:183], a[180:183], v[40:43], v[180:183]
    v_exp_f32 v59, v59
    v_mfma_f32_16x16x32_bf16 v[184:187], a[184:187], v[40:43], v[184:187]
    v_exp_f32 v60, v60
    v_mfma_f32_16x16x32_bf16 v[188:191], a[188:191], v[40:43], v[188:191]
    v_exp_f32 v61, v61
    v_mfma_f32_16x16x32_bf16 v[192:195], a[160:163], v[52:55], v[192:195]
    v_exp_f32 v62, v62
    v_mfma_f32_16x16x32_bf16 v[196:199], a[164:167], v[52:55], v[196:199]
    v_exp_f32 v63, v63
    v_mfma_f32_16x16x32_bf16 v[200:203], a[168:171], v[52:55], v[200:203]
    v_cvt_pk_bf16_f32 v56, v56, v57
    v_cvt_pk_bf16_f32 v57, v58, v59
    v_mfma_f32_16x16x32_bf16 v[204:207], a[172:175], v[52:55], v[204:207]
    v_cvt_pk_bf16_f32 v58, v60, v61
    v_cvt_pk_bf16_f32 v59, v62, v63
    v_mfma_f32_16x16x32_bf16 v[208:211], a[176:179], v[52:55], v[208:211]
    v_accvgpr_read_b32 v32, a224
    v_accvgpr_read_b32 v33, a225
    v_mfma_f32_16x16x32_bf16 v[212:215], a[180:183], v[52:55], v[212:215]
    v_accvgpr_read_b32 v34, a226
    v_accvgpr_read_b32 v35, a227
    v_mfma_f32_16x16x32_bf16 v[216:219], a[184:187], v[52:55], v[216:219]
    v_mfma_f32_16x16x32_bf16 v[220:223], a[188:191], v[52:55], v[220:223]
    v_smfmac_f32_16x16x64_bf16 a[228:231], a[232:235], v[52:59], v19
    v_mfma_f32_16x16x32_bf16 v[224:227], a[160:163], v[56:59], v[224:227]
    v_mfma_f32_16x16x32_bf16 v[228:231], a[164:167], v[56:59], v[228:231]
    v_mfma_f32_16x16x32_bf16 v[232:235], a[168:171], v[56:59], v[232:235]
    v_mfma_f32_16x16x32_bf16 v[236:239], a[172:175], v[56:59], v[236:239]
    v_mfma_f32_16x16x32_bf16 v[240:243], a[176:179], v[56:59], v[240:243]
    v_mfma_f32_16x16x32_bf16 v[244:247], a[180:183], v[56:59], v[244:247]
    v_mfma_f32_16x16x32_bf16 v[248:251], a[184:187], v[56:59], v[248:251]
    s_nop 4
    v_accvgpr_read_b32 v36, a228
    v_mfma_f32_16x16x32_bf16 v[252:255], a[188:191], v[56:59], v[252:255]
    v_accvgpr_read_b32 v37, a229
    v_accvgpr_read_b32 v38, a230
    v_accvgpr_read_b32 v39, a231
    v_add_f32 v28, v32, v33
    v_add_f32 v29, v34, v35
    v_add_f32 v30, v36, v37
    v_add_f32 v31, v38, v39
    v_add_f32 v32, v28, v29
    v_add_f32 v33, v30, v31
    v_min3_f32 v34, v28, v29, v30
    v_add_f32 v32, v32, v33
    v_min_f32 v34, v34, v31
    v_cmp_ngt_f32 vcc, s94, v32
    v_cmp_gt_f32_e64 s[4:5], s95, v34
    s_nop 0
    s_or_b64 s[4:5], s[4:5], vcc
    s_cbranch_scc1 L_tramp1
L_ret1:
    v_rcp_f32 v28, v28
    v_rcp_f32 v29, v29
    v_rcp_f32 v30, v30
    v_rcp_f32 v31, v31
    v_pk_mul_f32 v[128:129], v[128:129], v[28:29] op_sel_hi:[1,0]
    v_pk_mul_f32 v[130:131], v[130:131], v[28:29] op_sel_hi:[1,0]
    v_pk_mul_f32 v[132:133], v[132:133], v[28:29] op_sel_hi:[1,0]
    v_pk_mul_f32 v[134:135], v[134:135], v[28:29] op_sel_hi:[1,0]
    v_cvt_pk_bf16_f32 v128, v128, v129
    v_cvt_pk_bf16_f32 v129, v130, v131
    v_cvt_pk_bf16_f32 v130, v132, v133
    v_cvt_pk_bf16_f32 v131, v134, v135
    buffer_store_dwordx4 v[128:131], v24, s[40:43], s99 offen offset:0 sc1
    v_pk_mul_f32 v[136:137], v[136:137], v[28:29] op_sel_hi:[1,0]
    v_pk_mul_f32 v[138:139], v[138:139], v[28:29] op_sel_hi:[1,0]
    v_pk_mul_f32 v[140:141], v[140:141], v[28:29] op_sel_hi:[1,0]
    v_pk_mul_f32 v[142:143], v[142:143], v[28:29] op_sel_hi:[1,0]
    v_cvt_pk_bf16_f32 v136, v136, v137
    v_cvt_pk_bf16_f32 v137, v138, v139
    v_cvt_pk_bf16_f32 v138, v140, v141
    v_cvt_pk_bf16_f32 v139, v142, v143
    buffer_store_dwordx4 v[136:139], v24, s[40:43], s99 offen offset:1024 sc1
    v_pk_mul_f32 v[144:145], v[144:145], v[28:29] op_sel_hi:[1,0]
    v_pk_mul_f32 v[146:147], v[146:147], v[28:29] op_sel_hi:[1,0]
    v_pk_mul_f32 v[148:149], v[148:149], v[28:29] op_sel_hi:[1,0]
    v_pk_mul_f32 v[150:151], v[150:151], v[28:29] op_sel_hi:[1,0]
    v_cvt_pk_bf16_f32 v144, v144, v145
    v_cvt_pk_bf16_f32 v145, v146, v147
    v_cvt_pk_bf16_f32 v146, v148, v149
    v_cvt_pk_bf16_f32 v147, v150, v151
    buffer_store_dwordx4 v[144:147], v24, s[40:43], s100 offen offset:0 sc1
    v_pk_mul_f32 v[152:153], v[152:153], v[28:29] op_sel_hi:[1,0]
    v_pk_mul_f32 v[154:155], v[154:155], v[28:29] op_sel_hi:[1,0]
    v_pk_mul_f32 v[156:157], v[156:157], v[28:29] op_sel_hi:[1,0]
    v_pk_mul_f32 v[158:159], v[158:159], v[28:29] op_sel_hi:[1,0]
    v_cvt_pk_bf16_f32 v152, v152, v153
    v_cvt_pk_bf16_f32 v153, v154, v155
    v_cvt_pk_bf16_f32 v154, v156, v157
    v_cvt_pk_bf16_f32 v155, v158, v159
    buffer_store_dwordx4 v[152:155], v24, s[40:43], s100 offen offset:1024 sc1
    v_pk_mul_f32 v[160:161], v[160:161], v[28:29] op_sel:[0,1]
    v_pk_mul_f32 v[162:163], v[162:163], v[28:29] op_sel:[0,1]
    v_pk_mul_f32 v[164:165], v[164:165], v[28:29] op_sel:[0,1]
    v_pk_mul_f32 v[166:167], v[166:167], v[28:29] op_sel:[0,1]
    v_cvt_pk_bf16_f32 v160, v160, v161
    v_cvt_pk_bf16_f32 v161, v162, v163
    v_cvt_pk_bf16_f32 v162, v164, v165
    v_cvt_pk_bf16_f32 v163, v166, v167
    buffer_store_dwordx4 v[160:163], v25, s[40:43], s99 offen offset:0 sc1
    v_pk_mul_f32 v[168:169], v[168:169], v[28:29] op_sel:[0,1]
    v_pk_mul_f32 v[170:171], v[170:171], v[28:29] op_sel:[0,1]
    v_pk_mul_f32 v[172:173], v[172:173], v[28:29] op_sel:[0,1]
    v_pk_mul_f32 v[174:175], v[174:175], v[28:29] op_sel:[0,1]
    v_cvt_pk_bf16_f32 v168, v168, v169
    v_cvt_pk_bf16_f32 v169, v170, v171
    v_cvt_pk_bf16_f32 v170, v172, v173
    v_cvt_pk_bf16_f32 v171, v174, v175
    buffer_store_dwordx4 v[168:171], v25, s[40:43], s99 offen offset:1024 sc1
    v_pk_mul_f32 v[176:177], v[176:177], v[28:29] op_sel:[0,1]
    v_pk_mul_f32 v[178:179], v[178:179], v[28:29] op_sel:[0,1]
    v_pk_mul_f32 v[180:181], v[180:181], v[28:29] op_sel:[0,1]
    v_pk_mul_f32 v[182:183], v[182:183], v[28:29] op_sel:[0,1]
    v_cvt_pk_bf16_f32 v176, v176, v177
    v_cvt_pk_bf16_f32 v177, v178, v179
    v_cvt_pk_bf16_f32 v178, v180, v181
    v_cvt_pk_bf16_f32 v179, v182, v183
    buffer_store_dwordx4 v[176:179], v25, s[40:43], s100 offen offset:0 sc1
    v_pk_mul_f32 v[184:185], v[184:185], v[28:29] op_sel:[0,1]
    v_pk_mul_f32 v[186:187], v[186:187], v[28:29] op_sel:[0,1]
    v_pk_mul_f32 v[188:189], v[188:189], v[28:29] op_sel:[0,1]
    v_pk_mul_f32 v[190:191], v[190:191], v[28:29] op_sel:[0,1]
    v_cvt_pk_bf16_f32 v184, v184, v185
    v_cvt_pk_bf16_f32 v185, v186, v187
    v_cvt_pk_bf16_f32 v186, v188, v189
    v_cvt_pk_bf16_f32 v187, v190, v191
    buffer_store_dwordx4 v[184:187], v25, s[40:43], s100 offen offset:1024 sc1
    v_pk_mul_f32 v[192:193], v[192:193], v[30:31] op_sel_hi:[1,0]
    v_pk_mul_f32 v[194:195], v[194:195], v[30:31] op_sel_hi:[1,0]
    v_pk_mul_f32 v[196:197], v[196:197], v[30:31] op_sel_hi:[1,0]
    v_pk_mul_f32 v[198:199], v[198:199], v[30:31] op_sel_hi:[1,0]
    v_cvt_pk_bf16_f32 v192, v192, v193
    v_cvt_pk_bf16_f32 v193, v194, v195
    v_cvt_pk_bf16_f32 v194, v196, v197
    v_cvt_pk_bf16_f32 v195, v198, v199
    buffer_store_dwordx4 v[192:195], v26, s[40:43], s99 offen offset:0 sc1
    v_pk_mul_f32 v[200:201], v[200:201], v[30:31] op_sel_hi:[1,0]
    v_pk_mul_f32 v[202:203], v[202:203], v[30:31] op_sel_hi:[1,0]
    v_pk_mul_f32 v[204:205], v[204:205], v[30:31] op_sel_hi:[1,0]
    v_pk_mul_f32 v[206:207], v[206:207], v[30:31] op_sel_hi:[1,0]
    v_cvt_pk_bf16_f32 v200, v200, v201
    v_cvt_pk_bf16_f32 v201, v202, v203
    v_cvt_pk_bf16_f32 v202, v204, v205
    v_cvt_pk_bf16_f32 v203, v206, v207
    buffer_store_dwordx4 v[200:203], v26, s[40:43], s99 offen offset:1024 sc1
    v_pk_mul_f32 v[208:209], v[208:209], v[30:31] op_sel_hi:[1,0]
    v_pk_mul_f32 v[210:211], v[210:211], v[30:31] op_sel_hi:[1,0]
    v_pk_mul_f32 v[212:213], v[212:213], v[30:31] op_sel_hi:[1,0]
    v_pk_mul_f32 v[214:215], v[214:215], v[30:31] op_sel_hi:[1,0]
    v_cvt_pk_bf16_f32 v208, v208, v209
    v_cvt_pk_bf16_f32 v209, v210, v211
    v_cvt_pk_bf16_f32 v210, v212, v213
    v_cvt_pk_bf16_f32 v211, v214, v215
    buffer_store_dwordx4 v[208:211], v26, s[40:43], s100 offen offset:0 sc1
    v_pk_mul_f32 v[216:217], v[216:217], v[30:31] op_sel_hi:[1,0]
    v_pk_mul_f32 v[218:219], v[218:219], v[30:31] op_sel_hi:[1,0]
    v_pk_mul_f32 v[220:221], v[220:221], v[30:31] op_sel_hi:[1,0]
    v_pk_mul_f32 v[222:223], v[222:223], v[30:31] op_sel_hi:[1,0]
    v_cvt_pk_bf16_f32 v216, v216, v217
    v_cvt_pk_bf16_f32 v217, v218, v219
    v_cvt_pk_bf16_f32 v218, v220, v221
    v_cvt_pk_bf16_f32 v219, v222, v223
    buffer_store_dwordx4 v[216:219], v26, s[40:43], s100 offen offset:1024 sc1
    v_pk_mul_f32 v[224:225], v[224:225], v[30:31] op_sel:[0,1]
    v_pk_mul_f32 v[226:227], v[226:227], v[30:31] op_sel:[0,1]
    v_pk_mul_f32 v[228:229], v[228:229], v[30:31] op_sel:[0,1]
    v_pk_mul_f32 v[230:231], v[230:231], v[30:31] op_sel:[0,1]
    v_cvt_pk_bf16_f32 v224, v224, v225
    v_cvt_pk_bf16_f32 v225, v226, v227
    v_cvt_pk_bf16_f32 v226, v228, v229
    v_cvt_pk_bf16_f32 v227, v230, v231
    buffer_store_dwordx4 v[224:227], v27, s[40:43], s99 offen offset:0 sc1
    v_pk_mul_f32 v[232:233], v[232:233], v[30:31] op_sel:[0,1]
    v_pk_mul_f32 v[234:235], v[234:235], v[30:31] op_sel:[0,1]
    v_pk_mul_f32 v[236:237], v[236:237], v[30:31] op_sel:[0,1]
    v_pk_mul_f32 v[238:239], v[238:239], v[30:31] op_sel:[0,1]
    v_cvt_pk_bf16_f32 v232, v232, v233
    v_cvt_pk_bf16_f32 v233, v234, v235
    v_cvt_pk_bf16_f32 v234, v236, v237
    v_cvt_pk_bf16_f32 v235, v238, v239
    buffer_store_dwordx4 v[232:235], v27, s[40:43], s99 offen offset:1024 sc1
    v_pk_mul_f32 v[240:241], v[240:241], v[30:31] op_sel:[0,1]
    v_pk_mul_f32 v[242:243], v[242:243], v[30:31] op_sel:[0,1]
    v_pk_mul_f32 v[244:245], v[244:245], v[30:31] op_sel:[0,1]
    v_pk_mul_f32 v[246:247], v[246:247], v[30:31] op_sel:[0,1]
    v_cvt_pk_bf16_f32 v240, v240, v241
    v_cvt_pk_bf16_f32 v241, v242, v243
    v_cvt_pk_bf16_f32 v242, v244, v245
    v_cvt_pk_bf16_f32 v243, v246, v247
    buffer_store_dwordx4 v[240:243], v27, s[40:43], s100 offen offset:0 sc1
    v_pk_mul_f32 v[248:249], v[248:249], v[30:31] op_sel:[0,1]
    v_pk_mul_f32 v[250:251], v[250:251], v[30:31] op_sel:[0,1]
    v_pk_mul_f32 v[252:253], v[252:253], v[30:31] op_sel:[0,1]
    v_pk_mul_f32 v[254:255], v[254:255], v[30:31] op_sel:[0,1]
    v_cvt_pk_bf16_f32 v248, v248, v249
    v_cvt_pk_bf16_f32 v249, v250, v251
    v_cvt_pk_bf16_f32 v250, v252, v253
    v_cvt_pk_bf16_f32 v251, v254, v255
    buffer_store_dwordx4 v[248:251], v27, s[40:43], s100 offen offset:1024 sc1
L_k1_end:
    s_endpgm
.p2align 6
L_qs:
    v_mfma_f32_16x16x32_bf16 v[128:131], a[160:163], a[192:195], v[128:131]
    ds_read_b64_tr_b16 a[176:177], v56 offset:16384
    ds_read_b64_tr_b16 a[178:179], v56 offset:18432
    v_mfma_f32_16x16x32_bf16 v[160:163], a[160:163], a[196:199], v[160:163]
    ds_read_b128 a[208:211], v49 offset:0
    ds_read_b128 a[216:219], v51 offset:0
    v_mfma_f32_16x16x32_bf16 v[192:195], a[160:163], a[200:203], v[192:195]
    ds_read_b128 a[212:215], v49 offset:2048
    ds_read_b128 a[220:223], v51 offset:2048
    v_mfma_f32_16x16x32_bf16 v[132:135], a[164:167], a[192:195], v[132:135]
    ds_read_b64_tr_b16 a[180:181], v57 offset:16384
    ds_read_b64_tr_b16 a[182:183], v57 offset:18432
    v_mfma_f32_16x16x32_bf16 v[164:167], a[164:167], a[196:199], v[164:167]
    v_xor_b32 v49, 49152, v49
    v_xor_b32 v51, 98304, v51
    v_mfma_f32_16x16x32_bf16 v[196:199], a[164:167], a[200:203], v[196:199]
    s_waitcnt lgkmcnt(8)
    v_mfma_f32_16x16x32_bf16 v[136:139], a[168:171], a[192:195], v[136:139]
    ds_read_b64_tr_b16 a[184:185], v58 offset:16384
    ds_read_b64_tr_b16 a[186:187], v58 offset:18432
    v_mfma_f32_16x16x32_bf16 v[168:171], a[168:171], a[196:199], v[168:171]
    v_mfma_f32_16x16x32_bf16 v[200:203], a[168:171], a[200:203], v[200:203]
    v_mfma_f32_16x16x32_bf16 v[140:143], a[172:175], a[192:195], v[140:143]
    ds_read_b64_tr_b16 a[188:189], v59 offset:16384
    ds_read_b64_tr_b16 a[190:191], v59 offset:18432
    v_mfma_f32_16x16x32_bf16 v[172:175], a[172:175], a[196:199], v[172:175]
    v_mfma_f32_16x16x32_bf16 v[204:207], a[172:175], a[200:203], v[204:207]
    s_waitcnt lgkmcnt(4)
    v_mfma_f32_16x16x32_bf16 v[144:147], a[176:179], a[192:195], v[144:147]
    ds_read_b64_tr_b16 a[160:161], v52 offset:16640
    ds_read_b64_tr_b16 a[162:163], v52 offset:18688
    v_mfma_f32_16x16x32_bf16 v[176:179], a[176:179], a[196:199], v[176:179]
    s_mov_b32 m0, s90
    v_mfma_f32_16x16x32_bf16 v[208:211], a[176:179], a[200:203], v[208:211]
    buffer_load_dwordx4 v32, s[44:47], s87 offen offset:0 lds
    v_mfma_f32_16x16x32_bf16 v[148:151], a[180:183], a[192:195], v[148:151]
    ds_read_b64_tr_b16 a[164:165], v53 offset:16640
    ds_read_b64_tr_b16 a[166:167], v53 offset:18688
    v_mfma_f32_16x16x32_bf16 v[180:183], a[180:183], a[196:199], v[180:183]
    v_mfma_f32_16x16x32_bf16 v[212:215], a[180:183], a[200:203], v[212:215]
    buffer_load_dwordx4 v33, s[44:47], s87 offen offset:1024 lds
    s_waitcnt lgkmcnt(4)
    v_mfma_f32_16x16x32_bf16 v[152:155], a[184:187], a[192:195], v[152:155]
    ds_read_b64_tr_b16 a[168:169], v54 offset:16640
    ds_read_b64_tr_b16 a[170:171], v54 offset:18688
    v_mfma_f32_16x16x32_bf16 v[184:187], a[184:187], a[196:199], v[184:187]
    v_mfma_f32_16x16x32_bf16 v[216:219], a[184:187], a[200:203], v[216:219]
    buffer_load_dwordx4 v34, s[44:47], s87 offen offset:2048 lds
    v_mfma_f32_16x16x32_bf16 v[156:159], a[188:191], a[192:195], v[156:159]
    ds_read_b64_tr_b16 a[172:173], v55 offset:16640
    ds_read_b64_tr_b16 a[174:175], v55 offset:18688
    v_mfma_f32_16x16x32_bf16 v[188:191], a[188:191], a[196:199], v[188:191]
    v_mfma_f32_16x16x32_bf16 v[220:223], a[188:191], a[200:203], v[220:223]
    buffer_load_dwordx4 v35, s[44:47], s87 offen offset:3072 lds
    s_waitcnt lgkmcnt(4)
    v_mfma_f32_16x16x32_bf16 a[0:3], a[160:163], a[192:195], a[0:3]
    ds_read_b64_tr_b16 a[176:177], v56 offset:16640
    ds_read_b64_tr_b16 a[178:179], v56 offset:18688
    v_mfma_f32_16x16x32_bf16 a[32:35], a[160:163], a[196:199], a[32:35]
    s_xor_b32 s90, s90, 49152
    v_mfma_f32_16x16x32_bf16 a[64:67], a[160:163], a[200:203], a[64:67]
    s_or_b32 s8, s31, s10
    s_lshr_b32 s9, s6, 4
    s_cmp_lt_u32 s93, 3
    s_cselect_b32 s8, 2130706432, s8
    v_mfma_f32_16x16x32_bf16 a[4:7], a[164:167], a[192:195], a[4:7]
    ds_read_b64_tr_b16 a[180:181], v57 offset:16640
    ds_read_b64_tr_b16 a[182:183], v57 offset:18688
    v_mfma_f32_16x16x32_bf16 a[36:39], a[164:167], a[196:199], a[36:39]
    v_xor_b32 v64, s9, v13
    v_mfma_f32_16x16x32_bf16 a[68:71], a[164:167], a[200:203], a[68:71]
    s_waitcnt lgkmcnt(4)
    v_mfma_f32_16x16x32_bf16 a[8:11], a[168:171], a[192:195], a[8:11]
    ds_read_b64_tr_b16 a[184:185], v58 offset:16640
    ds_read_b64_tr_b16 a[186:187], v58 offset:18688
    v_mfma_f32_16x16x32_bf16 a[40:43], a[168:171], a[196:199], a[40:43]
    v_mfma_f32_16x16x32_bf16 a[72:75], a[168:171], a[200:203], a[72:75]
    v_mfma_f32_16x16x32_bf16 a[12:15], a[172:175], a[192:195], a[12:15]
    ds_read_b64_tr_b16 a[188:189], v59 offset:16640
    ds_read_b64_tr_b16 a[190:191], v59 offset:18688
    v_mfma_f32_16x16x32_bf16 a[44:47], a[172:175], a[196:199], a[44:47]
    v_mfma_f32_16x16x32_bf16 a[76:79], a[172:175], a[200:203], a[76:79]
    s_waitcnt vmcnt(14)
    s_barrier
    s_waitcnt lgkmcnt(4)
    v_mfma_f32_16x16x32_bf16 a[16:19], a[176:179], a[192:195], a[16:19]
    ds_read_b64_tr_b16 a[160:161], v52 offset:0
    ds_read_b64_tr_b16 a[162:163], v52 offset:2048
    v_mfma_f32_16x16x32_bf16 a[48:51], a[176:179], a[196:199], a[48:51]
    s_xor_b32 m0, s92, 229376
    v_mfma_f32_16x16x32_bf16 a[80:83], a[176:179], a[200:203], a[80:83]
    buffer_load_dwordx4 v40, s[52:55], s88 offen offset:0 lds
    v_mfma_f32_16x16x32_bf16 a[20:23], a[180:183], a[192:195], a[20:23]
    ds_read_b64_tr_b16 a[164:165], v53 offset:0
    ds_read_b64_tr_b16 a[166:167], v53 offset:2048
    v_mfma_f32_16x16x32_bf16 a[52:55], a[180:183], a[196:199], a[52:55]
    buffer_load_dwordx4 v41, s[52:55], s88 offen offset:1024 lds
    v_mfma_f32_16x16x32_bf16 a[84:87], a[180:183], a[200:203], a[84:87]
    s_waitcnt lgkmcnt(4)
    v_mfma_f32_16x16x32_bf16 a[24:27], a[184:187], a[192:195], a[24:27]
    ds_read_b64_tr_b16 a[168:169], v54 offset:0
    ds_read_b64_tr_b16 a[170:171], v54 offset:2048
    v_mfma_f32_16x16x32_bf16 a[56:59], a[184:187], a[196:199], a[56:59]
    buffer_load_dwordx4 v42, s[52:55], s88 offen offset:2048 lds
    v_mfma_f32_16x16x32_bf16 a[88:91], a[184:187], a[200:203], a[88:91]
    v_mfma_f32_16x16x32_bf16 a[28:31], a[188:191], a[192:195], a[28:31]
    ds_read_b64_tr_b16 a[172:173], v55 offset:0
    ds_read_b64_tr_b16 a[174:175], v55 offset:2048
    v_mfma_f32_16x16x32_bf16 a[60:63], a[188:191], a[196:199], a[60:63]
    buffer_load_dwordx4 v43, s[52:55], s88 offen offset:3072 lds
    v_mfma_f32_16x16x32_bf16 a[92:95], a[188:191], a[200:203], a[92:95]
    s_add_u32 s88, s88, 524288
    s_cmp_eq_u32 s88, 4980736
    s_cselect_b32 s88, 262144, s88
    s_or_b32 m0, s68, s6
    s_nop 0
    buffer_load_dwordx4 v64, s[32:35], s8 offen offset:0 nt lds
    s_waitcnt lgkmcnt(4)
    v_mfma_f32_16x16x32_bf16 v[128:131], a[160:163], a[208:211], v[128:131]
    ds_read_b64_tr_b16 a[176:177], v56 offset:0
    ds_read_b64_tr_b16 a[178:179], v56 offset:2048
    v_mfma_f32_16x16x32_bf16 v[160:163], a[160:163], a[212:215], v[160:163]
    s_mov_b32 m0, s91
    v_mfma_f32_16x16x32_bf16 v[192:195], a[160:163], a[216:219], v[192:195]
    buffer_load_dwordx4 v36, s[48:51], s87 offen offset:0 lds
    v_mfma_f32_16x16x32_bf16 v[132:135], a[164:167], a[208:211], v[132:135]
    ds_read_b64_tr_b16 a[180:181], v57 offset:0
    ds_read_b64_tr_b16 a[182:183], v57 offset:2048
    v_mfma_f32_16x16x32_bf16 v[164:167], a[164:167], a[212:215], v[164:167]
    v_mfma_f32_16x16x32_bf16 v[196:199], a[164:167], a[216:219], v[196:199]
    buffer_load_dwordx4 v37, s[48:51], s87 offen offset:1024 lds
    s_waitcnt lgkmcnt(4)
    v_mfma_f32_16x16x32_bf16 v[136:139], a[168:171], a[208:211], v[136:139]
    ds_read_b64_tr_b16 a[184:185], v58 offset:0
    ds_read_b64_tr_b16 a[186:187], v58 offset:2048
    v_mfma_f32_16x16x32_bf16 v[168:171], a[168:171], a[212:215], v[168:171]
    v_mfma_f32_16x16x32_bf16 v[200:203], a[168:171], a[216:219], v[200:203]
    buffer_load_dwordx4 v38, s[48:51], s87 offen offset:2048 lds
    v_mfma_f32_16x16x32_bf16 v[140:143], a[172:175], a[208:211], v[140:143]
    ds_read_b64_tr_b16 a[188:189], v59 offset:0
    ds_read_b64_tr_b16 a[190:191], v59 offset:2048
    v_mfma_f32_16x16x32_bf16 v[172:175], a[172:175], a[212:215], v[172:175]
    v_mfma_f32_16x16x32_bf16 v[204:207], a[172:175], a[216:219], v[204:207]
    buffer_load_dwordx4 v39, s[48:51], s87 offen offset:3072 lds
    s_waitcnt lgkmcnt(4)
    v_mfma_f32_16x16x32_bf16 v[144:147], a[176:179], a[208:211], v[144:147]
    ds_read_b64_tr_b16 a[160:161], v52 offset:256
    ds_read_b64_tr_b16 a[162:163], v52 offset:2304
    v_mfma_f32_16x16x32_bf16 v[176:179], a[176:179], a[212:215], v[176:179]
    s_xor_b32 s91, s91, 98304
    v_mfma_f32_16x16x32_bf16 v[208:211], a[176:179], a[216:219], v[208:211]
    s_add_u32 s87, s87, 128
    s_cmp_eq_u32 s87, 1152
    s_cselect_b32 s87, 0, s87
    v_xor_b32 v52, 229376, v52
    v_mfma_f32_16x16x32_bf16 v[148:151], a[180:183], a[208:211], v[148:151]
    ds_read_b64_tr_b16 a[164:165], v53 offset:256
    ds_read_b64_tr_b16 a[166:167], v53 offset:2304
    v_mfma_f32_16x16x32_bf16 v[180:183], a[180:183], a[212:215], v[180:183]
    v_xor_b32 v53, 229376, v53
    v_mfma_f32_16x16x32_bf16 v[212:215], a[180:183], a[216:219], v[212:215]
    s_waitcnt lgkmcnt(4)
    v_mfma_f32_16x16x32_bf16 v[152:155], a[184:187], a[208:211], v[152:155]
    ds_read_b64_tr_b16 a[168:169], v54 offset:256
    ds_read_b64_tr_b16 a[170:171], v54 offset:2304
    v_mfma_f32_16x16x32_bf16 v[184:187], a[184:187], a[212:215], v[184:187]
    v_xor_b32 v54, 229376, v54
    v_mfma_f32_16x16x32_bf16 v[216:219], a[184:187], a[216:219], v[216:219]
    v_mfma_f32_16x16x32_bf16 v[156:159], a[188:191], a[208:211], v[156:159]
    ds_read_b64_tr_b16 a[172:173], v55 offset:256
    ds_read_b64_tr_b16 a[174:175], v55 offset:2304
    v_mfma_f32_16x16x32_bf16 v[188:191], a[188:191], a[212:215], v[188:191]
    v_xor_b32 v55, 229376, v55
    v_mfma_f32_16x16x32_bf16 v[220:223], a[188:191], a[216:219], v[220:223]
    s_waitcnt lgkmcnt(4)
    v_mfma_f32_16x16x32_bf16 a[0:3], a[160:163], a[208:211], a[0:3]
    ds_read_b64_tr_b16 a[176:177], v56 offset:256
    ds_read_b64_tr_b16 a[178:179], v56 offset:2304
    v_mfma_f32_16x16x32_bf16 a[32:35], a[160:163], a[212:215], a[32:35]
    v_xor_b32 v56, 229376, v56
    v_mfma_f32_16x16x32_bf16 a[64:67], a[160:163], a[216:219], a[64:67]
    s_lshr_b32 s9, s6, 3
    s_and_b32 s9, s9, 128
    v_xor_b32 v64, s9, v17
    v_mfma_f32_16x16x32_bf16 a[4:7], a[164:167], a[208:211], a[4:7]
    ds_read_b64_tr_b16 a[180:181], v57 offset:256
    ds_read_b64_tr_b16 a[182:183], v57 offset:2304
    v_mfma_f32_16x16x32_bf16 a[36:39], a[164:167], a[212:215], a[36:39]
    v_xor_b32 v57, 229376, v57
    s_waitcnt vmcnt(17)
    v_mfma_f32_16x16x32_bf16 a[68:71], a[164:167], a[216:219], a[68:71]
    ds_read_b128 a[192:195], v48 offset:0
    ds_read_b128 a[200:203], v50 offset:0
    s_waitcnt lgkmcnt(6)
    v_mfma_f32_16x16x32_bf16 a[8:11], a[168:171], a[208:211], a[8:11]
    ds_read_b64_tr_b16 a[184:185], v58 offset:256
    ds_read_b64_tr_b16 a[186:187], v58 offset:2304
    v_mfma_f32_16x16x32_bf16 a[40:43], a[168:171], a[212:215], a[40:43]
    ds_read_b128 a[196:199], v48 offset:2048
    ds_read_b128 a[204:207], v50 offset:2048
    v_mfma_f32_16x16x32_bf16 a[72:75], a[168:171], a[216:219], a[72:75]
    v_xor_b32 v48, 49152, v48
    v_xor_b32 v50, 98304, v50
    v_xor_b32 v58, 229376, v58
    v_mfma_f32_16x16x32_bf16 a[12:15], a[172:175], a[208:211], a[12:15]
    ds_read_b64_tr_b16 a[188:189], v59 offset:256
    ds_read_b64_tr_b16 a[190:191], v59 offset:2304
    v_mfma_f32_16x16x32_bf16 a[44:47], a[172:175], a[212:215], a[44:47]
    v_xor_b32 v59, 229376, v59
    v_mfma_f32_16x16x32_bf16 a[76:79], a[172:175], a[216:219], a[76:79]
    s_waitcnt vmcnt(13)
    s_barrier
    s_waitcnt lgkmcnt(8)
    v_mfma_f32_16x16x32_bf16 a[16:19], a[176:179], a[208:211], a[16:19]
    ds_read_b64_tr_b16 a[160:161], v52 offset:16384
    ds_read_b64_tr_b16 a[162:163], v52 offset:18432
    v_mfma_f32_16x16x32_bf16 a[48:51], a[176:179], a[212:215], a[48:51]
    s_add_u32 m0, s92, 16384
    v_mfma_f32_16x16x32_bf16 a[80:83], a[176:179], a[216:219], a[80:83]
    buffer_load_dwordx4 v44, s[56:59], s89 offen offset:0 lds
    s_xor_b32 s92, s92, 229376
    v_mfma_f32_16x16x32_bf16 a[20:23], a[180:183], a[208:211], a[20:23]
    ds_read_b64_tr_b16 a[164:165], v53 offset:16384
    ds_read_b64_tr_b16 a[166:167], v53 offset:18432
    v_mfma_f32_16x16x32_bf16 a[52:55], a[180:183], a[212:215], a[52:55]
    buffer_load_dwordx4 v45, s[56:59], s89 offen offset:1024 lds
    v_mfma_f32_16x16x32_bf16 a[84:87], a[180:183], a[216:219], a[84:87]
    s_or_b32 s9, s6, 65536
    s_xor_b32 s6, s6, s7
    s_waitcnt lgkmcnt(4)
    v_mfma_f32_16x16x32_bf16 a[24:27], a[184:187], a[208:211], a[24:27]
    ds_read_b64_tr_b16 a[168:169], v54 offset:16384
    ds_read_b64_tr_b16 a[170:171], v54 offset:18432
    v_mfma_f32_16x16x32_bf16 a[56:59], a[184:187], a[212:215], a[56:59]
    buffer_load_dwordx4 v46, s[56:59], s89 offen offset:2048 lds
    v_mfma_f32_16x16x32_bf16 a[88:91], a[184:187], a[216:219], a[88:91]
    s_xor_b32 s10, s10, s11
    s_xor_b32 s11, s11, 133120
    s_xor_b32 s7, s7, 3072
    v_mfma_f32_16x16x32_bf16 a[28:31], a[188:191], a[208:211], a[28:31]
    ds_read_b64_tr_b16 a[172:173], v55 offset:16384
    ds_read_b64_tr_b16 a[174:175], v55 offset:18432
    v_mfma_f32_16x16x32_bf16 a[60:63], a[188:191], a[212:215], a[60:63]
    buffer_load_dwordx4 v47, s[56:59], s89 offen offset:3072 lds
    v_mfma_f32_16x16x32_bf16 a[92:95], a[188:191], a[216:219], a[92:95]
    s_add_u32 s89, s89, 524288
    s_cmp_eq_u32 s89, 4718592
    s_cselect_b32 s89, 0, s89
    s_or_b32 m0, s68, s9
    s_nop 0
    buffer_load_dwordx4 v64, s[36:39], s8 offen offset:0 nt lds
    s_waitcnt lgkmcnt(4)
    s_add_u32 s93, s93, 1
    s_cmp_lg_u32 s93, s30
    s_cbranch_scc1 L_qs
    s_branch L_qtail
.p2align 6
L_atts:
    v_mfma_f32_16x16x32_bf16 v[36:39], a[128:131], v[64:67], 0
    ds_read_b64_tr_b16 a[160:161], v5 offset:8192
    ds_read_b64_tr_b16 a[162:163], v5 offset:12288
    v_mfma_f32_16x16x32_bf16 v[36:39], a[132:135], v[68:71], v[36:39]
    ds_read_b64_tr_b16 a[164:165], v6 offset:8192
    ds_read_b64_tr_b16 a[166:167], v6 offset:12288
    v_mfma_f32_16x16x32_bf16 v[36:39], a[136:139], v[72:75], v[36:39]
    ds_read_b64_tr_b16 a[168:169], v7 offset:8192
    ds_read_b64_tr_b16 a[170:171], v7 offset:12288
    v_mfma_f32_16x16x32_bf16 v[36:39], a[140:143], v[76:79], v[36:39]
    ds_read_b64_tr_b16 a[172:173], v8 offset:8192
    ds_read_b64_tr_b16 a[174:175], v8 offset:12288
    v_mfma_f32_16x16x32_bf16 v[32:35], a[144:147], v[64:67], 0
    ds_read_b64_tr_b16 a[176:177], v9 offset:8192
    ds_read_b64_tr_b16 a[178:179], v9 offset:12288
    v_mfma_f32_16x16x32_bf16 v[32:35], a[148:151], v[68:71], v[32:35]
    ds_read_b64_tr_b16 a[180:181], v10 offset:8192
    ds_read_b64_tr_b16 a[182:183], v10 offset:12288
    v_mfma_f32_16x16x32_bf16 v[32:35], a[152:155], v[72:75], v[32:35]
    ds_read_b64_tr_b16 a[184:185], v11 offset:8192
    ds_read_b64_tr_b16 a[186:187], v11 offset:12288
    v_mfma_f32_16x16x32_bf16 v[32:35], a[156:159], v[76:79], v[32:35]
    ds_read_b64_tr_b16 a[188:189], v12 offset:8192
    ds_read_b64_tr_b16 a[190:191], v12 offset:12288
    v_mfma_f32_16x16x32_bf16 v[40:43], a[128:131], v[80:83], 0
    v_exp_f32 v36, v36
    v_mfma_f32_16x16x32_bf16 v[40:43], a[132:135], v[84:87], v[40:43]
    v_exp_f32 v37, v37
    v_mfma_f32_16x16x32_bf16 v[40:43], a[136:139], v[88:91], v[40:43]
    v_exp_f32 v38, v38
    v_mfma_f32_16x16x32_bf16 v[40:43], a[140:143], v[92:95], v[40:43]
    v_exp_f32 v39, v39
    v_mfma_f32_16x16x32_bf16 v[44:47], a[144:147], v[80:83], 0
    v_exp_f32 v32, v32
    v_mfma_f32_16x16x32_bf16 v[44:47], a[148:151], v[84:87], v[44:47]
    v_exp_f32 v33, v33
    v_mfma_f32_16x16x32_bf16 v[44:47], a[152:155], v[88:91], v[44:47]
    v_exp_f32 v34, v34
    v_mfma_f32_16x16x32_bf16 v[44:47], a[156:159], v[92:95], v[44:47]
    v_exp_f32 v35, v35
    v_mfma_f32_16x16x32_bf16 v[52:55], a[128:131], v[96:99], 0
    v_cvt_pk_bf16_f32 v36, v36, v37
    v_cvt_pk_bf16_f32 v37, v38, v39
    v_mfma_f32_16x16x32_bf16 v[52:55], a[132:135], v[100:103], v[52:55]
    v_cvt_pk_bf16_f32 v38, v32, v33
    v_cvt_pk_bf16_f32 v39, v34, v35
    v_mfma_f32_16x16x32_bf16 v[52:55], a[136:139], v[104:107], v[52:55]
    v_exp_f32 v40, v40
    v_mfma_f32_16x16x32_bf16 v[52:55], a[140:143], v[108:111], v[52:55]
    v_exp_f32 v41, v41
    v_mfma_f32_16x16x32_bf16 v[48:51], a[144:147], v[96:99], 0
    v_exp_f32 v42, v42
    v_mfma_f32_16x16x32_bf16 v[48:51], a[148:151], v[100:103], v[48:51]
    v_exp_f32 v43, v43
    v_mfma_f32_16x16x32_bf16 v[48:51], a[152:155], v[104:107], v[48:51]
    v_exp_f32 v44, v44
    v_mfma_f32_16x16x32_bf16 v[48:51], a[156:159], v[108:111], v[48:51]
    v_exp_f32 v45, v45
    s_nop 7
    v_exp_f32 v46, v46
    s_nop 0
    v_exp_f32 v47, v47
    s_nop 0
    v_cvt_pk_bf16_f32 v40, v40, v41
    v_cvt_pk_bf16_f32 v41, v42, v43
    v_cvt_pk_bf16_f32 v42, v44, v45
    v_cvt_pk_bf16_f32 v43, v46, v47
    v_exp_f32 v52, v52
    s_nop 0
    v_exp_f32 v53, v53
    s_nop 0
    v_exp_f32 v54, v54
    s_nop 0
    v_cvt_pk_bf16_f32 v52, v52, v53
    s_waitcnt lgkmcnt(0)
    v_mfma_f32_16x16x32_bf16 v[128:131], a[160:163], v[36:39], v[128:131]
    v_exp_f32 v55, v55
    v_mfma_f32_16x16x32_bf16 v[132:135], a[164:167], v[36:39], v[132:135]
    v_exp_f32 v48, v48
    v_mfma_f32_16x16x32_bf16 v[136:139], a[168:171], v[36:39], v[136:139]
    v_exp_f32 v49, v49
    v_mfma_f32_16x16x32_bf16 v[140:143], a[172:175], v[36:39], v[140:143]
    v_exp_f32 v50, v50
    v_mfma_f32_16x16x32_bf16 v[144:147], a[176:179], v[36:39], v[144:147]
    s_waitcnt vmcnt(16)
    s_barrier
    v_mfma_f32_16x16x32_bf16 v[148:151], a[180:183], v[36:39], v[148:151]
    ds_read_b128 a[128:131], v1 offset:0
    ds_read_b128 a[132:135], v2 offset:0
    v_mfma_f32_16x16x32_bf16 v[152:155], a[184:187], v[36:39], v[152:155]
    s_xor_b32 s12, s81, s31
    s_mov_b32 m0, s83
    v_mfma_f32_16x16x32_bf16 v[156:159], a[188:191], v[36:39], v[156:159]
    buffer_load_dwordx4 v13, s[32:35], s12 offen offset:0 nt lds
    v_smfmac_f32_16x16x64_bf16 a[224:227], a[232:235], v[36:43], v19
    v_exp_f32 v51, v51
    v_mfma_f32_16x16x32_bf16 v[160:163], a[160:163], v[40:43], v[160:163]
    v_cvt_pk_bf16_f32 v53, v54, v55
    v_cvt_pk_bf16_f32 v54, v48, v49
    v_mfma_f32_16x16x32_bf16 v[164:167], a[164:167], v[40:43], v[164:167]
    v_cvt_pk_bf16_f32 v55, v50, v51
    v_xor_b32 v5, s84, v5
    v_mfma_f32_16x16x32_bf16 v[168:171], a[168:171], v[40:43], v[168:171]
    buffer_load_dwordx4 v14, s[32:35], s12 offen offset:1024 nt lds
    v_mfma_f32_16x16x32_bf16 v[172:175], a[172:175], v[40:43], v[172:175]
    v_xor_b32 v6, s84, v6
    v_xor_b32 v7, s84, v7
    v_mfma_f32_16x16x32_bf16 v[176:179], a[176:179], v[40:43], v[176:179]
    v_xor_b32 v8, s84, v8
    v_xor_b32 v9, s84, v9
    v_mfma_f32_16x16x32_bf16 v[180:183], a[180:183], v[40:43], v[180:183]
    ds_read_b128 a[136:139], v3 offset:0
    ds_read_b128 a[140:143], v4 offset:0
    v_mfma_f32_16x16x32_bf16 v[184:187], a[184:187], v[40:43], v[184:187]
    ds_read_b128 a[144:147], v1 offset:4096
    ds_read_b128 a[148:151], v2 offset:4096
    v_mfma_f32_16x16x32_bf16 v[188:191], a[188:191], v[40:43], v[188:191]
    v_xor_b32 v10, s84, v10
    v_xor_b32 v11, s84, v11
    v_mfma_f32_16x16x32_bf16 v[192:195], a[160:163], v[52:55], v[192:195]
    v_xor_b32 v12, s84, v12
    v_mfma_f32_16x16x32_bf16 v[196:199], a[164:167], v[52:55], v[196:199]
    v_mfma_f32_16x16x32_bf16 v[200:203], a[168:171], v[52:55], v[200:203]
    v_mfma_f32_16x16x32_bf16 v[204:207], a[172:175], v[52:55], v[204:207]
    v_mfma_f32_16x16x32_bf16 v[208:211], a[176:179], v[52:55], v[208:211]
    v_mfma_f32_16x16x32_bf16 v[212:215], a[180:183], v[52:55], v[212:215]
    v_mfma_f32_16x16x32_bf16 v[216:219], a[184:187], v[52:55], v[216:219]
    ds_read_b128 a[152:155], v3 offset:4096
    ds_read_b128 a[156:159], v4 offset:4096
    v_mfma_f32_16x16x32_bf16 v[220:223], a[188:191], v[52:55], v[220:223]
    v_smfmac_f32_16x16x64_bf16 a[228:231], a[232:235], v[52:59], v19
    buffer_load_dwordx4 v15, s[32:35], s12 offen offset:2048 nt lds
    buffer_load_dwordx4 v16, s[32:35], s12 offen offset:3072 nt lds
    s_sub_u32 s81, s81, 4294734848
    s_and_b32 s81, s81, 4294734848
    s_waitcnt lgkmcnt(0)
    v_mfma_f32_16x16x32_bf16 v[36:39], a[128:131], v[64:67], 0
    ds_read_b64_tr_b16 a[160:161], v5 offset:0
    ds_read_b64_tr_b16 a[162:163], v5 offset:4096
    v_mfma_f32_16x16x32_bf16 v[36:39], a[132:135], v[68:71], v[36:39]
    ds_read_b64_tr_b16 a[164:165], v6 offset:0
    ds_read_b64_tr_b16 a[166:167], v6 offset:4096
    v_mfma_f32_16x16x32_bf16 v[36:39], a[136:139], v[72:75], v[36:39]
    ds_read_b64_tr_b16 a[168:169], v7 offset:0
    ds_read_b64_tr_b16 a[170:171], v7 offset:4096
    v_mfma_f32_16x16x32_bf16 v[36:39], a[140:143], v[76:79], v[36:39]
    ds_read_b64_tr_b16 a[172:173], v8 offset:0
    ds_read_b64_tr_b16 a[174:175], v8 offset:4096
    v_mfma_f32_16x16x32_bf16 v[32:35], a[144:147], v[64:67], 0
    ds_read_b64_tr_b16 a[176:177], v9 offset:0
    ds_read_b64_tr_b16 a[178:179], v9 offset:4096
    v_mfma_f32_16x16x32_bf16 v[32:35], a[148:151], v[68:71], v[32:35]
    ds_read_b64_tr_b16 a[180:181], v10 offset:0
    ds_read_b64_tr_b16 a[182:183], v10 offset:4096
    v_mfma_f32_16x16x32_bf16 v[32:35], a[152:155], v[72:75], v[32:35]
    ds_read_b64_tr_b16 a[184:185], v11 offset:0
    ds_read_b64_tr_b16 a[186:187], v11 offset:4096
    v_mfma_f32_16x16x32_bf16 v[32:35], a[156:159], v[76:79], v[32:35]
    ds_read_b64_tr_b16 a[188:189], v12 offset:0
    ds_read_b64_tr_b16 a[190:191], v12 offset:4096
    v_mfma_f32_16x16x32_bf16 v[40:43], a[128:131], v[80:83], 0
    v_exp_f32 v36, v36
    v_mfma_f32_16x16x32_bf16 v[40:43], a[132:135], v[84:87], v[40:43]
    v_exp_f32 v37, v37
    v_mfma_f32_16x16x32_bf16 v[40:43], a[136:139], v[88:91], v[40:43]
    v_exp_f32 v38, v38
    v_mfma_f32_16x16x32_bf16 v[40:43], a[140:143], v[92:95], v[40:43]
    v_exp_f32 v39, v39
    v_mfma_f32_16x16x32_bf16 v[44:47], a[144:147], v[80:83], 0
    v_exp_f32 v32, v32
    v_mfma_f32_16x16x32_bf16 v[44:47], a[148:151], v[84:87], v[44:47]
    v_exp_f32 v33, v33
    v_mfma_f32_16x16x32_bf16 v[44:47], a[152:155], v[88:91], v[44:47]
    v_exp_f32 v34, v34
    v_mfma_f32_16x16x32_bf16 v[44:47], a[156:159], v[92:95], v[44:47]
    s_xor_b32 s13, s82, s31
    s_add_u32 m0, s83, 65536
    v_mfma_f32_16x16x32_bf16 v[52:55], a[128:131], v[96:99], 0
    buffer_load_dwordx4 v17, s[36:39], s13 offen offset:0 nt lds
    v_mfma_f32_16x16x32_bf16 v[52:55], a[132:135], v[100:103], v[52:55]
    v_exp_f32 v35, v35
    v_mfma_f32_16x16x32_bf16 v[52:55], a[136:139], v[104:107], v[52:55]
    v_cvt_pk_bf16_f32 v36, v36, v37
    v_cvt_pk_bf16_f32 v37, v38, v39
    v_mfma_f32_16x16x32_bf16 v[52:55], a[140:143], v[108:111], v[52:55]
    v_cvt_pk_bf16_f32 v38, v32, v33
    v_cvt_pk_bf16_f32 v39, v34, v35
    v_mfma_f32_16x16x32_bf16 v[48:51], a[144:147], v[96:99], 0
    buffer_load_dwordx4 v18, s[36:39], s13 offen offset:1024 nt lds
    v_mfma_f32_16x16x32_bf16 v[48:51], a[148:151], v[100:103], v[48:51]
    v_exp_f32 v40, v40
    v_mfma_f32_16x16x32_bf16 v[48:51], a[152:155], v[104:107], v[48:51]
    v_exp_f32 v41, v41
    v_mfma_f32_16x16x32_bf16 v[48:51], a[156:159], v[108:111], v[48:51]
    v_exp_f32 v42, v42
    s_nop 7
    v_exp_f32 v43, v43
    s_nop 0
    v_exp_f32 v44, v44
    s_nop 0
    v_exp_f32 v45, v45
    s_nop 0
    v_exp_f32 v46, v46
    s_nop 0
    v_exp_f32 v47, v47
    s_nop 0
    v_cvt_pk_bf16_f32 v40, v40, v41
    v_cvt_pk_bf16_f32 v41, v42, v43
    v_cvt_pk_bf16_f32 v42, v44, v45
    v_cvt_pk_bf16_f32 v43, v46, v47
    s_waitcnt lgkmcnt(0)
    v_mfma_f32_16x16x32_bf16 v[128:131], a[160:163], v[36:39], v[128:131]
    v_exp_f32 v52, v52
    v_mfma_f32_16x16x32_bf16 v[132:135], a[164:167], v[36:39], v[132:135]
    v_exp_f32 v53, v53
    v_mfma_f32_16x16x32_bf16 v[136:139], a[168:171], v[36:39], v[136:139]
    v_exp_f32 v54, v54
    v_mfma_f32_16x16x32_bf16 v[140:143], a[172:175], v[36:39], v[140:143]
    v_exp_f32 v55, v55
    v_mfma_f32_16x16x32_bf16 v[144:147], a[176:179], v[36:39], v[144:147]
    v_exp_f32 v48, v48
    v_mfma_f32_16x16x32_bf16 v[148:151], a[180:183], v[36:39], v[148:151]
    ds_read_b128 a[128:131], v1 offset:8192
    ds_read_b128 a[132:135], v2 offset:8192
    v_mfma_f32_16x16x32_bf16 v[152:155], a[184:187], v[36:39], v[152:155]
    v_exp_f32 v49, v49
    v_mfma_f32_16x16x32_bf16 v[156:159], a[188:191], v[36:39], v[156:159]
    v_exp_f32 v50, v50
    v_smfmac_f32_16x16x64_bf16 a[224:227], a[232:235], v[36:43], v19
    v_exp_f32 v51, v51
    v_mfma_f32_16x16x32_bf16 v[160:163], a[160:163], v[40:43], v[160:163]
    buffer_load_dwordx4 v17, s[36:39], s13 offen offset:2048 nt lds
    v_mfma_f32_16x16x32_bf16 v[164:167], a[164:167], v[40:43], v[164:167]
    v_cvt_pk_bf16_f32 v52, v52, v53
    v_cvt_pk_bf16_f32 v53, v54, v55
    v_mfma_f32_16x16x32_bf16 v[168:171], a[168:171], v[40:43], v[168:171]
    v_cvt_pk_bf16_f32 v54, v48, v49
    v_cvt_pk_bf16_f32 v55, v50, v51
    v_mfma_f32_16x16x32_bf16 v[172:175], a[172:175], v[40:43], v[172:175]
    s_xor_b32 s83, s83, s84
    s_xor_b32 s84, s84, 49152
    v_mfma_f32_16x16x32_bf16 v[176:179], a[176:179], v[40:43], v[176:179]
    buffer_load_dwordx4 v18, s[36:39], s13 offen offset:3072 nt lds
    v_mfma_f32_16x16x32_bf16 v[180:183], a[180:183], v[40:43], v[180:183]
    ds_read_b128 a[136:139], v3 offset:8192
    ds_read_b128 a[140:143], v4 offset:8192
    v_mfma_f32_16x16x32_bf16 v[184:187], a[184:187], v[40:43], v[184:187]
    ds_read_b128 a[144:147], v1 offset:12288
    ds_read_b128 a[148:151], v2 offset:12288
    v_mfma_f32_16x16x32_bf16 v[188:191], a[188:191], v[40:43], v[188:191]
    v_mfma_f32_16x16x32_bf16 v[192:195], a[160:163], v[52:55], v[192:195]
    v_mfma_f32_16x16x32_bf16 v[196:199], a[164:167], v[52:55], v[196:199]
    v_mfma_f32_16x16x32_bf16 v[200:203], a[168:171], v[52:55], v[200:203]
    v_mfma_f32_16x16x32_bf16 v[204:207], a[172:175], v[52:55], v[204:207]
    v_mfma_f32_16x16x32_bf16 v[208:211], a[176:179], v[52:55], v[208:211]
    v_mfma_f32_16x16x32_bf16 v[212:215], a[180:183], v[52:55], v[212:215]
    v_xor_b32 v1, s84, v1
    v_xor_b32 v2, s84, v2
    v_mfma_f32_16x16x32_bf16 v[216:219], a[184:187], v[52:55], v[216:219]
    ds_read_b128 a[152:155], v3 offset:12288
    ds_read_b128 a[156:159], v4 offset:12288
    v_mfma_f32_16x16x32_bf16 v[220:223], a[188:191], v[52:55], v[220:223]
    v_xor_b32 v3, s84, v3
    v_xor_b32 v4, s84, v4
    v_smfmac_f32_16x16x64_bf16 a[228:231], a[232:235], v[52:59], v19
    s_sub_u32 s82, s82, 4294734848
    s_and_b32 s82, s82, 4294734848
    s_waitcnt lgkmcnt(0)
    s_cmp_lg_u32 s81, s85
    s_cbranch_scc1 L_atts
    s_branch L_after
L_tramp0:
    s_call_b64 s[62:63], L_fb
    s_branch L_ret0
L_tramp1:
    s_call_b64 s[62:63], L_fb
    s_branch L_ret1
L_fb:
    s_nop 15
    s_waitcnt vmcnt(0) lgkmcnt(0)
    v_mbcnt_lo_u32_b32 v37, -1, 0
    v_mbcnt_hi_u32_b32 v37, -1, v37
    v_and_b32 v38, 15, v37
    v_lshrrev_b32 v37, 4, v37
    v_lshlrev_b32 v36, 1, v37
    v_xor_b32 v36, v36, v38
    v_lshlrev_b32 v35, 8, v37
    v_lshl_add_u32 v33, v36, 4, v35
    v_xor_b32 v34, 128, v33
    v_lshlrev_b32 v38, 8, v38
    v_lshl_add_u32 v32, v37, 4, v38
    v_mov_b32 v40, 4284592614
    v_mov_b32 v28, 0
    v_mov_b32 v41, 4284592614
    v_mov_b32 v29, 0
    v_mov_b32 v42, 4284592614
    v_mov_b32 v30, 0
    v_mov_b32 v43, 4284592614
    v_mov_b32 v31, 0
    v_mov_b32 v128, 0
    v_mov_b32 v129, 0
    v_mov_b32 v130, 0
    v_mov_b32 v131, 0
    v_mov_b32 v132, 0
    v_mov_b32 v133, 0
    v_mov_b32 v134, 0
    v_mov_b32 v135, 0
    v_mov_b32 v136, 0
    v_mov_b32 v137, 0
    v_mov_b32 v138, 0
    v_mov_b32 v139, 0
    v_mov_b32 v140, 0
    v_mov_b32 v141, 0
    v_mov_b32 v142, 0
    v_mov_b32 v143, 0
    v_mov_b32 v144, 0
    v_mov_b32 v145, 0
    v_mov_b32 v146, 0
    v_mov_b32 v147, 0
    v_mov_b32 v148, 0
    v_mov_b32 v149, 0
    v_mov_b32 v150, 0
    v_mov_b32 v151, 0
    v_mov_b32 v152, 0
    v_mov_b32 v153, 0
    v_mov_b32 v154, 0
    v_mov_b32 v155, 0
    v_mov_b32 v156, 0
    v_mov_b32 v157, 0
    v_mov_b32 v158, 0
    v_mov_b32 v159, 0
    v_mov_b32 v160, 0
    v_mov_b32 v161, 0
    v_mov_b32 v162, 0
    v_mov_b32 v163, 0
    v_mov_b32 v164, 0
    v_mov_b32 v165, 0
    v_mov_b32 v166, 0
    v_mov_b32 v167, 0
    v_mov_b32 v168, 0
    v_mov_b32 v169, 0
    v_mov_b32 v170, 0
    v_mov_b32 v171, 0
    v_mov_b32 v172, 0
    v_mov_b32 v173, 0
    v_mov_b32 v174, 0
    v_mov_b32 v175, 0
    v_mov_b32 v176, 0
    v_mov_b32 v177, 0
    v_mov_b32 v178, 0
    v_mov_b32 v179, 0
    v_mov_b32 v180, 0
    v_mov_b32 v181, 0
    v_mov_b32 v182, 0
    v_mov_b32 v183, 0
    v_mov_b32 v184, 0
    v_mov_b32 v185, 0
    v_mov_b32 v186, 0
    v_mov_b32 v187, 0
    v_mov_b32 v188, 0
    v_mov_b32 v189, 0
    v_mov_b32 v190, 0
    v_mov_b32 v191, 0
    v_mov_b32 v192, 0
    v_mov_b32 v193, 0
    v_mov_b32 v194, 0
    v_mov_b32 v195, 0
    v_mov_b32 v196, 0
    v_mov_b32 v197, 0
    v_mov_b32 v198, 0
    v_mov_b32 v199, 0
    v_mov_b32 v200, 0
    v_mov_b32 v201, 0
    v_mov_b32 v202, 0
    v_mov_b32 v203, 0
    v_mov_b32 v204, 0
    v_mov_b32 v205, 0
    v_mov_b32 v206, 0
    v_mov_b32 v207, 0
    v_mov_b32 v208, 0
    v_mov_b32 v209, 0
    v_mov_b32 v210, 0
    v_mov_b32 v211, 0
    v_mov_b32 v212, 0
    v_mov_b32 v213, 0
    v_mov_b32 v214, 0
    v_mov_b32 v215, 0
    v_mov_b32 v216, 0
    v_mov_b32 v217, 0
    v_mov_b32 v218, 0
    v_mov_b32 v219, 0
    v_mov_b32 v220, 0
    v_mov_b32 v221, 0
    v_mov_b32 v222, 0
    v_mov_b32 v223, 0
    v_mov_b32 v224, 0
    v_mov_b32 v225, 0
    v_mov_b32 v226, 0
    v_mov_b32 v227, 0
    v_mov_b32 v228, 0
    v_mov_b32 v229, 0
    v_mov_b32 v230, 0
    v_mov_b32 v231, 0
    v_mov_b32 v232, 0
    v_mov_b32 v233, 0
    v_mov_b32 v234, 0
    v_mov_b32 v235, 0
    v_mov_b32 v236, 0
    v_mov_b32 v237, 0
    v_mov_b32 v238, 0
    v_mov_b32 v239, 0
    v_mov_b32 v240, 0
    v_mov_b32 v241, 0
    v_mov_b32 v242, 0
    v_mov_b32 v243, 0
    v_mov_b32 v244, 0
    v_mov_b32 v245, 0
    v_mov_b32 v246, 0
    v_mov_b32 v247, 0
    v_mov_b32 v248, 0
    v_mov_b32 v249, 0
    v_mov_b32 v250, 0
    v_mov_b32 v251, 0
    v_mov_b32 v252, 0
    v_mov_b32 v253, 0
    v_mov_b32 v254, 0
    v_mov_b32 v255, 0
    s_mov_b32 s6, s98
    s_mov_b32 s8, 32
L_fb_loop:
    s_add_u32 s7, s6, 4096
    buffer_load_dwordx4 a[192:195], v32, s[32:35], s6 offen offset:0
    buffer_load_dwordx4 a[196:199], v32, s[32:35], s6 offen offset:64
    buffer_load_dwordx4 a[200:203], v32, s[32:35], s6 offen offset:128
    buffer_load_dwordx4 a[204:207], v32, s[32:35], s6 offen offset:192
    s_add_u32 m0, s96, 0
    s_nop 0
    buffer_load_dwordx4 v33, s[36:39], s6 offen offset:0 lds
    buffer_load_dwordx4 v34, s[36:39], s6 offen offset:1024 lds
    buffer_load_dwordx4 v33, s[36:39], s6 offen offset:2048 lds
    buffer_load_dwordx4 v34, s[36:39], s6 offen offset:3072 lds
    buffer_load_dwordx4 a[208:211], v32, s[32:35], s7 offen offset:0
    buffer_load_dwordx4 a[212:215], v32, s[32:35], s7 offen offset:64
    buffer_load_dwordx4 a[216:219], v32, s[32:35], s7 offen offset:128
    buffer_load_dwordx4 a[220:223], v32, s[32:35], s7 offen offset:192
    s_add_u32 m0, s96, 4096
    s_nop 0
    buffer_load_dwordx4 v33, s[36:39], s7 offen offset:0 lds
    buffer_load_dwordx4 v34, s[36:39], s7 offen offset:1024 lds
    buffer_load_dwordx4 v33, s[36:39], s7 offen offset:2048 lds
    buffer_load_dwordx4 v34, s[36:39], s7 offen offset:3072 lds
    s_waitcnt vmcnt(0)
    v_and_b32 v35, 8191, v5
    v_add_u32 v35, s96, v35
    s_nop 0
    ds_read_b64_tr_b16 a[160:161], v35 offset:0
    ds_read_b64_tr_b16 a[162:163], v35 offset:4096
    v_and_b32 v35, 8191, v6
    v_add_u32 v35, s96, v35
    s_nop 0
    ds_read_b64_tr_b16 a[164:165], v35 offset:0
    ds_read_b64_tr_b16 a[166:167], v35 offset:4096
    v_and_b32 v35, 8191, v7
    v_add_u32 v35, s96, v35
    s_nop 0
    ds_read_b64_tr_b16 a[168:169], v35 offset:0
    ds_read_b64_tr_b16 a[170:171], v35 offset:4096
    v_and_b32 v35, 8191, v8
    v_add_u32 v35, s96, v35
    s_nop 0
    ds_read_b64_tr_b16 a[172:173], v35 offset:0
    ds_read_b64_tr_b16 a[174:175], v35 offset:4096
    v_and_b32 v35, 8191, v9
    v_add_u32 v35, s96, v35
    s_nop 0
    ds_read_b64_tr_b16 a[176:177], v35 offset:0
    ds_read_b64_tr_b16 a[178:179], v35 offset:4096
    v_and_b32 v35, 8191, v10
    v_add_u32 v35, s96, v35
    s_nop 0
    ds_read_b64_tr_b16 a[180:181], v35 offset:0
    ds_read_b64_tr_b16 a[182:183], v35 offset:4096
    v_and_b32 v35, 8191, v11
    v_add_u32 v35, s96, v35
    s_nop 0
    ds_read_b64_tr_b16 a[184:185], v35 offset:0
    ds_read_b64_tr_b16 a[186:187], v35 offset:4096
    v_and_b32 v35, 8191, v12
    v_add_u32 v35, s96, v35
    s_nop 0
    ds_read_b64_tr_b16 a[188:189], v35 offset:0
    ds_read_b64_tr_b16 a[190:191], v35 offset:4096
    s_waitcnt lgkmcnt(0)
    v_mfma_f32_16x16x32_bf16 v[48:51], a[192:195], v[64:67], 0
    v_mfma_f32_16x16x32_bf16 v[48:51], a[196:199], v[68:71], v[48:51]
    v_mfma_f32_16x16x32_bf16 v[48:51], a[200:203], v[72:75], v[48:51]
    v_mfma_f32_16x16x32_bf16 v[48:51], a[204:207], v[76:79], v[48:51]
    v_mfma_f32_16x16x32_bf16 v[52:55], a[208:211], v[64:67], 0
    v_mfma_f32_16x16x32_bf16 v[52:55], a[212:215], v[68:71], v[52:55]
    v_mfma_f32_16x16x32_bf16 v[52:55], a[216:219], v[72:75], v[52:55]
    v_mfma_f32_16x16x32_bf16 v[52:55], a[220:223], v[76:79], v[52:55]
    s_nop 9
    v_max3_f32 v37, v48, v49, v50
    v_max3_f32 v37, v37, v51, v52
    v_max3_f32 v37, v37, v53, v54
    v_max3_f32 v37, v37, v55, v40
    v_mov_b32 v38, v37
    s_nop 1
    v_permlane16_swap_b32 v37, v38
    v_max_f32 v37, v37, v38
    v_mov_b32 v38, v37
    s_nop 1
    v_permlane32_swap_b32 v37, v38
    v_max_f32 v37, v37, v38
    v_sub_f32 v36, v40, v37
    v_exp_f32 v36, v36
    v_mov_b32 v40, v37
    v_sub_f32 v48, v48, v37
    v_exp_f32 v48, v48
    v_sub_f32 v49, v49, v37
    v_exp_f32 v49, v49
    v_sub_f32 v50, v50, v37
    v_exp_f32 v50, v50
    v_sub_f32 v51, v51, v37
    v_exp_f32 v51, v51
    v_sub_f32 v52, v52, v37
    v_exp_f32 v52, v52
    v_sub_f32 v53, v53, v37
    v_exp_f32 v53, v53
    v_sub_f32 v54, v54, v37
    v_exp_f32 v54, v54
    v_sub_f32 v55, v55, v37
    v_exp_f32 v55, v55
    v_mul_f32 v28, v28, v36
    v_cvt_pk_bf16_f32 v48, v48, v49
    v_cvt_pk_bf16_f32 v49, v50, v51
    v_cvt_pk_bf16_f32 v50, v52, v53
    v_cvt_pk_bf16_f32 v51, v54, v55
    v_lshlrev_b32 v37, 16, v48
    v_and_b32 v38, 4294901760, v48
    v_add_f32 v28, v28, v37
    v_add_f32 v28, v28, v38
    v_lshlrev_b32 v37, 16, v49
    v_and_b32 v38, 4294901760, v49
    v_add_f32 v28, v28, v37
    v_add_f32 v28, v28, v38
    v_lshlrev_b32 v37, 16, v50
    v_and_b32 v38, 4294901760, v50
    v_add_f32 v28, v28, v37
    v_add_f32 v28, v28, v38
    v_lshlrev_b32 v37, 16, v51
    v_and_b32 v38, 4294901760, v51
    v_add_f32 v28, v28, v37
    v_add_f32 v28, v28, v38
    v_mul_f32 v128, v128, v36
    v_mul_f32 v129, v129, v36
    v_mul_f32 v130, v130, v36
    v_mul_f32 v131, v131, v36
    v_mul_f32 v132, v132, v36
    v_mul_f32 v133, v133, v36
    v_mul_f32 v134, v134, v36
    v_mul_f32 v135, v135, v36
    v_mul_f32 v136, v136, v36
    v_mul_f32 v137, v137, v36
    v_mul_f32 v138, v138, v36
    v_mul_f32 v139, v139, v36
    v_mul_f32 v140, v140, v36
    v_mul_f32 v141, v141, v36
    v_mul_f32 v142, v142, v36
    v_mul_f32 v143, v143, v36
    v_mul_f32 v144, v144, v36
    v_mul_f32 v145, v145, v36
    v_mul_f32 v146, v146, v36
    v_mul_f32 v147, v147, v36
    v_mul_f32 v148, v148, v36
    v_mul_f32 v149, v149, v36
    v_mul_f32 v150, v150, v36
    v_mul_f32 v151, v151, v36
    v_mul_f32 v152, v152, v36
    v_mul_f32 v153, v153, v36
    v_mul_f32 v154, v154, v36
    v_mul_f32 v155, v155, v36
    v_mul_f32 v156, v156, v36
    v_mul_f32 v157, v157, v36
    v_mul_f32 v158, v158, v36
    v_mul_f32 v159, v159, v36
    s_nop 1
    v_mfma_f32_16x16x32_bf16 v[128:131], a[160:163], v[48:51], v[128:131]
    v_mfma_f32_16x16x32_bf16 v[132:135], a[164:167], v[48:51], v[132:135]
    v_mfma_f32_16x16x32_bf16 v[136:139], a[168:171], v[48:51], v[136:139]
    v_mfma_f32_16x16x32_bf16 v[140:143], a[172:175], v[48:51], v[140:143]
    v_mfma_f32_16x16x32_bf16 v[144:147], a[176:179], v[48:51], v[144:147]
    v_mfma_f32_16x16x32_bf16 v[148:151], a[180:183], v[48:51], v[148:151]
    v_mfma_f32_16x16x32_bf16 v[152:155], a[184:187], v[48:51], v[152:155]
    v_mfma_f32_16x16x32_bf16 v[156:159], a[188:191], v[48:51], v[156:159]
    s_nop 7
    v_mfma_f32_16x16x32_bf16 v[48:51], a[192:195], v[80:83], 0
    v_mfma_f32_16x16x32_bf16 v[48:51], a[196:199], v[84:87], v[48:51]
    v_mfma_f32_16x16x32_bf16 v[48:51], a[200:203], v[88:91], v[48:51]
    v_mfma_f32_16x16x32_bf16 v[48:51], a[204:207], v[92:95], v[48:51]
    v_mfma_f32_16x16x32_bf16 v[52:55], a[208:211], v[80:83], 0
    v_mfma_f32_16x16x32_bf16 v[52:55], a[212:215], v[84:87], v[52:55]
    v_mfma_f32_16x16x32_bf16 v[52:55], a[216:219], v[88:91], v[52:55]
    v_mfma_f32_16x16x32_bf16 v[52:55], a[220:223], v[92:95], v[52:55]
    s_nop 9
    v_max3_f32 v37, v48, v49, v50
    v_max3_f32 v37, v37, v51, v52
    v_max3_f32 v37, v37, v53, v54
    v_max3_f32 v37, v37, v55, v41
    v_mov_b32 v38, v37
    s_nop 1
    v_permlane16_swap_b32 v37, v38
    v_max_f32 v37, v37, v38
    v_mov_b32 v38, v37
    s_nop 1
    v_permlane32_swap_b32 v37, v38
    v_max_f32 v37, v37, v38
    v_sub_f32 v36, v41, v37
    v_exp_f32 v36, v36
    v_mov_b32 v41, v37
    v_sub_f32 v48, v48, v37
    v_exp_f32 v48, v48
    v_sub_f32 v49, v49, v37
    v_exp_f32 v49, v49
    v_sub_f32 v50, v50, v37
    v_exp_f32 v50, v50
    v_sub_f32 v51, v51, v37
    v_exp_f32 v51, v51
    v_sub_f32 v52, v52, v37
    v_exp_f32 v52, v52
    v_sub_f32 v53, v53, v37
    v_exp_f32 v53, v53
    v_sub_f32 v54, v54, v37
    v_exp_f32 v54, v54
    v_sub_f32 v55, v55, v37
    v_exp_f32 v55, v55
    v_mul_f32 v29, v29, v36
    v_cvt_pk_bf16_f32 v48, v48, v49
    v_cvt_pk_bf16_f32 v49, v50, v51
    v_cvt_pk_bf16_f32 v50, v52, v53
    v_cvt_pk_bf16_f32 v51, v54, v55
    v_lshlrev_b32 v37, 16, v48
    v_and_b32 v38, 4294901760, v48
    v_add_f32 v29, v29, v37
    v_add_f32 v29, v29, v38
    v_lshlrev_b32 v37, 16, v49
    v_and_b32 v38, 4294901760, v49
    v_add_f32 v29, v29, v37
    v_add_f32 v29, v29, v38
    v_lshlrev_b32 v37, 16, v50
    v_and_b32 v38, 4294901760, v50
    v_add_f32 v29, v29, v37
    v_add_f32 v29, v29, v38
    v_lshlrev_b32 v37, 16, v51
    v_and_b32 v38, 4294901760, v51
    v_add_f32 v29, v29, v37
    v_add_f32 v29, v29, v38
    v_mul_f32 v160, v160, v36
    v_mul_f32 v161, v161, v36
    v_mul_f32 v162, v162, v36
    v_mul_f32 v163, v163, v36
    v_mul_f32 v164, v164, v36
    v_mul_f32 v165, v165, v36
    v_mul_f32 v166, v166, v36
    v_mul_f32 v167, v167, v36
    v_mul_f32 v168, v168, v36
    v_mul_f32 v169, v169, v36
    v_mul_f32 v170, v170, v36
    v_mul_f32 v171, v171, v36
    v_mul_f32 v172, v172, v36
    v_mul_f32 v173, v173, v36
    v_mul_f32 v174, v174, v36
    v_mul_f32 v175, v175, v36
    v_mul_f32 v176, v176, v36
    v_mul_f32 v177, v177, v36
    v_mul_f32 v178, v178, v36
    v_mul_f32 v179, v179, v36
    v_mul_f32 v180, v180, v36
    v_mul_f32 v181, v181, v36
    v_mul_f32 v182, v182, v36
    v_mul_f32 v183, v183, v36
    v_mul_f32 v184, v184, v36
    v_mul_f32 v185, v185, v36
    v_mul_f32 v186, v186, v36
    v_mul_f32 v187, v187, v36
    v_mul_f32 v188, v188, v36
    v_mul_f32 v189, v189, v36
    v_mul_f32 v190, v190, v36
    v_mul_f32 v191, v191, v36
    s_nop 1
    v_mfma_f32_16x16x32_bf16 v[160:163], a[160:163], v[48:51], v[160:163]
    v_mfma_f32_16x16x32_bf16 v[164:167], a[164:167], v[48:51], v[164:167]
    v_mfma_f32_16x16x32_bf16 v[168:171], a[168:171], v[48:51], v[168:171]
    v_mfma_f32_16x16x32_bf16 v[172:175], a[172:175], v[48:51], v[172:175]
    v_mfma_f32_16x16x32_bf16 v[176:179], a[176:179], v[48:51], v[176:179]
    v_mfma_f32_16x16x32_bf16 v[180:183], a[180:183], v[48:51], v[180:183]
    v_mfma_f32_16x16x32_bf16 v[184:187], a[184:187], v[48:51], v[184:187]
    v_mfma_f32_16x16x32_bf16 v[188:191], a[188:191], v[48:51], v[188:191]
    s_nop 7
    v_mfma_f32_16x16x32_bf16 v[48:51], a[192:195], v[96:99], 0
    v_mfma_f32_16x16x32_bf16 v[48:51], a[196:199], v[100:103], v[48:51]
    v_mfma_f32_16x16x32_bf16 v[48:51], a[200:203], v[104:107], v[48:51]
    v_mfma_f32_16x16x32_bf16 v[48:51], a[204:207], v[108:111], v[48:51]
    v_mfma_f32_16x16x32_bf16 v[52:55], a[208:211], v[96:99], 0
    v_mfma_f32_16x16x32_bf16 v[52:55], a[212:215], v[100:103], v[52:55]
    v_mfma_f32_16x16x32_bf16 v[52:55], a[216:219], v[104:107], v[52:55]
    v_mfma_f32_16x16x32_bf16 v[52:55], a[220:223], v[108:111], v[52:55]
    s_nop 9
    v_max3_f32 v37, v48, v49, v50
    v_max3_f32 v37, v37, v51, v52
    v_max3_f32 v37, v37, v53, v54
    v_max3_f32 v37, v37, v55, v42
    v_mov_b32 v38, v37
    s_nop 1
    v_permlane16_swap_b32 v37, v38
    v_max_f32 v37, v37, v38
    v_mov_b32 v38, v37
    s_nop 1
    v_permlane32_swap_b32 v37, v38
    v_max_f32 v37, v37, v38
    v_sub_f32 v36, v42, v37
    v_exp_f32 v36, v36
    v_mov_b32 v42, v37
    v_sub_f32 v48, v48, v37
    v_exp_f32 v48, v48
    v_sub_f32 v49, v49, v37
    v_exp_f32 v49, v49
    v_sub_f32 v50, v50, v37
    v_exp_f32 v50, v50
    v_sub_f32 v51, v51, v37
    v_exp_f32 v51, v51
    v_sub_f32 v52, v52, v37
    v_exp_f32 v52, v52
    v_sub_f32 v53, v53, v37
    v_exp_f32 v53, v53
    v_sub_f32 v54, v54, v37
    v_exp_f32 v54, v54
    v_sub_f32 v55, v55, v37
    v_exp_f32 v55, v55
    v_mul_f32 v30, v30, v36
    v_cvt_pk_bf16_f32 v48, v48, v49
    v_cvt_pk_bf16_f32 v49, v50, v51
    v_cvt_pk_bf16_f32 v50, v52, v53
    v_cvt_pk_bf16_f32 v51, v54, v55
    v_lshlrev_b32 v37, 16, v48
    v_and_b32 v38, 4294901760, v48
    v_add_f32 v30, v30, v37
    v_add_f32 v30, v30, v38
    v_lshlrev_b32 v37, 16, v49
    v_and_b32 v38, 4294901760, v49
    v_add_f32 v30, v30, v37
    v_add_f32 v30, v30, v38
    v_lshlrev_b32 v37, 16, v50
    v_and_b32 v38, 4294901760, v50
    v_add_f32 v30, v30, v37
    v_add_f32 v30, v30, v38
    v_lshlrev_b32 v37, 16, v51
    v_and_b32 v38, 4294901760, v51
    v_add_f32 v30, v30, v37
    v_add_f32 v30, v30, v38
    v_mul_f32 v192, v192, v36
    v_mul_f32 v193, v193, v36
    v_mul_f32 v194, v194, v36
    v_mul_f32 v195, v195, v36
    v_mul_f32 v196, v196, v36
    v_mul_f32 v197, v197, v36
    v_mul_f32 v198, v198, v36
    v_mul_f32 v199, v199, v36
    v_mul_f32 v200, v200, v36
    v_mul_f32 v201, v201, v36
    v_mul_f32 v202, v202, v36
    v_mul_f32 v203, v203, v36
    v_mul_f32 v204, v204, v36
    v_mul_f32 v205, v205, v36
    v_mul_f32 v206, v206, v36
    v_mul_f32 v207, v207, v36
    v_mul_f32 v208, v208, v36
    v_mul_f32 v209, v209, v36
    v_mul_f32 v210, v210, v36
    v_mul_f32 v211, v211, v36
    v_mul_f32 v212, v212, v36
    v_mul_f32 v213, v213, v36
    v_mul_f32 v214, v214, v36
    v_mul_f32 v215, v215, v36
    v_mul_f32 v216, v216, v36
    v_mul_f32 v217, v217, v36
    v_mul_f32 v218, v218, v36
    v_mul_f32 v219, v219, v36
    v_mul_f32 v220, v220, v36
    v_mul_f32 v221, v221, v36
    v_mul_f32 v222, v222, v36
    v_mul_f32 v223, v223, v36
    s_nop 1
    v_mfma_f32_16x16x32_bf16 v[192:195], a[160:163], v[48:51], v[192:195]
    v_mfma_f32_16x16x32_bf16 v[196:199], a[164:167], v[48:51], v[196:199]
    v_mfma_f32_16x16x32_bf16 v[200:203], a[168:171], v[48:51], v[200:203]
    v_mfma_f32_16x16x32_bf16 v[204:207], a[172:175], v[48:51], v[204:207]
    v_mfma_f32_16x16x32_bf16 v[208:211], a[176:179], v[48:51], v[208:211]
    v_mfma_f32_16x16x32_bf16 v[212:215], a[180:183], v[48:51], v[212:215]
    v_mfma_f32_16x16x32_bf16 v[216:219], a[184:187], v[48:51], v[216:219]
    v_mfma_f32_16x16x32_bf16 v[220:223], a[188:191], v[48:51], v[220:223]
    s_nop 7
    v_mfma_f32_16x16x32_bf16 v[48:51], a[192:195], v[112:115], 0
    v_mfma_f32_16x16x32_bf16 v[48:51], a[196:199], v[116:119], v[48:51]
    v_mfma_f32_16x16x32_bf16 v[48:51], a[200:203], v[120:123], v[48:51]
    v_mfma_f32_16x16x32_bf16 v[48:51], a[204:207], v[124:127], v[48:51]
    v_mfma_f32_16x16x32_bf16 v[52:55], a[208:211], v[112:115], 0
    v_mfma_f32_16x16x32_bf16 v[52:55], a[212:215], v[116:119], v[52:55]
    v_mfma_f32_16x16x32_bf16 v[52:55], a[216:219], v[120:123], v[52:55]
    v_mfma_f32_16x16x32_bf16 v[52:55], a[220:223], v[124:127], v[52:55]
    s_nop 9
    v_max3_f32 v37, v48, v49, v50
    v_max3_f32 v37, v37, v51, v52
    v_max3_f32 v37, v37, v53, v54
    v_max3_f32 v37, v37, v55, v43
    v_mov_b32 v38, v37
    s_nop 1
    v_permlane16_swap_b32 v37, v38
    v_max_f32 v37, v37, v38
    v_mov_b32 v38, v37
    s_nop 1
    v_permlane32_swap_b32 v37, v38
    v_max_f32 v37, v37, v38
    v_sub_f32 v36, v43, v37
    v_exp_f32 v36, v36
    v_mov_b32 v43, v37
    v_sub_f32 v48, v48, v37
    v_exp_f32 v48, v48
    v_sub_f32 v49, v49, v37
    v_exp_f32 v49, v49
    v_sub_f32 v50, v50, v37
    v_exp_f32 v50, v50
    v_sub_f32 v51, v51, v37
    v_exp_f32 v51, v51
    v_sub_f32 v52, v52, v37
    v_exp_f32 v52, v52
    v_sub_f32 v53, v53, v37
    v_exp_f32 v53, v53
    v_sub_f32 v54, v54, v37
    v_exp_f32 v54, v54
    v_sub_f32 v55, v55, v37
    v_exp_f32 v55, v55
    v_mul_f32 v31, v31, v36
    v_cvt_pk_bf16_f32 v48, v48, v49
    v_cvt_pk_bf16_f32 v49, v50, v51
    v_cvt_pk_bf16_f32 v50, v52, v53
    v_cvt_pk_bf16_f32 v51, v54, v55
    v_lshlrev_b32 v37, 16, v48
    v_and_b32 v38, 4294901760, v48
    v_add_f32 v31, v31, v37
    v_add_f32 v31, v31, v38
    v_lshlrev_b32 v37, 16, v49
    v_and_b32 v38, 4294901760, v49
    v_add_f32 v31, v31, v37
    v_add_f32 v31, v31, v38
    v_lshlrev_b32 v37, 16, v50
    v_and_b32 v38, 4294901760, v50
    v_add_f32 v31, v31, v37
    v_add_f32 v31, v31, v38
    v_lshlrev_b32 v37, 16, v51
    v_and_b32 v38, 4294901760, v51
    v_add_f32 v31, v31, v37
    v_add_f32 v31, v31, v38
    v_mul_f32 v224, v224, v36
    v_mul_f32 v225, v225, v36
    v_mul_f32 v226, v226, v36
    v_mul_f32 v227, v227, v36
    v_mul_f32 v228, v228, v36
    v_mul_f32 v229, v229, v36
    v_mul_f32 v230, v230, v36
    v_mul_f32 v231, v231, v36
    v_mul_f32 v232, v232, v36
    v_mul_f32 v233, v233, v36
    v_mul_f32 v234, v234, v36
    v_mul_f32 v235, v235, v36
    v_mul_f32 v236, v236, v36
    v_mul_f32 v237, v237, v36
    v_mul_f32 v238, v238, v36
    v_mul_f32 v239, v239, v36
    v_mul_f32 v240, v240, v36
    v_mul_f32 v241, v241, v36
    v_mul_f32 v242, v242, v36
    v_mul_f32 v243, v243, v36
    v_mul_f32 v244, v244, v36
    v_mul_f32 v245, v245, v36
    v_mul_f32 v246, v246, v36
    v_mul_f32 v247, v247, v36
    v_mul_f32 v248, v248, v36
    v_mul_f32 v249, v249, v36
    v_mul_f32 v250, v250, v36
    v_mul_f32 v251, v251, v36
    v_mul_f32 v252, v252, v36
    v_mul_f32 v253, v253, v36
    v_mul_f32 v254, v254, v36
    v_mul_f32 v255, v255, v36
    s_nop 1
    v_mfma_f32_16x16x32_bf16 v[224:227], a[160:163], v[48:51], v[224:227]
    v_mfma_f32_16x16x32_bf16 v[228:231], a[164:167], v[48:51], v[228:231]
    v_mfma_f32_16x16x32_bf16 v[232:235], a[168:171], v[48:51], v[232:235]
    v_mfma_f32_16x16x32_bf16 v[236:239], a[172:175], v[48:51], v[236:239]
    v_mfma_f32_16x16x32_bf16 v[240:243], a[176:179], v[48:51], v[240:243]
    v_mfma_f32_16x16x32_bf16 v[244:247], a[180:183], v[48:51], v[244:247]
    v_mfma_f32_16x16x32_bf16 v[248:251], a[184:187], v[48:51], v[248:251]
    v_mfma_f32_16x16x32_bf16 v[252:255], a[188:191], v[48:51], v[252:255]
    s_nop 7
    s_add_u32 s6, s6, 8192
    s_sub_u32 s8, s8, 1
    s_cmp_lg_u32 s8, 0
    s_cbranch_scc1 L_fb_loop
    v_mov_b32 v38, v28
    s_nop 1
    v_permlane16_swap_b32 v28, v38
    v_add_f32 v28, v28, v38
    v_mov_b32 v38, v28
    s_nop 1
    v_permlane32_swap_b32 v28, v38
    v_add_f32 v28, v28, v38
    v_mov_b32 v38, v29
    s_nop 1
    v_permlane16_swap_b32 v29, v38
    v_add_f32 v29, v29, v38
    v_mov_b32 v38, v29
    s_nop 1
    v_permlane32_swap_b32 v29, v38
    v_add_f32 v29, v29, v38
    v_mov_b32 v38, v30
    s_nop 1
    v_permlane16_swap_b32 v30, v38
    v_add_f32 v30, v30, v38
    v_mov_b32 v38, v30
    s_nop 1
    v_permlane32_swap_b32 v30, v38
    v_add_f32 v30, v30, v38
    v_mov_b32 v38, v31
    s_nop 1
    v_permlane16_swap_b32 v31, v38
    v_add_f32 v31, v31, v38
    v_mov_b32 v38, v31
    s_nop 1
    v_permlane32_swap_b32 v31, v38
    v_add_f32 v31, v31, v38
    s_nop 9
    s_setpc_b64 s[62:63]
.globl oproj_kernel
.p2align 8
.type oproj_kernel,@function
oproj_kernel:
    s_cmp_ge_u32 s2, 240
    s_cbranch_scc1 L_k2_end
    s_load_dwordx2 s[10:11], s[0:1], 96
    s_load_dwordx2 s[8:9], s[0:1], 80
    s_bfe_u32 s29, s2, 65538
    s_lshr_b32 s32, s2, 3
    s_mul_i32 s33, s32, 43
    s_lshr_b32 s33, s33, 8
    s_mul_i32 s34, s33, 6
    s_sub_u32 s31, s32, s34
    s_add_u32 s39, s33, s31
    s_and_b32 s32, s2, 3
    s_mul_i32 s32, s32, 5
    s_add_u32 s30, s32, s33
    v_lshrrev_b32 v14, 6, v0
    v_and_b32 v12, 63, v0
    v_readfirstlane_b32 s28, v14
    v_lshlrev_b32 v17, 4, v12
    s_nop 2
    s_lshr_b32 s42, s28, 1
    s_and_b32 s43, s28, 1
    s_mul_i32 s32, s42, 393216
    s_mul_i32 s33, s43, 3072
    v_add_u32 v4, s32, v17
    s_sub_u32 s32, 393216, s32
    v_add_u32 v7, s33, v17
    s_sub_u32 s33, 3072, s33
    v_add_u32 v1, s32, v17
    v_add_u32 v18, s33, v17
    v_add_u32 v2, 131072, v1
    v_add_u32 v3, 262144, v1
    v_add_u32 v5, 131072, v4
    v_add_u32 v6, 262144, v4
    s_mul_i32 s32, s29, 15728640
    s_mul_i32 s33, s30, 786432
    s_add_u32 s32, s32, s33
    s_lshl_b32 s33, s28, 15
    s_add_u32 s32, s32, s33
    s_mul_i32 s33, s29, 4718592
    s_mul_i32 s34, s31, 786432
    s_add_u32 s33, s33, s34
    s_mul_i32 s34, s28, 196608
    s_add_u32 s33, s33, s34
    s_add_u32 s33, s33, 33554432
    s_mov_b32 s35, 0
    s_mov_b32 s36, 0
    s_waitcnt lgkmcnt(0)
    s_add_u32 s16, s10, s32
    s_addc_u32 s17, s11, 0
    s_mov_b32 s18, 688128
    s_mov_b32 s19, 131072
    s_add_u32 s20, s10, s33
    s_addc_u32 s21, s11, 0
    s_mov_b32 s22, 196608
    s_mov_b32 s23, 131072
    s_mov_b32 s44, 6144
    buffer_load_dwordx4 v[56:59], v18, s[20:23], s36 offen offset:0
    buffer_load_dwordx4 v[104:107], v18, s[20:23], s44 offen offset:0
    buffer_load_dwordx4 v[32:35], v1, s[16:19], s35 offen offset:0
    buffer_load_dwordx4 v[80:83], v1, s[16:19], s35 offen offset:1024
    buffer_load_dwordx4 v[36:39], v2, s[16:19], s35 offen offset:0
    buffer_load_dwordx4 v[84:87], v2, s[16:19], s35 offen offset:1024
    buffer_load_dwordx4 v[40:43], v3, s[16:19], s35 offen offset:0
    buffer_load_dwordx4 v[88:91], v3, s[16:19], s35 offen offset:1024
    buffer_load_dwordx4 v[44:47], v4, s[16:19], s35 offen offset:0
    buffer_load_dwordx4 v[92:95], v4, s[16:19], s35 offen offset:1024
    buffer_load_dwordx4 v[48:51], v5, s[16:19], s35 offen offset:0
    buffer_load_dwordx4 v[96:99], v5, s[16:19], s35 offen offset:1024
    buffer_load_dwordx4 v[52:55], v6, s[16:19], s35 offen offset:0
    buffer_load_dwordx4 v[100:103], v6, s[16:19], s35 offen offset:1024
    buffer_load_dwordx4 v[60:63], v18, s[20:23], s36 offen offset:1024
    buffer_load_dwordx4 v[108:111], v18, s[20:23], s44 offen offset:1024
    buffer_load_dwordx4 v[64:67], v18, s[20:23], s36 offen offset:2048
    buffer_load_dwordx4 v[112:115], v18, s[20:23], s44 offen offset:2048
    buffer_load_dwordx4 v[68:71], v7, s[20:23], s36 offen offset:0
    buffer_load_dwordx4 v[116:119], v7, s[20:23], s44 offen offset:0
    buffer_load_dwordx4 v[72:75], v7, s[20:23], s36 offen offset:1024
    buffer_load_dwordx4 v[120:123], v7, s[20:23], s44 offen offset:1024
    buffer_load_dwordx4 v[76:79], v7, s[20:23], s36 offen offset:2048
    buffer_load_dwordx4 v[124:127], v7, s[20:23], s44 offen offset:2048
    s_add_u32 s36, s36, 12288
    s_add_u32 s44, s44, 12288
    s_add_u32 s35, s35, 2048
    s_add_u32 s24, s8, 0
    s_addc_u32 s25, s9, 0
    s_mov_b32 s26, 4423680
    s_mov_b32 s27, 131072
    v_lshrrev_b32 v13, 4, v12
    s_mul_i32 s32, s28, 27648
    v_add_u32 v10, s32, v17
    s_xor_b32 s32, s28, 1
    s_mul_i32 s32, s32, 27648
    s_add_u32 s32, s32, 0
    v_add_u32 v8, s32, v17
    s_xor_b32 s32, s28, 2
    s_mul_i32 s32, s32, 27648
    s_add_u32 s32, s32, 9216
    v_add_u32 v9, s32, v17
    s_xor_b32 s32, s28, 3
    s_mul_i32 s32, s32, 27648
    s_add_u32 s32, s32, 18432
    v_add_u32 v16, s32, v17
    s_mul_i32 s40, s30, 221184
    s_mul_i32 s41, s29, 1152
    s_add_u32 s40, s40, s41
    s_mul_i32 s41, s31, 192
    s_add_u32 s40, s40, s41
    s_mul_i32 s41, s42, 110592
    s_add_u32 s40, s40, s41
    s_mul_i32 s41, s43, 96
    s_add_u32 s40, s40, s41
    v_and_b32 v14, 15, v12
    v_mul_u32_u24 v14, 2304, v14
    v_mul_u32_u24 v15, 24, v13
    v_add3_u32 v11, v14, v15, s40
    s_mov_b32 s40, 36864
    s_mov_b32 s41, 73728
    s_waitcnt vmcnt(21)
    v_mfma_f32_16x16x32_bf16 a[0:3], v[56:59], v[32:35], 0
    s_waitcnt vmcnt(20)
    v_mfma_f32_16x16x32_bf16 a[0:3], v[104:107], v[80:83], a[0:3]
    buffer_load_dwordx4 v[152:155], v18, s[20:23], s36 offen offset:0
    s_waitcnt vmcnt(20)
    v_mfma_f32_16x16x32_bf16 a[4:7], v[56:59], v[36:39], 0
    s_waitcnt vmcnt(19)
    v_mfma_f32_16x16x32_bf16 a[4:7], v[104:107], v[84:87], a[4:7]
    s_waitcnt vmcnt(18)
    v_mfma_f32_16x16x32_bf16 a[8:11], v[56:59], v[40:43], 0
    buffer_load_dwordx4 v[200:203], v18, s[20:23], s44 offen offset:0
    s_waitcnt vmcnt(18)
    v_mfma_f32_16x16x32_bf16 a[8:11], v[104:107], v[88:91], a[8:11]
    s_waitcnt vmcnt(17)
    v_mfma_f32_16x16x32_bf16 a[12:15], v[56:59], v[44:47], 0
    s_waitcnt vmcnt(16)
    v_mfma_f32_16x16x32_bf16 a[12:15], v[104:107], v[92:95], a[12:15]
    buffer_load_dwordx4 v[128:131], v1, s[16:19], s35 offen offset:0
    s_waitcnt vmcnt(16)
    v_mfma_f32_16x16x32_bf16 a[16:19], v[56:59], v[48:51], 0
    s_waitcnt vmcnt(15)
    v_mfma_f32_16x16x32_bf16 a[16:19], v[104:107], v[96:99], a[16:19]
    s_waitcnt vmcnt(14)
    v_mfma_f32_16x16x32_bf16 a[20:23], v[56:59], v[52:55], 0
    buffer_load_dwordx4 v[176:179], v1, s[16:19], s35 offen offset:1024
    s_waitcnt vmcnt(14)
    v_mfma_f32_16x16x32_bf16 a[20:23], v[104:107], v[100:103], a[20:23]
    s_waitcnt vmcnt(13)
    v_mfma_f32_16x16x32_bf16 a[24:27], v[60:63], v[32:35], 0
    s_waitcnt vmcnt(12)
    v_mfma_f32_16x16x32_bf16 a[24:27], v[108:111], v[80:83], a[24:27]
    buffer_load_dwordx4 v[132:135], v2, s[16:19], s35 offen offset:0
    v_mfma_f32_16x16x32_bf16 a[28:31], v[60:63], v[36:39], 0
    v_mfma_f32_16x16x32_bf16 a[28:31], v[108:111], v[84:87], a[28:31]
    v_mfma_f32_16x16x32_bf16 a[32:35], v[60:63], v[40:43], 0
    buffer_load_dwordx4 v[180:183], v2, s[16:19], s35 offen offset:1024
    v_mfma_f32_16x16x32_bf16 a[32:35], v[108:111], v[88:91], a[32:35]
    v_mfma_f32_16x16x32_bf16 a[36:39], v[60:63], v[44:47], 0
    v_mfma_f32_16x16x32_bf16 a[36:39], v[108:111], v[92:95], a[36:39]
    buffer_load_dwordx4 v[136:139], v3, s[16:19], s35 offen offset:0
    v_mfma_f32_16x16x32_bf16 a[40:43], v[60:63], v[48:51], 0
    v_mfma_f32_16x16x32_bf16 a[40:43], v[108:111], v[96:99], a[40:43]
    v_mfma_f32_16x16x32_bf16 a[44:47], v[60:63], v[52:55], 0
    buffer_load_dwordx4 v[184:187], v3, s[16:19], s35 offen offset:1024
    v_mfma_f32_16x16x32_bf16 a[44:47], v[108:111], v[100:103], a[44:47]
    s_waitcnt vmcnt(15)
    v_mfma_f32_16x16x32_bf16 a[48:51], v[64:67], v[32:35], 0
    s_waitcnt vmcnt(14)
    v_mfma_f32_16x16x32_bf16 a[48:51], v[112:115], v[80:83], a[48:51]
    buffer_load_dwordx4 v[140:143], v4, s[16:19], s35 offen offset:0
    v_mfma_f32_16x16x32_bf16 a[52:55], v[64:67], v[36:39], 0
    v_mfma_f32_16x16x32_bf16 a[52:55], v[112:115], v[84:87], a[52:55]
    v_mfma_f32_16x16x32_bf16 a[56:59], v[64:67], v[40:43], 0
    buffer_load_dwordx4 v[188:191], v4, s[16:19], s35 offen offset:1024
    v_mfma_f32_16x16x32_bf16 a[56:59], v[112:115], v[88:91], a[56:59]
    v_mfma_f32_16x16x32_bf16 a[60:63], v[64:67], v[44:47], 0
    v_mfma_f32_16x16x32_bf16 a[60:63], v[112:115], v[92:95], a[60:63]
    buffer_load_dwordx4 v[144:147], v5, s[16:19], s35 offen offset:0
    v_mfma_f32_16x16x32_bf16 a[64:67], v[64:67], v[48:51], 0
    v_mfma_f32_16x16x32_bf16 a[64:67], v[112:115], v[96:99], a[64:67]
    v_mfma_f32_16x16x32_bf16 a[68:71], v[64:67], v[52:55], 0
    buffer_load_dwordx4 v[192:195], v5, s[16:19], s35 offen offset:1024
    v_mfma_f32_16x16x32_bf16 a[68:71], v[112:115], v[100:103], a[68:71]
    s_waitcnt vmcnt(17)
    v_mfma_f32_16x16x32_bf16 a[72:75], v[68:71], v[32:35], 0
    s_waitcnt vmcnt(16)
    v_mfma_f32_16x16x32_bf16 a[72:75], v[116:119], v[80:83], a[72:75]
    buffer_load_dwordx4 v[148:151], v6, s[16:19], s35 offen offset:0
    v_mfma_f32_16x16x32_bf16 a[76:79], v[68:71], v[36:39], 0
    v_mfma_f32_16x16x32_bf16 a[76:79], v[116:119], v[84:87], a[76:79]
    v_mfma_f32_16x16x32_bf16 a[80:83], v[68:71], v[40:43], 0
    buffer_load_dwordx4 v[196:199], v6, s[16:19], s35 offen offset:1024
    v_mfma_f32_16x16x32_bf16 a[80:83], v[116:119], v[88:91], a[80:83]
    v_mfma_f32_16x16x32_bf16 a[84:87], v[68:71], v[44:47], 0
    v_mfma_f32_16x16x32_bf16 a[84:87], v[116:119], v[92:95], a[84:87]
    buffer_load_dwordx4 v[156:159], v18, s[20:23], s36 offen offset:1024
    v_mfma_f32_16x16x32_bf16 a[88:91], v[68:71], v[48:51], 0
    v_mfma_f32_16x16x32_bf16 a[88:91], v[116:119], v[96:99], a[88:91]
    v_mfma_f32_16x16x32_bf16 a[92:95], v[68:71], v[52:55], 0
    buffer_load_dwordx4 v[204:207], v18, s[20:23], s44 offen offset:1024
    v_mfma_f32_16x16x32_bf16 a[92:95], v[116:119], v[100:103], a[92:95]
    s_waitcnt vmcnt(19)
    v_mfma_f32_16x16x32_bf16 a[96:99], v[72:75], v[32:35], 0
    s_waitcnt vmcnt(18)
    v_mfma_f32_16x16x32_bf16 a[96:99], v[120:123], v[80:83], a[96:99]
    buffer_load_dwordx4 v[160:163], v18, s[20:23], s36 offen offset:2048
    v_mfma_f32_16x16x32_bf16 a[100:103], v[72:75], v[36:39], 0
    v_mfma_f32_16x16x32_bf16 a[100:103], v[120:123], v[84:87], a[100:103]
    v_mfma_f32_16x16x32_bf16 a[104:107], v[72:75], v[40:43], 0
    buffer_load_dwordx4 v[208:211], v18, s[20:23], s44 offen offset:2048
    v_mfma_f32_16x16x32_bf16 a[104:107], v[120:123], v[88:91], a[104:107]
    v_mfma_f32_16x16x32_bf16 a[108:111], v[72:75], v[44:47], 0
    v_mfma_f32_16x16x32_bf16 a[108:111], v[120:123], v[92:95], a[108:111]
    buffer_load_dwordx4 v[164:167], v7, s[20:23], s36 offen offset:0
    v_mfma_f32_16x16x32_bf16 a[112:115], v[72:75], v[48:51], 0
    v_mfma_f32_16x16x32_bf16 a[112:115], v[120:123], v[96:99], a[112:115]
    v_mfma_f32_16x16x32_bf16 a[116:119], v[72:75], v[52:55], 0
    buffer_load_dwordx4 v[212:215], v7, s[20:23], s44 offen offset:0
    v_mfma_f32_16x16x32_bf16 a[116:119], v[120:123], v[100:103], a[116:119]
    s_waitcnt vmcnt(21)
    v_mfma_f32_16x16x32_bf16 a[120:123], v[76:79], v[32:35], 0
    s_waitcnt vmcnt(20)
    v_mfma_f32_16x16x32_bf16 a[120:123], v[124:127], v[80:83], a[120:123]
    buffer_load_dwordx4 v[168:171], v7, s[20:23], s36 offen offset:1024
    v_mfma_f32_16x16x32_bf16 a[124:127], v[76:79], v[36:39], 0
    v_mfma_f32_16x16x32_bf16 a[124:127], v[124:127], v[84:87], a[124:127]
    v_mfma_f32_16x16x32_bf16 a[128:131], v[76:79], v[40:43], 0
    buffer_load_dwordx4 v[216:219], v7, s[20:23], s44 offen offset:1024
    v_mfma_f32_16x16x32_bf16 a[128:131], v[124:127], v[88:91], a[128:131]
    v_mfma_f32_16x16x32_bf16 a[132:135], v[76:79], v[44:47], 0
    v_mfma_f32_16x16x32_bf16 a[132:135], v[124:127], v[92:95], a[132:135]
    buffer_load_dwordx4 v[172:175], v7, s[20:23], s36 offen offset:2048
    v_mfma_f32_16x16x32_bf16 a[136:139], v[76:79], v[48:51], 0
    v_mfma_f32_16x16x32_bf16 a[136:139], v[124:127], v[96:99], a[136:139]
    v_mfma_f32_16x16x32_bf16 a[140:143], v[76:79], v[52:55], 0
    buffer_load_dwordx4 v[220:223], v7, s[20:23], s44 offen offset:2048
    s_add_u32 s36, s36, 12288
    s_add_u32 s44, s44, 12288
    s_add_u32 s35, s35, 2048
    v_mfma_f32_16x16x32_bf16 a[140:143], v[124:127], v[100:103], a[140:143]
    s_waitcnt vmcnt(21)
    v_mfma_f32_16x16x32_bf16 a[0:3], v[152:155], v[128:131], a[0:3]
    s_waitcnt vmcnt(20)
    v_mfma_f32_16x16x32_bf16 a[0:3], v[200:203], v[176:179], a[0:3]
    buffer_load_dwordx4 v[56:59], v18, s[20:23], s36 offen offset:0
    s_waitcnt vmcnt(20)
    v_mfma_f32_16x16x32_bf16 a[4:7], v[152:155], v[132:135], a[4:7]
    s_waitcnt vmcnt(19)
    v_mfma_f32_16x16x32_bf16 a[4:7], v[200:203], v[180:183], a[4:7]
    s_waitcnt vmcnt(18)
    v_mfma_f32_16x16x32_bf16 a[8:11], v[152:155], v[136:139], a[8:11]
    buffer_load_dwordx4 v[104:107], v18, s[20:23], s44 offen offset:0
    s_waitcnt vmcnt(18)
    v_mfma_f32_16x16x32_bf16 a[8:11], v[200:203], v[184:187], a[8:11]
    s_waitcnt vmcnt(17)
    v_mfma_f32_16x16x32_bf16 a[12:15], v[152:155], v[140:143], a[12:15]
    s_waitcnt vmcnt(16)
    v_mfma_f32_16x16x32_bf16 a[12:15], v[200:203], v[188:191], a[12:15]
    buffer_load_dwordx4 v[32:35], v1, s[16:19], s35 offen offset:0
    s_waitcnt vmcnt(16)
    v_mfma_f32_16x16x32_bf16 a[16:19], v[152:155], v[144:147], a[16:19]
    s_waitcnt vmcnt(15)
    v_mfma_f32_16x16x32_bf16 a[16:19], v[200:203], v[192:195], a[16:19]
    s_waitcnt vmcnt(14)
    v_mfma_f32_16x16x32_bf16 a[20:23], v[152:155], v[148:151], a[20:23]
    buffer_load_dwordx4 v[80:83], v1, s[16:19], s35 offen offset:1024
    s_waitcnt vmcnt(14)
    v_mfma_f32_16x16x32_bf16 a[20:23], v[200:203], v[196:199], a[20:23]
    s_waitcnt vmcnt(13)
    v_mfma_f32_16x16x32_bf16 a[24:27], v[156:159], v[128:131], a[24:27]
    s_waitcnt vmcnt(12)
    v_mfma_f32_16x16x32_bf16 a[24:27], v[204:207], v[176:179], a[24:27]
    buffer_load_dwordx4 v[36:39], v2, s[16:19], s35 offen offset:0
    v_mfma_f32_16x16x32_bf16 a[28:31], v[156:159], v[132:135], a[28:31]
    v_mfma_f32_16x16x32_bf16 a[28:31], v[204:207], v[180:183], a[28:31]
    v_mfma_f32_16x16x32_bf16 a[32:35], v[156:159], v[136:139], a[32:35]
    buffer_load_dwordx4 v[84:87], v2, s[16:19], s35 offen offset:1024
    v_mfma_f32_16x16x32_bf16 a[32:35], v[204:207], v[184:187], a[32:35]
    v_mfma_f32_16x16x32_bf16 a[36:39], v[156:159], v[140:143], a[36:39]
    v_mfma_f32_16x16x32_bf16 a[36:39], v[204:207], v[188:191], a[36:39]
    buffer_load_dwordx4 v[40:43], v3, s[16:19], s35 offen offset:0
    v_mfma_f32_16x16x32_bf16 a[40:43], v[156:159], v[144:147], a[40:43]
    v_mfma_f32_16x16x32_bf16 a[40:43], v[204:207], v[192:195], a[40:43]
    v_mfma_f32_16x16x32_bf16 a[44:47], v[156:159], v[148:151], a[44:47]
    buffer_load_dwordx4 v[88:91], v3, s[16:19], s35 offen offset:1024
    v_mfma_f32_16x16x32_bf16 a[44:47], v[204:207], v[196:199], a[44:47]
    s_waitcnt vmcnt(15)
    v_mfma_f32_16x16x32_bf16 a[48:51], v[160:163], v[128:131], a[48:51]
    s_waitcnt vmcnt(14)
    v_mfma_f32_16x16x32_bf16 a[48:51], v[208:211], v[176:179], a[48:51]
    buffer_load_dwordx4 v[44:47], v4, s[16:19], s35 offen offset:0
    v_mfma_f32_16x16x32_bf16 a[52:55], v[160:163], v[132:135], a[52:55]
    v_mfma_f32_16x16x32_bf16 a[52:55], v[208:211], v[180:183], a[52:55]
    v_mfma_f32_16x16x32_bf16 a[56:59], v[160:163], v[136:139], a[56:59]
    buffer_load_dwordx4 v[92:95], v4, s[16:19], s35 offen offset:1024
    v_mfma_f32_16x16x32_bf16 a[56:59], v[208:211], v[184:187], a[56:59]
    v_mfma_f32_16x16x32_bf16 a[60:63], v[160:163], v[140:143], a[60:63]
    v_mfma_f32_16x16x32_bf16 a[60:63], v[208:211], v[188:191], a[60:63]
    buffer_load_dwordx4 v[48:51], v5, s[16:19], s35 offen offset:0
    v_mfma_f32_16x16x32_bf16 a[64:67], v[160:163], v[144:147], a[64:67]
    v_mfma_f32_16x16x32_bf16 a[64:67], v[208:211], v[192:195], a[64:67]
    v_mfma_f32_16x16x32_bf16 a[68:71], v[160:163], v[148:151], a[68:71]
    buffer_load_dwordx4 v[96:99], v5, s[16:19], s35 offen offset:1024
    v_mfma_f32_16x16x32_bf16 a[68:71], v[208:211], v[196:199], a[68:71]
    s_waitcnt vmcnt(17)
    v_mfma_f32_16x16x32_bf16 a[72:75], v[164:167], v[128:131], a[72:75]
    s_waitcnt vmcnt(16)
    v_mfma_f32_16x16x32_bf16 a[72:75], v[212:215], v[176:179], a[72:75]
    buffer_load_dwordx4 v[52:55], v6, s[16:19], s35 offen offset:0
    v_mfma_f32_16x16x32_bf16 a[76:79], v[164:167], v[132:135], a[76:79]
    v_mfma_f32_16x16x32_bf16 a[76:79], v[212:215], v[180:183], a[76:79]
    v_mfma_f32_16x16x32_bf16 a[80:83], v[164:167], v[136:139], a[80:83]
    buffer_load_dwordx4 v[100:103], v6, s[16:19], s35 offen offset:1024
    v_mfma_f32_16x16x32_bf16 a[80:83], v[212:215], v[184:187], a[80:83]
    v_mfma_f32_16x16x32_bf16 a[84:87], v[164:167], v[140:143], a[84:87]
    v_mfma_f32_16x16x32_bf16 a[84:87], v[212:215], v[188:191], a[84:87]
    buffer_load_dwordx4 v[60:63], v18, s[20:23], s36 offen offset:1024
    v_mfma_f32_16x16x32_bf16 a[88:91], v[164:167], v[144:147], a[88:91]
    v_mfma_f32_16x16x32_bf16 a[88:91], v[212:215], v[192:195], a[88:91]
    v_mfma_f32_16x16x32_bf16 a[92:95], v[164:167], v[148:151], a[92:95]
    buffer_load_dwordx4 v[108:111], v18, s[20:23], s44 offen offset:1024
    v_mfma_f32_16x16x32_bf16 a[92:95], v[212:215], v[196:199], a[92:95]
    s_waitcnt vmcnt(19)
    v_mfma_f32_16x16x32_bf16 a[96:99], v[168:171], v[128:131], a[96:99]
    s_waitcnt vmcnt(18)
    v_mfma_f32_16x16x32_bf16 a[96:99], v[216:219], v[176:179], a[96:99]
    buffer_load_dwordx4 v[64:67], v18, s[20:23], s36 offen offset:2048
    v_mfma_f32_16x16x32_bf16 a[100:103], v[168:171], v[132:135], a[100:103]
    v_mfma_f32_16x16x32_bf16 a[100:103], v[216:219], v[180:183], a[100:103]
    v_mfma_f32_16x16x32_bf16 a[104:107], v[168:171], v[136:139], a[104:107]
    buffer_load_dwordx4 v[112:115], v18, s[20:23], s44 offen offset:2048
    v_mfma_f32_16x16x32_bf16 a[104:107], v[216:219], v[184:187], a[104:107]
    v_mfma_f32_16x16x32_bf16 a[108:111], v[168:171], v[140:143], a[108:111]
    v_mfma_f32_16x16x32_bf16 a[108:111], v[216:219], v[188:191], a[108:111]
    buffer_load_dwordx4 v[68:71], v7, s[20:23], s36 offen offset:0
    v_mfma_f32_16x16x32_bf16 a[112:115], v[168:171], v[144:147], a[112:115]
    v_mfma_f32_16x16x32_bf16 a[112:115], v[216:219], v[192:195], a[112:115]
    v_mfma_f32_16x16x32_bf16 a[116:119], v[168:171], v[148:151], a[116:119]
    buffer_load_dwordx4 v[116:119], v7, s[20:23], s44 offen offset:0
    v_mfma_f32_16x16x32_bf16 a[116:119], v[216:219], v[196:199], a[116:119]
    s_waitcnt vmcnt(21)
    v_mfma_f32_16x16x32_bf16 a[120:123], v[172:175], v[128:131], a[120:123]
    s_waitcnt vmcnt(20)
    v_mfma_f32_16x16x32_bf16 a[120:123], v[220:223], v[176:179], a[120:123]
    buffer_load_dwordx4 v[72:75], v7, s[20:23], s36 offen offset:1024
    v_mfma_f32_16x16x32_bf16 a[124:127], v[172:175], v[132:135], a[124:127]
    v_mfma_f32_16x16x32_bf16 a[124:127], v[220:223], v[180:183], a[124:127]
    v_mfma_f32_16x16x32_bf16 a[128:131], v[172:175], v[136:139], a[128:131]
    buffer_load_dwordx4 v[120:123], v7, s[20:23], s44 offen offset:1024
    v_mfma_f32_16x16x32_bf16 a[128:131], v[220:223], v[184:187], a[128:131]
    v_mfma_f32_16x16x32_bf16 a[132:135], v[172:175], v[140:143], a[132:135]
    v_mfma_f32_16x16x32_bf16 a[132:135], v[220:223], v[188:191], a[132:135]
    buffer_load_dwordx4 v[76:79], v7, s[20:23], s36 offen offset:2048
    v_mfma_f32_16x16x32_bf16 a[136:139], v[172:175], v[144:147], a[136:139]
    v_mfma_f32_16x16x32_bf16 a[136:139], v[220:223], v[192:195], a[136:139]
    v_mfma_f32_16x16x32_bf16 a[140:143], v[172:175], v[148:151], a[140:143]
    buffer_load_dwordx4 v[124:127], v7, s[20:23], s44 offen offset:2048
    s_add_u32 s36, s36, 12288
    s_add_u32 s44, s44, 12288
    s_add_u32 s35, s35, 2048
    v_mfma_f32_16x16x32_bf16 a[140:143], v[220:223], v[196:199], a[140:143]
    s_mov_b32 s37, 6
L_k2_loop:
    s_waitcnt vmcnt(21)
    v_mfma_f32_16x16x32_bf16 a[0:3], v[56:59], v[32:35], a[0:3]
    s_waitcnt vmcnt(20)
    v_mfma_f32_16x16x32_bf16 a[0:3], v[104:107], v[80:83], a[0:3]
    buffer_load_dwordx4 v[152:155], v18, s[20:23], s36 offen offset:0
    s_waitcnt vmcnt(20)
    v_mfma_f32_16x16x32_bf16 a[4:7], v[56:59], v[36:39], a[4:7]
    s_waitcnt vmcnt(19)
    v_mfma_f32_16x16x32_bf16 a[4:7], v[104:107], v[84:87], a[4:7]
    s_waitcnt vmcnt(18)
    v_mfma_f32_16x16x32_bf16 a[8:11], v[56:59], v[40:43], a[8:11]
    buffer_load_dwordx4 v[200:203], v18, s[20:23], s44 offen offset:0
    s_waitcnt vmcnt(18)
    v_mfma_f32_16x16x32_bf16 a[8:11], v[104:107], v[88:91], a[8:11]
    s_waitcnt vmcnt(17)
    v_mfma_f32_16x16x32_bf16 a[12:15], v[56:59], v[44:47], a[12:15]
    s_waitcnt vmcnt(16)
    v_mfma_f32_16x16x32_bf16 a[12:15], v[104:107], v[92:95], a[12:15]
    buffer_load_dwordx4 v[128:131], v1, s[16:19], s35 offen offset:0
    s_waitcnt vmcnt(16)
    v_mfma_f32_16x16x32_bf16 a[16:19], v[56:59], v[48:51], a[16:19]
    s_waitcnt vmcnt(15)
    v_mfma_f32_16x16x32_bf16 a[16:19], v[104:107], v[96:99], a[16:19]
    s_waitcnt vmcnt(14)
    v_mfma_f32_16x16x32_bf16 a[20:23], v[56:59], v[52:55], a[20:23]
    buffer_load_dwordx4 v[176:179], v1, s[16:19], s35 offen offset:1024
    s_waitcnt vmcnt(14)
    v_mfma_f32_16x16x32_bf16 a[20:23], v[104:107], v[100:103], a[20:23]
    s_waitcnt vmcnt(13)
    v_mfma_f32_16x16x32_bf16 a[24:27], v[60:63], v[32:35], a[24:27]
    s_waitcnt vmcnt(12)
    v_mfma_f32_16x16x32_bf16 a[24:27], v[108:111], v[80:83], a[24:27]
    buffer_load_dwordx4 v[132:135], v2, s[16:19], s35 offen offset:0
    v_mfma_f32_16x16x32_bf16 a[28:31], v[60:63], v[36:39], a[28:31]
    v_mfma_f32_16x16x32_bf16 a[28:31], v[108:111], v[84:87], a[28:31]
    v_mfma_f32_16x16x32_bf16 a[32:35], v[60:63], v[40:43], a[32:35]
    buffer_load_dwordx4 v[180:183], v2, s[16:19], s35 offen offset:1024
    v_mfma_f32_16x16x32_bf16 a[32:35], v[108:111], v[88:91], a[32:35]
    v_mfma_f32_16x16x32_bf16 a[36:39], v[60:63], v[44:47], a[36:39]
    v_mfma_f32_16x16x32_bf16 a[36:39], v[108:111], v[92:95], a[36:39]
    buffer_load_dwordx4 v[136:139], v3, s[16:19], s35 offen offset:0
    v_mfma_f32_16x16x32_bf16 a[40:43], v[60:63], v[48:51], a[40:43]
    v_mfma_f32_16x16x32_bf16 a[40:43], v[108:111], v[96:99], a[40:43]
    v_mfma_f32_16x16x32_bf16 a[44:47], v[60:63], v[52:55], a[44:47]
    buffer_load_dwordx4 v[184:187], v3, s[16:19], s35 offen offset:1024
    v_mfma_f32_16x16x32_bf16 a[44:47], v[108:111], v[100:103], a[44:47]
    s_waitcnt vmcnt(15)
    v_mfma_f32_16x16x32_bf16 a[48:51], v[64:67], v[32:35], a[48:51]
    s_waitcnt vmcnt(14)
    v_mfma_f32_16x16x32_bf16 a[48:51], v[112:115], v[80:83], a[48:51]
    buffer_load_dwordx4 v[140:143], v4, s[16:19], s35 offen offset:0
    v_mfma_f32_16x16x32_bf16 a[52:55], v[64:67], v[36:39], a[52:55]
    v_mfma_f32_16x16x32_bf16 a[52:55], v[112:115], v[84:87], a[52:55]
    v_mfma_f32_16x16x32_bf16 a[56:59], v[64:67], v[40:43], a[56:59]
    buffer_load_dwordx4 v[188:191], v4, s[16:19], s35 offen offset:1024
    v_mfma_f32_16x16x32_bf16 a[56:59], v[112:115], v[88:91], a[56:59]
    v_mfma_f32_16x16x32_bf16 a[60:63], v[64:67], v[44:47], a[60:63]
    v_mfma_f32_16x16x32_bf16 a[60:63], v[112:115], v[92:95], a[60:63]
    buffer_load_dwordx4 v[144:147], v5, s[16:19], s35 offen offset:0
    v_mfma_f32_16x16x32_bf16 a[64:67], v[64:67], v[48:51], a[64:67]
    v_mfma_f32_16x16x32_bf16 a[64:67], v[112:115], v[96:99], a[64:67]
    v_mfma_f32_16x16x32_bf16 a[68:71], v[64:67], v[52:55], a[68:71]
    buffer_load_dwordx4 v[192:195], v5, s[16:19], s35 offen offset:1024
    v_mfma_f32_16x16x32_bf16 a[68:71], v[112:115], v[100:103], a[68:71]
    s_waitcnt vmcnt(17)
    v_mfma_f32_16x16x32_bf16 a[72:75], v[68:71], v[32:35], a[72:75]
    s_waitcnt vmcnt(16)
    v_mfma_f32_16x16x32_bf16 a[72:75], v[116:119], v[80:83], a[72:75]
    buffer_load_dwordx4 v[148:151], v6, s[16:19], s35 offen offset:0
    v_mfma_f32_16x16x32_bf16 a[76:79], v[68:71], v[36:39], a[76:79]
    v_mfma_f32_16x16x32_bf16 a[76:79], v[116:119], v[84:87], a[76:79]
    v_mfma_f32_16x16x32_bf16 a[80:83], v[68:71], v[40:43], a[80:83]
    buffer_load_dwordx4 v[196:199], v6, s[16:19], s35 offen offset:1024
    v_mfma_f32_16x16x32_bf16 a[80:83], v[116:119], v[88:91], a[80:83]
    v_mfma_f32_16x16x32_bf16 a[84:87], v[68:71], v[44:47], a[84:87]
    v_mfma_f32_16x16x32_bf16 a[84:87], v[116:119], v[92:95], a[84:87]
    buffer_load_dwordx4 v[156:159], v18, s[20:23], s36 offen offset:1024
    v_mfma_f32_16x16x32_bf16 a[88:91], v[68:71], v[48:51], a[88:91]
    v_mfma_f32_16x16x32_bf16 a[88:91], v[116:119], v[96:99], a[88:91]
    v_mfma_f32_16x16x32_bf16 a[92:95], v[68:71], v[52:55], a[92:95]
    buffer_load_dwordx4 v[204:207], v18, s[20:23], s44 offen offset:1024
    v_mfma_f32_16x16x32_bf16 a[92:95], v[116:119], v[100:103], a[92:95]
    s_waitcnt vmcnt(19)
    v_mfma_f32_16x16x32_bf16 a[96:99], v[72:75], v[32:35], a[96:99]
    s_waitcnt vmcnt(18)
    v_mfma_f32_16x16x32_bf16 a[96:99], v[120:123], v[80:83], a[96:99]
    buffer_load_dwordx4 v[160:163], v18, s[20:23], s36 offen offset:2048
    v_mfma_f32_16x16x32_bf16 a[100:103], v[72:75], v[36:39], a[100:103]
    v_mfma_f32_16x16x32_bf16 a[100:103], v[120:123], v[84:87], a[100:103]
    v_mfma_f32_16x16x32_bf16 a[104:107], v[72:75], v[40:43], a[104:107]
    buffer_load_dwordx4 v[208:211], v18, s[20:23], s44 offen offset:2048
    v_mfma_f32_16x16x32_bf16 a[104:107], v[120:123], v[88:91], a[104:107]
    v_mfma_f32_16x16x32_bf16 a[108:111], v[72:75], v[44:47], a[108:111]
    v_mfma_f32_16x16x32_bf16 a[108:111], v[120:123], v[92:95], a[108:111]
    buffer_load_dwordx4 v[164:167], v7, s[20:23], s36 offen offset:0
    v_mfma_f32_16x16x32_bf16 a[112:115], v[72:75], v[48:51], a[112:115]
    v_mfma_f32_16x16x32_bf16 a[112:115], v[120:123], v[96:99], a[112:115]
    v_mfma_f32_16x16x32_bf16 a[116:119], v[72:75], v[52:55], a[116:119]
    buffer_load_dwordx4 v[212:215], v7, s[20:23], s44 offen offset:0
    v_mfma_f32_16x16x32_bf16 a[116:119], v[120:123], v[100:103], a[116:119]
    s_waitcnt vmcnt(21)
    v_mfma_f32_16x16x32_bf16 a[120:123], v[76:79], v[32:35], a[120:123]
    s_waitcnt vmcnt(20)
    v_mfma_f32_16x16x32_bf16 a[120:123], v[124:127], v[80:83], a[120:123]
    buffer_load_dwordx4 v[168:171], v7, s[20:23], s36 offen offset:1024
    v_mfma_f32_16x16x32_bf16 a[124:127], v[76:79], v[36:39], a[124:127]
    v_mfma_f32_16x16x32_bf16 a[124:127], v[124:127], v[84:87], a[124:127]
    v_mfma_f32_16x16x32_bf16 a[128:131], v[76:79], v[40:43], a[128:131]
    buffer_load_dwordx4 v[216:219], v7, s[20:23], s44 offen offset:1024
    v_mfma_f32_16x16x32_bf16 a[128:131], v[124:127], v[88:91], a[128:131]
    v_mfma_f32_16x16x32_bf16 a[132:135], v[76:79], v[44:47], a[132:135]
    v_mfma_f32_16x16x32_bf16 a[132:135], v[124:127], v[92:95], a[132:135]
    buffer_load_dwordx4 v[172:175], v7, s[20:23], s36 offen offset:2048
    v_mfma_f32_16x16x32_bf16 a[136:139], v[76:79], v[48:51], a[136:139]
    v_mfma_f32_16x16x32_bf16 a[136:139], v[124:127], v[96:99], a[136:139]
    v_mfma_f32_16x16x32_bf16 a[140:143], v[76:79], v[52:55], a[140:143]
    buffer_load_dwordx4 v[220:223], v7, s[20:23], s44 offen offset:2048
    s_add_u32 s36, s36, 12288
    s_add_u32 s44, s44, 12288
    s_add_u32 s35, s35, 2048
    v_mfma_f32_16x16x32_bf16 a[140:143], v[124:127], v[100:103], a[140:143]
    s_waitcnt vmcnt(21)
    v_mfma_f32_16x16x32_bf16 a[0:3], v[152:155], v[128:131], a[0:3]
    s_waitcnt vmcnt(20)
    v_mfma_f32_16x16x32_bf16 a[0:3], v[200:203], v[176:179], a[0:3]
    buffer_load_dwordx4 v[56:59], v18, s[20:23], s36 offen offset:0
    s_waitcnt vmcnt(20)
    v_mfma_f32_16x16x32_bf16 a[4:7], v[152:155], v[132:135], a[4:7]
    s_waitcnt vmcnt(19)
    v_mfma_f32_16x16x32_bf16 a[4:7], v[200:203], v[180:183], a[4:7]
    s_waitcnt vmcnt(18)
    v_mfma_f32_16x16x32_bf16 a[8:11], v[152:155], v[136:139], a[8:11]
    buffer_load_dwordx4 v[104:107], v18, s[20:23], s44 offen offset:0
    s_waitcnt vmcnt(18)
    v_mfma_f32_16x16x32_bf16 a[8:11], v[200:203], v[184:187], a[8:11]
    s_waitcnt vmcnt(17)
    v_mfma_f32_16x16x32_bf16 a[12:15], v[152:155], v[140:143], a[12:15]
    s_waitcnt vmcnt(16)
    v_mfma_f32_16x16x32_bf16 a[12:15], v[200:203], v[188:191], a[12:15]
    buffer_load_dwordx4 v[32:35], v1, s[16:19], s35 offen offset:0
    s_waitcnt vmcnt(16)
    v_mfma_f32_16x16x32_bf16 a[16:19], v[152:155], v[144:147], a[16:19]
    s_waitcnt vmcnt(15)
    v_mfma_f32_16x16x32_bf16 a[16:19], v[200:203], v[192:195], a[16:19]
    s_waitcnt vmcnt(14)
    v_mfma_f32_16x16x32_bf16 a[20:23], v[152:155], v[148:151], a[20:23]
    buffer_load_dwordx4 v[80:83], v1, s[16:19], s35 offen offset:1024
    s_waitcnt vmcnt(14)
    v_mfma_f32_16x16x32_bf16 a[20:23], v[200:203], v[196:199], a[20:23]
    s_waitcnt vmcnt(13)
    v_mfma_f32_16x16x32_bf16 a[24:27], v[156:159], v[128:131], a[24:27]
    s_waitcnt vmcnt(12)
    v_mfma_f32_16x16x32_bf16 a[24:27], v[204:207], v[176:179], a[24:27]
    buffer_load_dwordx4 v[36:39], v2, s[16:19], s35 offen offset:0
    v_mfma_f32_16x16x32_bf16 a[28:31], v[156:159], v[132:135], a[28:31]
    v_mfma_f32_16x16x32_bf16 a[28:31], v[204:207], v[180:183], a[28:31]
    v_mfma_f32_16x16x32_bf16 a[32:35], v[156:159], v[136:139], a[32:35]
    buffer_load_dwordx4 v[84:87], v2, s[16:19], s35 offen offset:1024
    v_mfma_f32_16x16x32_bf16 a[32:35], v[204:207], v[184:187], a[32:35]
    v_mfma_f32_16x16x32_bf16 a[36:39], v[156:159], v[140:143], a[36:39]
    v_mfma_f32_16x16x32_bf16 a[36:39], v[204:207], v[188:191], a[36:39]
    buffer_load_dwordx4 v[40:43], v3, s[16:19], s35 offen offset:0
    v_mfma_f32_16x16x32_bf16 a[40:43], v[156:159], v[144:147], a[40:43]
    v_mfma_f32_16x16x32_bf16 a[40:43], v[204:207], v[192:195], a[40:43]
    v_mfma_f32_16x16x32_bf16 a[44:47], v[156:159], v[148:151], a[44:47]
    buffer_load_dwordx4 v[88:91], v3, s[16:19], s35 offen offset:1024
    v_mfma_f32_16x16x32_bf16 a[44:47], v[204:207], v[196:199], a[44:47]
    s_waitcnt vmcnt(15)
    v_mfma_f32_16x16x32_bf16 a[48:51], v[160:163], v[128:131], a[48:51]
    s_waitcnt vmcnt(14)
    v_mfma_f32_16x16x32_bf16 a[48:51], v[208:211], v[176:179], a[48:51]
    buffer_load_dwordx4 v[44:47], v4, s[16:19], s35 offen offset:0
    v_mfma_f32_16x16x32_bf16 a[52:55], v[160:163], v[132:135], a[52:55]
    v_mfma_f32_16x16x32_bf16 a[52:55], v[208:211], v[180:183], a[52:55]
    v_mfma_f32_16x16x32_bf16 a[56:59], v[160:163], v[136:139], a[56:59]
    buffer_load_dwordx4 v[92:95], v4, s[16:19], s35 offen offset:1024
    v_mfma_f32_16x16x32_bf16 a[56:59], v[208:211], v[184:187], a[56:59]
    v_mfma_f32_16x16x32_bf16 a[60:63], v[160:163], v[140:143], a[60:63]
    v_mfma_f32_16x16x32_bf16 a[60:63], v[208:211], v[188:191], a[60:63]
    buffer_load_dwordx4 v[48:51], v5, s[16:19], s35 offen offset:0
    v_mfma_f32_16x16x32_bf16 a[64:67], v[160:163], v[144:147], a[64:67]
    v_mfma_f32_16x16x32_bf16 a[64:67], v[208:211], v[192:195], a[64:67]
    v_mfma_f32_16x16x32_bf16 a[68:71], v[160:163], v[148:151], a[68:71]
    buffer_load_dwordx4 v[96:99], v5, s[16:19], s35 offen offset:1024
    v_mfma_f32_16x16x32_bf16 a[68:71], v[208:211], v[196:199], a[68:71]
    s_waitcnt vmcnt(17)
    v_mfma_f32_16x16x32_bf16 a[72:75], v[164:167], v[128:131], a[72:75]
    s_waitcnt vmcnt(16)
    v_mfma_f32_16x16x32_bf16 a[72:75], v[212:215], v[176:179], a[72:75]
    buffer_load_dwordx4 v[52:55], v6, s[16:19], s35 offen offset:0
    v_mfma_f32_16x16x32_bf16 a[76:79], v[164:167], v[132:135], a[76:79]
    v_mfma_f32_16x16x32_bf16 a[76:79], v[212:215], v[180:183], a[76:79]
    v_mfma_f32_16x16x32_bf16 a[80:83], v[164:167], v[136:139], a[80:83]
    buffer_load_dwordx4 v[100:103], v6, s[16:19], s35 offen offset:1024
    v_mfma_f32_16x16x32_bf16 a[80:83], v[212:215], v[184:187], a[80:83]
    v_mfma_f32_16x16x32_bf16 a[84:87], v[164:167], v[140:143], a[84:87]
    v_mfma_f32_16x16x32_bf16 a[84:87], v[212:215], v[188:191], a[84:87]
    buffer_load_dwordx4 v[60:63], v18, s[20:23], s36 offen offset:1024
    v_mfma_f32_16x16x32_bf16 a[88:91], v[164:167], v[144:147], a[88:91]
    v_mfma_f32_16x16x32_bf16 a[88:91], v[212:215], v[192:195], a[88:91]
    v_mfma_f32_16x16x32_bf16 a[92:95], v[164:167], v[148:151], a[92:95]
    buffer_load_dwordx4 v[108:111], v18, s[20:23], s44 offen offset:1024
    v_mfma_f32_16x16x32_bf16 a[92:95], v[212:215], v[196:199], a[92:95]
    s_waitcnt vmcnt(19)
    v_mfma_f32_16x16x32_bf16 a[96:99], v[168:171], v[128:131], a[96:99]
    s_waitcnt vmcnt(18)
    v_mfma_f32_16x16x32_bf16 a[96:99], v[216:219], v[176:179], a[96:99]
    buffer_load_dwordx4 v[64:67], v18, s[20:23], s36 offen offset:2048
    v_mfma_f32_16x16x32_bf16 a[100:103], v[168:171], v[132:135], a[100:103]
    v_mfma_f32_16x16x32_bf16 a[100:103], v[216:219], v[180:183], a[100:103]
    v_mfma_f32_16x16x32_bf16 a[104:107], v[168:171], v[136:139], a[104:107]
    buffer_load_dwordx4 v[112:115], v18, s[20:23], s44 offen offset:2048
    v_mfma_f32_16x16x32_bf16 a[104:107], v[216:219], v[184:187], a[104:107]
    v_mfma_f32_16x16x32_bf16 a[108:111], v[168:171], v[140:143], a[108:111]
    v_mfma_f32_16x16x32_bf16 a[108:111], v[216:219], v[188:191], a[108:111]
    buffer_load_dwordx4 v[68:71], v7, s[20:23], s36 offen offset:0
    v_mfma_f32_16x16x32_bf16 a[112:115], v[168:171], v[144:147], a[112:115]
    v_mfma_f32_16x16x32_bf16 a[112:115], v[216:219], v[192:195], a[112:115]
    v_mfma_f32_16x16x32_bf16 a[116:119], v[168:171], v[148:151], a[116:119]
    buffer_load_dwordx4 v[116:119], v7, s[20:23], s44 offen offset:0
    v_mfma_f32_16x16x32_bf16 a[116:119], v[216:219], v[196:199], a[116:119]
    s_waitcnt vmcnt(21)
    v_mfma_f32_16x16x32_bf16 a[120:123], v[172:175], v[128:131], a[120:123]
    s_waitcnt vmcnt(20)
    v_mfma_f32_16x16x32_bf16 a[120:123], v[220:223], v[176:179], a[120:123]
    buffer_load_dwordx4 v[72:75], v7, s[20:23], s36 offen offset:1024
    v_mfma_f32_16x16x32_bf16 a[124:127], v[172:175], v[132:135], a[124:127]
    v_mfma_f32_16x16x32_bf16 a[124:127], v[220:223], v[180:183], a[124:127]
    v_mfma_f32_16x16x32_bf16 a[128:131], v[172:175], v[136:139], a[128:131]
    buffer_load_dwordx4 v[120:123], v7, s[20:23], s44 offen offset:1024
    v_mfma_f32_16x16x32_bf16 a[128:131], v[220:223], v[184:187], a[128:131]
    v_mfma_f32_16x16x32_bf16 a[132:135], v[172:175], v[140:143], a[132:135]
    v_mfma_f32_16x16x32_bf16 a[132:135], v[220:223], v[188:191], a[132:135]
    buffer_load_dwordx4 v[76:79], v7, s[20:23], s36 offen offset:2048
    v_mfma_f32_16x16x32_bf16 a[136:139], v[172:175], v[144:147], a[136:139]
    v_mfma_f32_16x16x32_bf16 a[136:139], v[220:223], v[192:195], a[136:139]
    v_mfma_f32_16x16x32_bf16 a[140:143], v[172:175], v[148:151], a[140:143]
    buffer_load_dwordx4 v[124:127], v7, s[20:23], s44 offen offset:2048
    s_add_u32 s36, s36, 12288
    s_add_u32 s44, s44, 12288
    s_add_u32 s35, s35, 2048
    v_mfma_f32_16x16x32_bf16 a[140:143], v[220:223], v[196:199], a[140:143]
    s_sub_u32 s37, s37, 1
    s_cmp_lg_u32 s37, 0
    s_cbranch_scc1 L_k2_loop
    s_waitcnt vmcnt(21)
    v_mfma_f32_16x16x32_bf16 a[0:3], v[56:59], v[32:35], a[0:3]
    s_waitcnt vmcnt(20)
    v_mfma_f32_16x16x32_bf16 a[0:3], v[104:107], v[80:83], a[0:3]
    buffer_load_dwordx4 v[152:155], v18, s[20:23], s36 offen offset:0
    s_waitcnt vmcnt(20)
    v_mfma_f32_16x16x32_bf16 a[4:7], v[56:59], v[36:39], a[4:7]
    s_waitcnt vmcnt(19)
    v_mfma_f32_16x16x32_bf16 a[4:7], v[104:107], v[84:87], a[4:7]
    s_waitcnt vmcnt(18)
    v_mfma_f32_16x16x32_bf16 a[8:11], v[56:59], v[40:43], a[8:11]
    buffer_load_dwordx4 v[200:203], v18, s[20:23], s44 offen offset:0
    s_waitcnt vmcnt(18)
    v_mfma_f32_16x16x32_bf16 a[8:11], v[104:107], v[88:91], a[8:11]
    s_waitcnt vmcnt(17)
    v_mfma_f32_16x16x32_bf16 a[12:15], v[56:59], v[44:47], a[12:15]
    s_waitcnt vmcnt(16)
    v_mfma_f32_16x16x32_bf16 a[12:15], v[104:107], v[92:95], a[12:15]
    buffer_load_dwordx4 v[128:131], v1, s[16:19], s35 offen offset:0
    s_waitcnt vmcnt(16)
    v_mfma_f32_16x16x32_bf16 a[16:19], v[56:59], v[48:51], a[16:19]
    s_waitcnt vmcnt(15)
    v_mfma_f32_16x16x32_bf16 a[16:19], v[104:107], v[96:99], a[16:19]
    s_waitcnt vmcnt(14)
    v_mfma_f32_16x16x32_bf16 a[20:23], v[56:59], v[52:55], a[20:23]
    buffer_load_dwordx4 v[176:179], v1, s[16:19], s35 offen offset:1024
    s_waitcnt vmcnt(14)
    v_mfma_f32_16x16x32_bf16 a[20:23], v[104:107], v[100:103], a[20:23]
    s_waitcnt vmcnt(13)
    v_mfma_f32_16x16x32_bf16 a[24:27], v[60:63], v[32:35], a[24:27]
    s_waitcnt vmcnt(12)
    v_mfma_f32_16x16x32_bf16 a[24:27], v[108:111], v[80:83], a[24:27]
    buffer_load_dwordx4 v[132:135], v2, s[16:19], s35 offen offset:0
    v_mfma_f32_16x16x32_bf16 a[28:31], v[60:63], v[36:39], a[28:31]
    v_mfma_f32_16x16x32_bf16 a[28:31], v[108:111], v[84:87], a[28:31]
    v_mfma_f32_16x16x32_bf16 a[32:35], v[60:63], v[40:43], a[32:35]
    buffer_load_dwordx4 v[180:183], v2, s[16:19], s35 offen offset:1024
    v_mfma_f32_16x16x32_bf16 a[32:35], v[108:111], v[88:91], a[32:35]
    v_mfma_f32_16x16x32_bf16 a[36:39], v[60:63], v[44:47], a[36:39]
    v_mfma_f32_16x16x32_bf16 a[36:39], v[108:111], v[92:95], a[36:39]
    buffer_load_dwordx4 v[136:139], v3, s[16:19], s35 offen offset:0
    v_mfma_f32_16x16x32_bf16 a[40:43], v[60:63], v[48:51], a[40:43]
    v_mfma_f32_16x16x32_bf16 a[40:43], v[108:111], v[96:99], a[40:43]
    v_mfma_f32_16x16x32_bf16 a[44:47], v[60:63], v[52:55], a[44:47]
    buffer_load_dwordx4 v[184:187], v3, s[16:19], s35 offen offset:1024
    v_mfma_f32_16x16x32_bf16 a[44:47], v[108:111], v[100:103], a[44:47]
    s_waitcnt vmcnt(15)
    v_mfma_f32_16x16x32_bf16 a[48:51], v[64:67], v[32:35], a[48:51]
    s_waitcnt vmcnt(14)
    v_mfma_f32_16x16x32_bf16 a[48:51], v[112:115], v[80:83], a[48:51]
    buffer_load_dwordx4 v[140:143], v4, s[16:19], s35 offen offset:0
    v_mfma_f32_16x16x32_bf16 a[52:55], v[64:67], v[36:39], a[52:55]
    v_mfma_f32_16x16x32_bf16 a[52:55], v[112:115], v[84:87], a[52:55]
    v_mfma_f32_16x16x32_bf16 a[56:59], v[64:67], v[40:43], a[56:59]
    buffer_load_dwordx4 v[188:191], v4, s[16:19], s35 offen offset:1024
    v_mfma_f32_16x16x32_bf16 a[56:59], v[112:115], v[88:91], a[56:59]
    v_mfma_f32_16x16x32_bf16 a[60:63], v[64:67], v[44:47], a[60:63]
    v_mfma_f32_16x16x32_bf16 a[60:63], v[112:115], v[92:95], a[60:63]
    buffer_load_dwordx4 v[144:147], v5, s[16:19], s35 offen offset:0
    v_mfma_f32_16x16x32_bf16 a[64:67], v[64:67], v[48:51], a[64:67]
    v_mfma_f32_16x16x32_bf16 a[64:67], v[112:115], v[96:99], a[64:67]
    v_mfma_f32_16x16x32_bf16 a[68:71], v[64:67], v[52:55], a[68:71]
    buffer_load_dwordx4 v[192:195], v5, s[16:19], s35 offen offset:1024
    v_mfma_f32_16x16x32_bf16 a[68:71], v[112:115], v[100:103], a[68:71]
    s_waitcnt vmcnt(17)
    v_mfma_f32_16x16x32_bf16 a[72:75], v[68:71], v[32:35], a[72:75]
    s_waitcnt vmcnt(16)
    v_mfma_f32_16x16x32_bf16 a[72:75], v[116:119], v[80:83], a[72:75]
    buffer_load_dwordx4 v[148:151], v6, s[16:19], s35 offen offset:0
    v_mfma_f32_16x16x32_bf16 a[76:79], v[68:71], v[36:39], a[76:79]
    v_mfma_f32_16x16x32_bf16 a[76:79], v[116:119], v[84:87], a[76:79]
    v_mfma_f32_16x16x32_bf16 a[80:83], v[68:71], v[40:43], a[80:83]
    buffer_load_dwordx4 v[196:199], v6, s[16:19], s35 offen offset:1024
    v_mfma_f32_16x16x32_bf16 a[80:83], v[116:119], v[88:91], a[80:83]
    v_mfma_f32_16x16x32_bf16 a[84:87], v[68:71], v[44:47], a[84:87]
    v_mfma_f32_16x16x32_bf16 a[84:87], v[116:119], v[92:95], a[84:87]
    buffer_load_dwordx4 v[156:159], v18, s[20:23], s36 offen offset:1024
    v_mfma_f32_16x16x32_bf16 a[88:91], v[68:71], v[48:51], a[88:91]
    v_mfma_f32_16x16x32_bf16 a[88:91], v[116:119], v[96:99], a[88:91]
    v_mfma_f32_16x16x32_bf16 a[92:95], v[68:71], v[52:55], a[92:95]
    buffer_load_dwordx4 v[204:207], v18, s[20:23], s44 offen offset:1024
    v_mfma_f32_16x16x32_bf16 a[92:95], v[116:119], v[100:103], a[92:95]
    s_waitcnt vmcnt(19)
    v_mfma_f32_16x16x32_bf16 a[96:99], v[72:75], v[32:35], a[96:99]
    s_waitcnt vmcnt(18)
    v_mfma_f32_16x16x32_bf16 a[96:99], v[120:123], v[80:83], a[96:99]
    buffer_load_dwordx4 v[160:163], v18, s[20:23], s36 offen offset:2048
    v_mfma_f32_16x16x32_bf16 a[100:103], v[72:75], v[36:39], a[100:103]
    v_mfma_f32_16x16x32_bf16 a[100:103], v[120:123], v[84:87], a[100:103]
    v_mfma_f32_16x16x32_bf16 a[104:107], v[72:75], v[40:43], a[104:107]
    buffer_load_dwordx4 v[208:211], v18, s[20:23], s44 offen offset:2048
    v_mfma_f32_16x16x32_bf16 a[104:107], v[120:123], v[88:91], a[104:107]
    v_mfma_f32_16x16x32_bf16 a[108:111], v[72:75], v[44:47], a[108:111]
    v_mfma_f32_16x16x32_bf16 a[108:111], v[120:123], v[92:95], a[108:111]
    buffer_load_dwordx4 v[164:167], v7, s[20:23], s36 offen offset:0
    v_mfma_f32_16x16x32_bf16 a[112:115], v[72:75], v[48:51], a[112:115]
    v_mfma_f32_16x16x32_bf16 a[112:115], v[120:123], v[96:99], a[112:115]
    v_mfma_f32_16x16x32_bf16 a[116:119], v[72:75], v[52:55], a[116:119]
    buffer_load_dwordx4 v[212:215], v7, s[20:23], s44 offen offset:0
    v_mfma_f32_16x16x32_bf16 a[116:119], v[120:123], v[100:103], a[116:119]
    s_waitcnt vmcnt(21)
    v_mfma_f32_16x16x32_bf16 a[120:123], v[76:79], v[32:35], a[120:123]
    s_waitcnt vmcnt(20)
    v_mfma_f32_16x16x32_bf16 a[120:123], v[124:127], v[80:83], a[120:123]
    buffer_load_dwordx4 v[168:171], v7, s[20:23], s36 offen offset:1024
    v_mfma_f32_16x16x32_bf16 a[124:127], v[76:79], v[36:39], a[124:127]
    v_mfma_f32_16x16x32_bf16 a[124:127], v[124:127], v[84:87], a[124:127]
    v_mfma_f32_16x16x32_bf16 a[128:131], v[76:79], v[40:43], a[128:131]
    buffer_load_dwordx4 v[216:219], v7, s[20:23], s44 offen offset:1024
    v_mfma_f32_16x16x32_bf16 a[128:131], v[124:127], v[88:91], a[128:131]
    v_mfma_f32_16x16x32_bf16 a[132:135], v[76:79], v[44:47], a[132:135]
    v_mfma_f32_16x16x32_bf16 a[132:135], v[124:127], v[92:95], a[132:135]
    buffer_load_dwordx4 v[172:175], v7, s[20:23], s36 offen offset:2048
    v_mfma_f32_16x16x32_bf16 a[136:139], v[76:79], v[48:51], a[136:139]
    v_mfma_f32_16x16x32_bf16 a[136:139], v[124:127], v[96:99], a[136:139]
    v_mfma_f32_16x16x32_bf16 a[140:143], v[76:79], v[52:55], a[140:143]
    buffer_load_dwordx4 v[220:223], v7, s[20:23], s44 offen offset:2048
    s_add_u32 s36, s36, 12288
    s_add_u32 s44, s44, 12288
    s_add_u32 s35, s35, 2048
    v_mfma_f32_16x16x32_bf16 a[140:143], v[124:127], v[100:103], a[140:143]
    s_waitcnt vmcnt(21)
    v_mfma_f32_16x16x32_bf16 a[0:3], v[152:155], v[128:131], a[0:3]
    s_waitcnt vmcnt(20)
    v_mfma_f32_16x16x32_bf16 a[0:3], v[200:203], v[176:179], a[0:3]
    s_waitcnt vmcnt(19)
    v_mfma_f32_16x16x32_bf16 a[4:7], v[152:155], v[132:135], a[4:7]
    s_waitcnt vmcnt(18)
    v_mfma_f32_16x16x32_bf16 a[4:7], v[200:203], v[180:183], a[4:7]
    s_waitcnt vmcnt(17)
    v_mfma_f32_16x16x32_bf16 a[8:11], v[152:155], v[136:139], a[8:11]
    s_waitcnt vmcnt(16)
    v_mfma_f32_16x16x32_bf16 a[8:11], v[200:203], v[184:187], a[8:11]
    s_waitcnt vmcnt(15)
    v_mfma_f32_16x16x32_bf16 a[12:15], v[152:155], v[140:143], a[12:15]
    s_waitcnt vmcnt(14)
    v_mfma_f32_16x16x32_bf16 a[12:15], v[200:203], v[188:191], a[12:15]
    s_waitcnt vmcnt(13)
    v_mfma_f32_16x16x32_bf16 a[16:19], v[152:155], v[144:147], a[16:19]
    s_waitcnt vmcnt(12)
    v_mfma_f32_16x16x32_bf16 a[16:19], v[200:203], v[192:195], a[16:19]
    ds_write_b128 v16, a[0:3] offset:0
    s_waitcnt vmcnt(11)
    v_mfma_f32_16x16x32_bf16 a[20:23], v[152:155], v[148:151], a[20:23]
    s_waitcnt vmcnt(10)
    v_mfma_f32_16x16x32_bf16 a[20:23], v[200:203], v[196:199], a[20:23]
    ds_write_b128 v16, a[4:7] offset:3072
    s_waitcnt vmcnt(9)
    v_mfma_f32_16x16x32_bf16 a[24:27], v[156:159], v[128:131], a[24:27]
    s_waitcnt vmcnt(8)
    v_mfma_f32_16x16x32_bf16 a[24:27], v[204:207], v[176:179], a[24:27]
    ds_write_b128 v16, a[8:11] offset:6144
    v_mfma_f32_16x16x32_bf16 a[28:31], v[156:159], v[132:135], a[28:31]
    v_mfma_f32_16x16x32_bf16 a[28:31], v[204:207], v[180:183], a[28:31]
    ds_write_b128 v8, a[12:15] offset:0
    v_mfma_f32_16x16x32_bf16 a[32:35], v[156:159], v[136:139], a[32:35]
    v_mfma_f32_16x16x32_bf16 a[32:35], v[204:207], v[184:187], a[32:35]
    ds_write_b128 v8, a[16:19] offset:3072
    v_mfma_f32_16x16x32_bf16 a[36:39], v[156:159], v[140:143], a[36:39]
    v_mfma_f32_16x16x32_bf16 a[36:39], v[204:207], v[188:191], a[36:39]
    ds_write_b128 v8, a[20:23] offset:6144
    v_mfma_f32_16x16x32_bf16 a[40:43], v[156:159], v[144:147], a[40:43]
    v_mfma_f32_16x16x32_bf16 a[40:43], v[204:207], v[192:195], a[40:43]
    ds_write_b128 v16, a[24:27] offset:1024
    v_mfma_f32_16x16x32_bf16 a[44:47], v[156:159], v[148:151], a[44:47]
    v_mfma_f32_16x16x32_bf16 a[44:47], v[204:207], v[196:199], a[44:47]
    ds_write_b128 v16, a[28:31] offset:4096
    s_waitcnt vmcnt(7)
    v_mfma_f32_16x16x32_bf16 a[48:51], v[160:163], v[128:131], a[48:51]
    s_waitcnt vmcnt(6)
    v_mfma_f32_16x16x32_bf16 a[48:51], v[208:211], v[176:179], a[48:51]
    ds_write_b128 v16, a[32:35] offset:7168
    v_mfma_f32_16x16x32_bf16 a[52:55], v[160:163], v[132:135], a[52:55]
    v_mfma_f32_16x16x32_bf16 a[52:55], v[208:211], v[180:183], a[52:55]
    ds_write_b128 v8, a[36:39] offset:1024
    v_mfma_f32_16x16x32_bf16 a[56:59], v[160:163], v[136:139], a[56:59]
    v_mfma_f32_16x16x32_bf16 a[56:59], v[208:211], v[184:187], a[56:59]
    ds_write_b128 v8, a[40:43] offset:4096
    v_mfma_f32_16x16x32_bf16 a[60:63], v[160:163], v[140:143], a[60:63]
    v_mfma_f32_16x16x32_bf16 a[60:63], v[208:211], v[188:191], a[60:63]
    ds_write_b128 v8, a[44:47] offset:7168
    v_mfma_f32_16x16x32_bf16 a[64:67], v[160:163], v[144:147], a[64:67]
    v_mfma_f32_16x16x32_bf16 a[64:67], v[208:211], v[192:195], a[64:67]
    ds_write_b128 v16, a[48:51] offset:2048
    v_mfma_f32_16x16x32_bf16 a[68:71], v[160:163], v[148:151], a[68:71]
    v_mfma_f32_16x16x32_bf16 a[68:71], v[208:211], v[196:199], a[68:71]
    ds_write_b128 v16, a[52:55] offset:5120
    s_waitcnt vmcnt(5)
    v_mfma_f32_16x16x32_bf16 a[72:75], v[164:167], v[128:131], a[72:75]
    s_waitcnt vmcnt(4)
    v_mfma_f32_16x16x32_bf16 a[72:75], v[212:215], v[176:179], a[72:75]
    ds_write_b128 v16, a[56:59] offset:8192
    v_mfma_f32_16x16x32_bf16 a[76:79], v[164:167], v[132:135], a[76:79]
    v_mfma_f32_16x16x32_bf16 a[76:79], v[212:215], v[180:183], a[76:79]
    ds_write_b128 v8, a[60:63] offset:2048
    v_mfma_f32_16x16x32_bf16 a[80:83], v[164:167], v[136:139], a[80:83]
    v_mfma_f32_16x16x32_bf16 a[80:83], v[212:215], v[184:187], a[80:83]
    ds_write_b128 v8, a[64:67] offset:5120
    s_waitcnt vmcnt(3)
    v_mfma_f32_16x16x32_bf16 a[96:99], v[168:171], v[128:131], a[96:99]
    s_waitcnt vmcnt(2)
    v_mfma_f32_16x16x32_bf16 a[96:99], v[216:219], v[176:179], a[96:99]
    ds_write_b128 v8, a[68:71] offset:8192
    v_mfma_f32_16x16x32_bf16 a[100:103], v[168:171], v[132:135], a[100:103]
    v_mfma_f32_16x16x32_bf16 a[100:103], v[216:219], v[180:183], a[100:103]
    ds_write_b128 v9, a[72:75] offset:0
    v_mfma_f32_16x16x32_bf16 a[104:107], v[168:171], v[136:139], a[104:107]
    v_mfma_f32_16x16x32_bf16 a[104:107], v[216:219], v[184:187], a[104:107]
    ds_write_b128 v9, a[76:79] offset:3072
    s_waitcnt vmcnt(1)
    v_mfma_f32_16x16x32_bf16 a[120:123], v[172:175], v[128:131], a[120:123]
    s_waitcnt vmcnt(0)
    v_mfma_f32_16x16x32_bf16 a[120:123], v[220:223], v[176:179], a[120:123]
    ds_write_b128 v9, a[80:83] offset:6144
    v_mfma_f32_16x16x32_bf16 a[124:127], v[172:175], v[132:135], a[124:127]
    v_mfma_f32_16x16x32_bf16 a[124:127], v[220:223], v[180:183], a[124:127]
    ds_write_b128 v9, a[96:99] offset:1024
    v_mfma_f32_16x16x32_bf16 a[128:131], v[172:175], v[136:139], a[128:131]
    v_mfma_f32_16x16x32_bf16 a[128:131], v[220:223], v[184:187], a[128:131]
    ds_write_b128 v9, a[100:103] offset:4096
    v_mfma_f32_16x16x32_bf16 a[84:87], v[164:167], v[140:143], a[84:87]
    v_mfma_f32_16x16x32_bf16 a[84:87], v[212:215], v[188:191], a[84:87]
    ds_write_b128 v9, a[104:107] offset:7168
    v_mfma_f32_16x16x32_bf16 a[88:91], v[164:167], v[144:147], a[88:91]
    v_mfma_f32_16x16x32_bf16 a[88:91], v[212:215], v[192:195], a[88:91]
    ds_write_b128 v9, a[120:123] offset:2048
    v_mfma_f32_16x16x32_bf16 a[92:95], v[164:167], v[148:151], a[92:95]
    v_mfma_f32_16x16x32_bf16 a[92:95], v[212:215], v[196:199], a[92:95]
    ds_write_b128 v9, a[124:127] offset:5120
    v_mfma_f32_16x16x32_bf16 a[108:111], v[168:171], v[140:143], a[108:111]
    v_mfma_f32_16x16x32_bf16 a[108:111], v[216:219], v[188:191], a[108:111]
    ds_write_b128 v9, a[128:131] offset:8192
    v_mfma_f32_16x16x32_bf16 a[112:115], v[168:171], v[144:147], a[112:115]
    v_mfma_f32_16x16x32_bf16 a[112:115], v[216:219], v[192:195], a[112:115]
    v_mfma_f32_16x16x32_bf16 a[116:119], v[168:171], v[148:151], a[116:119]
    v_mfma_f32_16x16x32_bf16 a[116:119], v[216:219], v[196:199], a[116:119]
    v_mfma_f32_16x16x32_bf16 a[132:135], v[172:175], v[140:143], a[132:135]
    v_mfma_f32_16x16x32_bf16 a[132:135], v[220:223], v[188:191], a[132:135]
    v_mfma_f32_16x16x32_bf16 a[136:139], v[172:175], v[144:147], a[136:139]
    v_mfma_f32_16x16x32_bf16 a[136:139], v[220:223], v[192:195], a[136:139]
    v_mfma_f32_16x16x32_bf16 a[140:143], v[172:175], v[148:151], a[140:143]
    v_mfma_f32_16x16x32_bf16 a[140:143], v[220:223], v[196:199], a[140:143]
    s_nop 7
    v_accvgpr_read_b32 v140, a84
    v_accvgpr_read_b32 v141, a85
    v_accvgpr_read_b32 v142, a86
    v_accvgpr_read_b32 v143, a87
    v_accvgpr_read_b32 v144, a108
    v_accvgpr_read_b32 v145, a109
    v_accvgpr_read_b32 v146, a110
    v_accvgpr_read_b32 v147, a111
    v_accvgpr_read_b32 v148, a132
    v_accvgpr_read_b32 v149, a133
    v_accvgpr_read_b32 v150, a134
    v_accvgpr_read_b32 v151, a135
    v_accvgpr_read_b32 v152, a88
    v_accvgpr_read_b32 v153, a89
    v_accvgpr_read_b32 v154, a90
    v_accvgpr_read_b32 v155, a91
    v_accvgpr_read_b32 v156, a112
    v_accvgpr_read_b32 v157, a113
    v_accvgpr_read_b32 v158, a114
    v_accvgpr_read_b32 v159, a115
    v_accvgpr_read_b32 v160, a136
    v_accvgpr_read_b32 v161, a137
    v_accvgpr_read_b32 v162, a138
    v_accvgpr_read_b32 v163, a139
    v_accvgpr_read_b32 v164, a92
    v_accvgpr_read_b32 v165, a93
    v_accvgpr_read_b32 v166, a94
    v_accvgpr_read_b32 v167, a95
    v_accvgpr_read_b32 v168, a116
    v_accvgpr_read_b32 v169, a117
    v_accvgpr_read_b32 v170, a118
    v_accvgpr_read_b32 v171, a119
    v_accvgpr_read_b32 v172, a140
    v_accvgpr_read_b32 v173, a141
    v_accvgpr_read_b32 v174, a142
    v_accvgpr_read_b32 v175, a143
    s_waitcnt lgkmcnt(0)
    s_barrier
    ds_read_b128 v[32:35], v10 offset:0
    ds_read_b128 v[68:71], v10 offset:9216
    ds_read_b128 v[104:107], v10 offset:18432
    ds_read_b128 v[36:39], v10 offset:1024
    ds_read_b128 v[72:75], v10 offset:10240
    ds_read_b128 v[108:111], v10 offset:19456
    ds_read_b128 v[40:43], v10 offset:2048
    ds_read_b128 v[76:79], v10 offset:11264
    ds_read_b128 v[112:115], v10 offset:20480
    ds_read_b128 v[44:47], v10 offset:3072
    ds_read_b128 v[80:83], v10 offset:12288
    ds_read_b128 v[116:119], v10 offset:21504
    ds_read_b128 v[48:51], v10 offset:4096
    ds_read_b128 v[84:87], v10 offset:13312
    ds_read_b128 v[120:123], v10 offset:22528
    ds_read_b128 v[52:55], v10 offset:5120
    ds_read_b128 v[88:91], v10 offset:14336
    ds_read_b128 v[124:127], v10 offset:23552
    ds_read_b128 v[56:59], v10 offset:6144
    ds_read_b128 v[92:95], v10 offset:15360
    ds_read_b128 v[128:131], v10 offset:24576
    ds_read_b128 v[60:63], v10 offset:7168
    ds_read_b128 v[96:99], v10 offset:16384
    ds_read_b128 v[132:135], v10 offset:25600
    ds_read_b128 v[64:67], v10 offset:8192
    ds_read_b128 v[100:103], v10 offset:17408
    ds_read_b128 v[136:139], v10 offset:26624
    s_waitcnt lgkmcnt(15)
    v_add_f32 v32, v32, v68
    v_add_f32 v104, v104, v140
    v_add_f32 v33, v33, v69
    v_add_f32 v105, v105, v141
    v_add_f32 v34, v34, v70
    v_add_f32 v106, v106, v142
    v_add_f32 v35, v35, v71
    v_add_f32 v107, v107, v143
    v_add_f32 v32, v32, v104
    v_add_f32 v33, v33, v105
    v_add_f32 v34, v34, v106
    v_add_f32 v35, v35, v107
    v_cvt_pk_bf16_f32 v192, v32, v33
    v_cvt_pk_bf16_f32 v193, v34, v35
    s_waitcnt lgkmcnt(15)
    v_add_f32 v36, v36, v72
    v_add_f32 v108, v108, v144
    v_add_f32 v37, v37, v73
    v_add_f32 v109, v109, v145
    v_add_f32 v38, v38, v74
    v_add_f32 v110, v110, v146
    v_add_f32 v39, v39, v75
    v_add_f32 v111, v111, v147
    v_add_f32 v36, v36, v108
    v_add_f32 v37, v37, v109
    v_add_f32 v38, v38, v110
    v_add_f32 v39, v39, v111
    v_cvt_pk_bf16_f32 v194, v36, v37
    v_cvt_pk_bf16_f32 v195, v38, v39
    s_waitcnt lgkmcnt(15)
    v_add_f32 v40, v40, v76
    v_add_f32 v112, v112, v148
    v_add_f32 v41, v41, v77
    v_add_f32 v113, v113, v149
    v_add_f32 v42, v42, v78
    v_add_f32 v114, v114, v150
    v_add_f32 v43, v43, v79
    v_add_f32 v115, v115, v151
    v_add_f32 v40, v40, v112
    v_add_f32 v41, v41, v113
    v_add_f32 v42, v42, v114
    v_add_f32 v43, v43, v115
    v_cvt_pk_bf16_f32 v196, v40, v41
    v_cvt_pk_bf16_f32 v197, v42, v43
    buffer_store_dwordx4 v[192:195], v11, s[24:27], 0 offen offset:0
    buffer_store_dwordx2 v[196:197], v11, s[24:27], 0 offen offset:16
    s_waitcnt lgkmcnt(15)
    v_add_f32 v44, v44, v80
    v_add_f32 v116, v116, v152
    v_add_f32 v45, v45, v81
    v_add_f32 v117, v117, v153
    v_add_f32 v46, v46, v82
    v_add_f32 v118, v118, v154
    v_add_f32 v47, v47, v83
    v_add_f32 v119, v119, v155
    v_add_f32 v44, v44, v116
    v_add_f32 v45, v45, v117
    v_add_f32 v46, v46, v118
    v_add_f32 v47, v47, v119
    v_cvt_pk_bf16_f32 v200, v44, v45
    v_cvt_pk_bf16_f32 v201, v46, v47
    s_waitcnt lgkmcnt(12)
    v_add_f32 v48, v48, v84
    v_add_f32 v120, v120, v156
    v_add_f32 v49, v49, v85
    v_add_f32 v121, v121, v157
    v_add_f32 v50, v50, v86
    v_add_f32 v122, v122, v158
    v_add_f32 v51, v51, v87
    v_add_f32 v123, v123, v159
    v_add_f32 v48, v48, v120
    v_add_f32 v49, v49, v121
    v_add_f32 v50, v50, v122
    v_add_f32 v51, v51, v123
    v_cvt_pk_bf16_f32 v202, v48, v49
    v_cvt_pk_bf16_f32 v203, v50, v51
    s_waitcnt lgkmcnt(9)
    v_add_f32 v52, v52, v88
    v_add_f32 v124, v124, v160
    v_add_f32 v53, v53, v89
    v_add_f32 v125, v125, v161
    v_add_f32 v54, v54, v90
    v_add_f32 v126, v126, v162
    v_add_f32 v55, v55, v91
    v_add_f32 v127, v127, v163
    v_add_f32 v52, v52, v124
    v_add_f32 v53, v53, v125
    v_add_f32 v54, v54, v126
    v_add_f32 v55, v55, v127
    v_cvt_pk_bf16_f32 v204, v52, v53
    v_cvt_pk_bf16_f32 v205, v54, v55
    buffer_store_dwordx4 v[200:203], v11, s[24:27], s40 offen offset:0
    buffer_store_dwordx2 v[204:205], v11, s[24:27], s40 offen offset:16
    s_waitcnt lgkmcnt(6)
    v_add_f32 v56, v56, v92
    v_add_f32 v128, v128, v164
    v_add_f32 v57, v57, v93
    v_add_f32 v129, v129, v165
    v_add_f32 v58, v58, v94
    v_add_f32 v130, v130, v166
    v_add_f32 v59, v59, v95
    v_add_f32 v131, v131, v167
    v_add_f32 v56, v56, v128
    v_add_f32 v57, v57, v129
    v_add_f32 v58, v58, v130
    v_add_f32 v59, v59, v131
    v_cvt_pk_bf16_f32 v208, v56, v57
    v_cvt_pk_bf16_f32 v209, v58, v59
    s_waitcnt lgkmcnt(3)
    v_add_f32 v60, v60, v96
    v_add_f32 v132, v132, v168
    v_add_f32 v61, v61, v97
    v_add_f32 v133, v133, v169
    v_add_f32 v62, v62, v98
    v_add_f32 v134, v134, v170
    v_add_f32 v63, v63, v99
    v_add_f32 v135, v135, v171
    v_add_f32 v60, v60, v132
    v_add_f32 v61, v61, v133
    v_add_f32 v62, v62, v134
    v_add_f32 v63, v63, v135
    v_cvt_pk_bf16_f32 v210, v60, v61
    v_cvt_pk_bf16_f32 v211, v62, v63
    s_waitcnt lgkmcnt(0)
    v_add_f32 v64, v64, v100
    v_add_f32 v136, v136, v172
    v_add_f32 v65, v65, v101
    v_add_f32 v137, v137, v173
    v_add_f32 v66, v66, v102
    v_add_f32 v138, v138, v174
    v_add_f32 v67, v67, v103
    v_add_f32 v139, v139, v175
    v_add_f32 v64, v64, v136
    v_add_f32 v65, v65, v137
    v_add_f32 v66, v66, v138
    v_add_f32 v67, v67, v139
    v_cvt_pk_bf16_f32 v212, v64, v65
    v_cvt_pk_bf16_f32 v213, v66, v67
    buffer_store_dwordx4 v[208:211], v11, s[24:27], s41 offen offset:0
    buffer_store_dwordx2 v[212:213], v11, s[24:27], s41 offen offset:16
L_k2_end:
    s_endpgm

L_code_end:
.section .rodata,"a"
.p2align 6
.amdhsa_kernel attn_kernel
  .amdhsa_next_free_vgpr 512
  .amdhsa_next_free_sgpr 102
  .amdhsa_accum_offset 256
  .amdhsa_group_segment_fixed_size 0
  .amdhsa_kernarg_size 104
  .amdhsa_user_sgpr_count 2
  .amdhsa_user_sgpr_kernarg_segment_ptr 1
  .amdhsa_system_sgpr_workgroup_id_x 1
.end_amdhsa_kernel

.p2align 6
.amdhsa_kernel oproj_kernel
  .amdhsa_next_free_vgpr 512
  .amdhsa_next_free_sgpr 96
  .amdhsa_accum_offset 256
  .amdhsa_group_segment_fixed_size 0
  .amdhsa_kernarg_size 104
  .amdhsa_user_sgpr_count 2
  .amdhsa_user_sgpr_kernarg_segment_ptr 1
  .amdhsa_system_sgpr_workgroup_id_x 1
.end_amdhsa_kernel
```
